```python
import torch

def _softmax(x, axis=-1):
    return torch.softmax(x, dim=axis)
def _gelu(x):
    return torch.nn.functional.gelu(x, approximate="tanh")
def _silu(x):
    return torch.nn.functional.silu(x)
def _sigmoid(x):
    return torch.sigmoid(x)
def _layernorm(x, axis=-1, eps=1e-5):
    m = x.mean(dim=axis, keepdim=True)
    v = x.var(dim=axis, keepdim=True, unbiased=False)
    return (x - m) / torch.sqrt(v + eps)
def _scatter_add(tgt, idx, src, axis=0):
    return tgt.clone().index_add_(axis, idx, src)
def _segment_sum(src, seg, n):
    out = torch.zeros((n,) + src.shape[1:], dtype=src.dtype)
    return out.index_add_(0, seg, src)
def _pad(x, pw):
    flat = tuple(v for pair in reversed(pw) for v in pair)
    return torch.nn.functional.pad(x, flat)

kernel_name = 'standalone__batchnorm__sampling'

def setup_inputs():

    _w = (lambda a: (lambda t: t.to(torch.bfloat16) if t.is_floating_point() else t)(torch.as_tensor(a)))
    B, S, C = 1024, 32, 512
    K = 3
    return {
        "x": _w((lambda *s: torch.randn(*s, dtype=torch.bfloat16) * 0.05)(B, S, C)),
        "w": _w((lambda *s: torch.randn(*s, dtype=torch.bfloat16) * 0.05)(K, C, C) * (1.0 / (K * C) ** 0.5)),
        "mean": _w((lambda *s: torch.randn(*s, dtype=torch.bfloat16) * 0.05)(C) * 0.1),
        "var": _w(torch.abs((lambda *s: torch.randn(*s, dtype=torch.bfloat16) * 0.05)(C)) + 0.5),
        "g": _w((lambda *s: torch.randn(*s, dtype=torch.bfloat16) * 0.05)(C) + 1.0),
        "b": _w((lambda *s: torch.randn(*s, dtype=torch.bfloat16) * 0.05)(C) * 0.1),
    }

def reference(x, w, mean, var, g, b):
    K = 3
    P = K // 2
    S = x.shape[1]
    xp = _pad(x, ((0, 0), (P, P), (0, 0)))
    y = sum(torch.einsum('bsc,cd->bsd', xp[:, k:k + S, :], w[k]) for k in range(K))
    inv_std = 1.0 / torch.sqrt(var + 1e-5)
    y = (y - mean) * (g * inv_std) + b
    return _silu(y)
```

```asm
; @launch grid=(256,1,1) block=(256,1,1) lds=163840
.amdgcn_target "amdgcn-amd-amdhsa--gfx950"
.text
.globl standalone__batchnorm__sampling_kernel
.p2align 8
.type standalone__batchnorm__sampling_kernel,@function
standalone__batchnorm__sampling_kernel:
    s_cmp_ge_u32 s2, 256
    s_cbranch_scc1 L_end
    s_load_dwordx8 s[32:39], s[0:1], 0
    s_load_dwordx4 s[40:43], s[0:1], 32
    s_load_dwordx2 s[44:45], s[0:1], 48
    s_getpc_b64 s[64:65]
L_pc:
    s_and_b32 s65, s65, 0xffff
    s_mov_b32 s66, L_code_end-L_pc
    s_mov_b32 s67, 0x00020000
    v_lshrrev_b32 v12, 6, v0
    v_and_b32 v11, 63, v0
    v_lshlrev_b32 v0, 6, v0
    buffer_load_dword v255, v0, s[64:67], 0 offen
    v_readfirstlane_b32 s20, v12
    s_and_b32 s3, s2, 7
    s_lshr_b32 s4, s2, 3
    s_and_b32 s5, s4, 3
    s_lshr_b32 s4, s4, 2
    s_add_u32 s6, s4, s3
    s_and_b32 s6, s6, 3
    s_lshl_b32 s3, s3, 3
    s_add_u32 s3, s3, s4
    s_lshl_b32 s3, s3, 19
    s_lshl_b32 s5, s5, 8
    s_add_u32 s7, s6, 0
    s_and_b32 s7, s7, 3
    s_lshl_b32 s24, s7, 17
    s_add_u32 s7, s6, 1
    s_and_b32 s7, s7, 3
    s_lshl_b32 s25, s7, 17
    s_add_u32 s7, s6, 2
    s_and_b32 s7, s7, 3
    s_lshl_b32 s30, s7, 17
    s_add_u32 s7, s6, 3
    s_and_b32 s7, s7, 3
    s_lshl_b32 s31, s7, 17
    v_and_b32 v13, 15, v11
    v_lshrrev_b32 v14, 4, v11
    s_and_b32 s7, s20, 1
    s_mul_i32 s4, s7, 3
    v_and_b32 v17, 3, v11
    v_xor_b32 v16, s4, v17
    v_lshlrev_b32 v16, 4, v16
    v_lshrrev_b32 v15, 5, v11
    v_lshl_add_u32 v16, v15, 6, v16
    v_bfe_u32 v15, v11, 2, 3
    v_lshl_add_u32 v16, v15, 15, v16
    s_lshl_b32 s4, s7, 18
    v_add_u32 v127, s4, v16
    s_lshr_b32 s4, s20, 1
    s_lshl_b32 s26, s4, 13
    s_lshl_b32 s7, s7, 10
    s_add_u32 s26, s26, s7
    s_lshl_b32 s27, s4, 12
    s_lshl_b32 s4, s4, 2
    v_add_u32 v16, s4, v14
    v_lshrrev_b32 v15, 1, v13
    v_xor_b32 v16, v16, v15
    v_lshlrev_b32 v16, 5, v16
    v_and_b32 v15, 1, v13
    v_lshl_add_u32 v16, v15, 4, v16
    v_lshl_add_u32 v16, v14, 10, v16
    s_lshl_b32 s7, s20, 12
    v_add_u32 v123, s7, v16
    s_lshl_b32 s21, s20, 10
    s_mov_b32 s28, 0xbfb8aa3b
    s_waitcnt lgkmcnt(0)
    s_add_u32 s8, s32, s3
    s_addc_u32 s9, s33, 0
    s_mov_b32 s10, 524288
    s_mov_b32 s11, 0x00020000
    s_add_u32 s12, s34, s5
    s_addc_u32 s13, s35, 0
    s_sub_u32 s14, 1572864, s5
    s_mov_b32 s15, 0x00020000
    s_lshr_b32 s4, s24, 9
    s_add_u32 s32, s4, s27
    s_lshr_b32 s4, s25, 9
    s_add_u32 s33, s4, s27
    s_lshr_b32 s4, s30, 9
    s_add_u32 s34, s4, s27
    s_lshr_b32 s4, s31, 9
    s_add_u32 s35, s4, s27
    s_add_u32 m0, s26, 0
    s_add_u32 s29, s32, 0
    s_nop 0
    buffer_load_dwordx4 v127, s[8:11], s29 offen lds
    s_add_u32 m0, s26, 2048
    s_add_u32 s29, s32, 1024
    s_nop 0
    buffer_load_dwordx4 v127, s[8:11], s29 offen lds
    s_add_u32 m0, s26, 4096
    s_add_u32 s29, s32, 2048
    s_nop 0
    buffer_load_dwordx4 v127, s[8:11], s29 offen lds
    s_add_u32 m0, s26, 6144
    s_add_u32 s29, s32, 3072
    s_nop 0
    buffer_load_dwordx4 v127, s[8:11], s29 offen lds
    s_add_u32 m0, s21, 16384
    s_add_u32 s29, s24, 0
    s_nop 0
    buffer_load_dwordx4 v123, s[12:15], s29 offen lds
    s_add_u32 m0, s21, 20480
    s_add_u32 s29, s24, 16384
    s_nop 0
    buffer_load_dwordx4 v123, s[12:15], s29 offen lds
    s_add_u32 m0, s21, 24576
    s_add_u32 s29, s24, 524288
    s_nop 0
    buffer_load_dwordx4 v123, s[12:15], s29 offen lds
    s_add_u32 m0, s21, 28672
    s_add_u32 s29, s24, 540672
    s_nop 0
    buffer_load_dwordx4 v123, s[12:15], s29 offen lds
    s_add_u32 m0, s21, 32768
    s_add_u32 s29, s24, 1048576
    s_nop 0
    buffer_load_dwordx4 v123, s[12:15], s29 offen lds
    s_add_u32 m0, s21, 36864
    s_add_u32 s29, s24, 1064960
    s_nop 0
    buffer_load_dwordx4 v123, s[12:15], s29 offen lds
    s_add_u32 s3, s3, s5
    s_add_u32 s16, s44, s3
    s_addc_u32 s17, s45, 0
    s_sub_u32 s18, 524288, s5
    s_mov_b32 s19, 0x00020000
    s_lshr_b32 s7, s20, 1
    s_mul_i32 s7, s7, 3
    v_xor_b32 v17, s7, v17
    v_lshlrev_b32 v17, 4, v17
    v_lshl_add_u32 v17, v14, 6, v17
    v_bfe_u32 v16, v11, 2, 2
    v_lshl_add_u32 v17, v16, 15, v17
    s_lshl_b32 s7, s20, 17
    v_add_u32 v17, s7, v17
    s_lshr_b32 s7, s24, 9
    v_add_u32 v4, s7, v17
    s_lshr_b32 s7, s25, 9
    v_add_u32 v5, s7, v17
    s_lshr_b32 s7, s30, 9
    v_add_u32 v6, s7, v17
    s_lshr_b32 s7, s31, 9
    v_add_u32 v7, s7, v17
    s_lshl_b32 s7, s20, 6
    s_add_u32 s4, s7, s5
    v_lshlrev_b32 v16, 3, v14
    v_add_u32 v224, s4, v16
    v_lshrrev_b32 v15, 3, v13
    v_mul_u32_u24 v17, 3, v15
    v_xor_b32 v17, v14, v17
    v_lshlrev_b32 v17, 4, v17
    v_lshl_add_u32 v18, v15, 10, v17
    v_and_b32 v16, 7, v13
    v_lshl_add_u32 v126, v16, 6, v18
    v_lshrrev_b32 v16, 2, v13
    v_lshl_add_u32 v17, v16, 10, v17
    v_and_b32 v16, 3, v13
    v_lshl_add_u32 v1, v16, 6, v17
    v_add_u32 v2, 0x10000, v1
    v_lshrrev_b32 v16, 2, v13
    v_and_b32 v17, 1, v14
    v_lshl_add_u32 v17, v17, 2, v16
    s_lshl_b32 s3, s20, 1
    v_xor_b32 v17, s3, v17
    v_lshlrev_b32 v17, 5, v17
    v_lshl_add_u32 v16, v14, 3, v16
    v_lshl_add_u32 v17, v16, 8, v17
    v_and_b32 v16, 3, v11
    v_lshl_add_u32 v17, v16, 3, v17
    v_add_u32 v124, 16384, v17
    v_xor_b32 v125, 32, v124
    v_add_u32 v121, 98304, v124
    v_add_u32 v122, 98304, v125
    v_add_u32 v120, 0x10000, v126
    v_and_b32 v16, 1, v14
    v_lshlrev_b32 v16, 5, v16
    v_lshrrev_b32 v17, 1, v14
    v_lshl_add_u32 v16, v17, 4, v16
    v_lshl_add_u32 v16, v13, 15, v16
    v_add_u32 v3, s7, v16
    s_add_u32 m0, s21, 40960
    s_add_u32 s29, s24, 32768
    s_nop 0
    buffer_load_dwordx4 v123, s[12:15], s29 offen lds
    s_add_u32 m0, s21, 45056
    s_add_u32 s29, s24, 49152
    s_nop 0
    buffer_load_dwordx4 v123, s[12:15], s29 offen lds
    s_add_u32 m0, s21, 49152
    s_add_u32 s29, s24, 557056
    s_nop 0
    buffer_load_dwordx4 v123, s[12:15], s29 offen lds
    s_add_u32 m0, s21, 53248
    s_add_u32 s29, s24, 573440
    s_nop 0
    buffer_load_dwordx4 v123, s[12:15], s29 offen lds
    s_add_u32 m0, s21, 57344
    s_add_u32 s29, s24, 1081344
    s_nop 0
    buffer_load_dwordx4 v123, s[12:15], s29 offen lds
    s_add_u32 m0, s21, 61440
    s_add_u32 s29, s24, 1097728
    s_nop 0
    buffer_load_dwordx4 v123, s[12:15], s29 offen lds
    global_load_dwordx2 v[208:209], v224, s[36:37]
    global_load_dwordx2 v[210:211], v224, s[36:37] offset:32
    global_load_dwordx2 v[212:213], v224, s[38:39]
    global_load_dwordx2 v[214:215], v224, s[38:39] offset:32
    global_load_dwordx2 v[216:217], v224, s[40:41]
    global_load_dwordx2 v[218:219], v224, s[40:41] offset:32
    global_load_dwordx2 v[220:221], v224, s[42:43]
    global_load_dwordx2 v[222:223], v224, s[42:43] offset:32
    s_add_u32 m0, s26, 65536
    s_add_u32 s29, s32, 128
    s_nop 0
    buffer_load_dwordx4 v127, s[8:11], s29 offen lds
    s_add_u32 m0, s26, 67584
    s_add_u32 s29, s32, 1152
    s_nop 0
    buffer_load_dwordx4 v127, s[8:11], s29 offen lds
    s_add_u32 m0, s26, 69632
    s_add_u32 s29, s32, 2176
    s_nop 0
    buffer_load_dwordx4 v127, s[8:11], s29 offen lds
    s_add_u32 m0, s26, 71680
    s_add_u32 s29, s32, 3200
    s_nop 0
    buffer_load_dwordx4 v127, s[8:11], s29 offen lds
    s_add_u32 m0, s21, 114688
    s_add_u32 s29, s24, 65536
    s_nop 0
    buffer_load_dwordx4 v123, s[12:15], s29 offen lds
    s_add_u32 m0, s21, 118784
    s_add_u32 s29, s24, 81920
    s_nop 0
    buffer_load_dwordx4 v123, s[12:15], s29 offen lds
    s_add_u32 m0, s21, 122880
    s_add_u32 s29, s24, 589824
    s_nop 0
    buffer_load_dwordx4 v123, s[12:15], s29 offen lds
    s_add_u32 m0, s21, 126976
    s_add_u32 s29, s24, 606208
    s_nop 0
    buffer_load_dwordx4 v123, s[12:15], s29 offen lds
    s_add_u32 m0, s21, 131072
    s_add_u32 s29, s24, 1114112
    s_nop 0
    buffer_load_dwordx4 v123, s[12:15], s29 offen lds
    s_add_u32 m0, s21, 135168
    s_add_u32 s29, s24, 1130496
    s_nop 0
    buffer_load_dwordx4 v123, s[12:15], s29 offen lds
    s_waitcnt vmcnt(24)
    s_barrier
    ds_read_b64_tr_b16 a[0:1], v124 offset:0
    ds_read_b64_tr_b16 a[2:3], v124 offset:1024
    ds_read_b64_tr_b16 a[4:5], v125 offset:0
    ds_read_b64_tr_b16 a[6:7], v125 offset:1024
    ds_read_b64_tr_b16 a[8:9], v124 offset:8192
    ds_read_b64_tr_b16 a[10:11], v124 offset:9216
    ds_read_b64_tr_b16 a[12:13], v125 offset:8192
    ds_read_b64_tr_b16 a[14:15], v125 offset:9216
    ds_read_b64_tr_b16 a[16:17], v124 offset:16384
    ds_read_b64_tr_b16 a[18:19], v124 offset:17408
    ds_read_b64_tr_b16 a[20:21], v125 offset:16384
    ds_read_b64_tr_b16 a[22:23], v125 offset:17408
    ds_read_b128 v[88:91], v126 offset:0
    ds_read_b128 v[92:95], v126 offset:2048
    ds_read_b128 v[96:99], v126 offset:4096
    s_waitcnt lgkmcnt(3)
    s_waitcnt lgkmcnt(2)
    v_mfma_f32_16x16x32_bf16 v[40:43], a[8:11], v[88:91], 0
    ds_read_b128 v[100:103], v126 offset:6144
    s_waitcnt lgkmcnt(2)
    v_mfma_f32_16x16x32_bf16 v[40:43], a[16:19], v[92:95], v[40:43]
    s_add_u32 m0, s21, 139264
    s_add_u32 s29, s24, 98304
    v_mfma_f32_16x16x32_bf16 v[44:47], a[20:23], v[92:95], 0
    buffer_load_dwordx4 v123, s[12:15], s29 offen lds
    v_mfma_f32_16x16x32_bf16 v[44:47], a[12:15], v[88:91], v[44:47]
    v_mfma_f32_16x16x32_bf16 v[48:51], a[0:3], v[88:91], 0
    v_mfma_f32_16x16x32_bf16 v[48:51], a[8:11], v[92:95], v[48:51]
    s_add_u32 m0, s21, 143360
    s_add_u32 s29, s24, 114688
    s_waitcnt lgkmcnt(1)
    v_mfma_f32_16x16x32_bf16 v[48:51], a[16:19], v[96:99], v[48:51]
    buffer_load_dwordx4 v123, s[12:15], s29 offen lds
    v_mfma_f32_16x16x32_bf16 v[52:55], a[20:23], v[96:99], 0
    v_mfma_f32_16x16x32_bf16 v[52:55], a[12:15], v[92:95], v[52:55]
    v_mfma_f32_16x16x32_bf16 v[52:55], a[4:7], v[88:91], v[52:55]
    ds_read_b128 v[88:91], v126 offset:8192
    s_add_u32 m0, s21, 147456
    s_add_u32 s29, s24, 622592
    v_mfma_f32_16x16x32_bf16 v[56:59], a[0:3], v[92:95], 0
    buffer_load_dwordx4 v123, s[12:15], s29 offen lds
    v_mfma_f32_16x16x32_bf16 v[56:59], a[8:11], v[96:99], v[56:59]
    s_waitcnt lgkmcnt(1)
    v_mfma_f32_16x16x32_bf16 v[56:59], a[16:19], v[100:103], v[56:59]
    v_mfma_f32_16x16x32_bf16 v[60:63], a[20:23], v[100:103], 0
    s_add_u32 m0, s21, 151552
    s_add_u32 s29, s24, 638976
    v_mfma_f32_16x16x32_bf16 v[60:63], a[12:15], v[96:99], v[60:63]
    buffer_load_dwordx4 v123, s[12:15], s29 offen lds
    v_mfma_f32_16x16x32_bf16 v[60:63], a[4:7], v[92:95], v[60:63]
    ds_read_b128 v[92:95], v126 offset:10240
    v_mfma_f32_16x16x32_bf16 v[64:67], a[0:3], v[96:99], 0
    v_mfma_f32_16x16x32_bf16 v[64:67], a[8:11], v[100:103], v[64:67]
    s_add_u32 m0, s21, 155648
    s_add_u32 s29, s24, 1146880
    s_waitcnt lgkmcnt(1)
    v_mfma_f32_16x16x32_bf16 v[64:67], a[16:19], v[88:91], v[64:67]
    buffer_load_dwordx4 v123, s[12:15], s29 offen lds
    v_mfma_f32_16x16x32_bf16 v[68:71], a[20:23], v[88:91], 0
    v_mfma_f32_16x16x32_bf16 v[68:71], a[12:15], v[100:103], v[68:71]
    v_mfma_f32_16x16x32_bf16 v[68:71], a[4:7], v[96:99], v[68:71]
    ds_read_b128 v[96:99], v126 offset:12288
    s_add_u32 m0, s21, 159744
    s_add_u32 s29, s24, 1163264
    v_mfma_f32_16x16x32_bf16 v[72:75], a[0:3], v[100:103], 0
    buffer_load_dwordx4 v123, s[12:15], s29 offen lds
    s_waitcnt vmcnt(24)
    v_mfma_f32_16x16x32_bf16 v[72:75], a[8:11], v[88:91], v[72:75]
    s_barrier
    s_waitcnt lgkmcnt(1)
    v_mfma_f32_16x16x32_bf16 v[72:75], a[16:19], v[92:95], v[72:75]
    ds_read_b64_tr_b16 a[24:25], v124 offset:24576
    v_mfma_f32_16x16x32_bf16 v[76:79], a[20:23], v[92:95], 0
    ds_read_b64_tr_b16 a[26:27], v124 offset:25600
    s_add_u32 m0, s26, 81920
    s_add_u32 s29, s33, 0
    v_mfma_f32_16x16x32_bf16 v[76:79], a[12:15], v[88:91], v[76:79]
    buffer_load_dwordx4 v127, s[8:11], s29 offen lds
    ds_read_b64_tr_b16 a[28:29], v125 offset:24576
    v_mfma_f32_16x16x32_bf16 v[76:79], a[4:7], v[100:103], v[76:79]
    ds_read_b128 v[100:103], v126 offset:14336
    ds_read_b64_tr_b16 a[30:31], v125 offset:25600
    v_mfma_f32_16x16x32_bf16 v[80:83], a[0:3], v[88:91], 0
    ds_read_b64_tr_b16 a[32:33], v124 offset:32768
    v_mfma_f32_16x16x32_bf16 v[80:83], a[8:11], v[92:95], v[80:83]
    ds_read_b64_tr_b16 a[34:35], v124 offset:33792
    s_waitcnt lgkmcnt(7)
    v_mfma_f32_16x16x32_bf16 v[80:83], a[16:19], v[96:99], v[80:83]
    ds_read_b64_tr_b16 a[36:37], v125 offset:32768
    s_add_u32 m0, s26, 83968
    s_add_u32 s29, s33, 1024
    v_mfma_f32_16x16x32_bf16 v[84:87], a[20:23], v[96:99], 0
    buffer_load_dwordx4 v127, s[8:11], s29 offen lds
    ds_read_b64_tr_b16 a[38:39], v125 offset:33792
    v_mfma_f32_16x16x32_bf16 v[84:87], a[12:15], v[92:95], v[84:87]
    ds_read_b64_tr_b16 a[40:41], v124 offset:40960
    v_mfma_f32_16x16x32_bf16 v[84:87], a[4:7], v[88:91], v[84:87]
    ds_read_b128 v[88:91], v126 offset:512
    ds_read_b64_tr_b16 a[42:43], v124 offset:41984
    v_mfma_f32_16x16x32_bf16 v[24:27], a[0:3], v[92:95], 0
    ds_read_b64_tr_b16 a[44:45], v125 offset:40960
    s_add_u32 m0, s26, 86016
    s_add_u32 s29, s33, 2048
    v_mfma_f32_16x16x32_bf16 v[24:27], a[8:11], v[96:99], v[24:27]
    buffer_load_dwordx4 v127, s[8:11], s29 offen lds
    s_waitcnt lgkmcnt(9)
    v_mfma_f32_16x16x32_bf16 v[24:27], a[16:19], v[100:103], v[24:27]
    ds_read_b64_tr_b16 a[46:47], v125 offset:41984
    v_mfma_f32_16x16x32_bf16 v[28:31], a[20:23], v[100:103], 0
    v_mfma_f32_16x16x32_bf16 v[28:31], a[12:15], v[96:99], v[28:31]
    s_add_u32 m0, s26, 88064
    s_add_u32 s29, s33, 3072
    v_mfma_f32_16x16x32_bf16 v[28:31], a[4:7], v[92:95], v[28:31]
    ds_read_b128 v[92:95], v126 offset:2560
    buffer_load_dwordx4 v127, s[8:11], s29 offen lds
    v_mfma_f32_16x16x32_bf16 v[32:35], a[0:3], v[96:99], 0
    v_mfma_f32_16x16x32_bf16 v[32:35], a[8:11], v[100:103], v[32:35]
    v_mfma_f32_16x16x32_bf16 v[36:39], a[12:15], v[100:103], 0
    s_add_u32 m0, s21, 16384
    s_add_u32 s29, s25, 0
    v_mfma_f32_16x16x32_bf16 v[36:39], a[4:7], v[96:99], v[36:39]
    ds_read_b128 v[96:99], v126 offset:4608
    buffer_load_dwordx4 v123, s[12:15], s29 offen lds
    v_mfma_f32_16x16x32_bf16 v[8:11], a[0:3], v[100:103], 0
    s_waitcnt lgkmcnt(2)
    v_mfma_f32_16x16x32_bf16 v[12:15], a[4:7], v[100:103], 0
    ds_read_b128 v[100:103], v126 offset:6656
    v_mfma_f32_16x16x32_bf16 v[40:43], a[32:35], v[88:91], v[40:43]
    s_waitcnt vmcnt(21)
    s_waitcnt lgkmcnt(2)
    v_mfma_f32_16x16x32_bf16 v[40:43], a[40:43], v[92:95], v[40:43]
    v_lshlrev_b32 v104, 16, v212
    s_add_u32 m0, s21, 20480
    s_add_u32 s29, s25, 16384
    v_mfma_f32_16x16x32_bf16 v[44:47], a[44:47], v[92:95], v[44:47]
    buffer_load_dwordx4 v123, s[12:15], s29 offen lds
    v_and_b32 v105, 0xffff0000, v212
    v_mfma_f32_16x16x32_bf16 v[44:47], a[36:39], v[88:91], v[44:47]
    v_lshlrev_b32 v106, 16, v213
    v_and_b32 v107, 0xffff0000, v213
    v_mfma_f32_16x16x32_bf16 v[48:51], a[24:27], v[88:91], v[48:51]
    v_lshlrev_b32 v108, 16, v214
    v_and_b32 v109, 0xffff0000, v214
    v_mfma_f32_16x16x32_bf16 v[48:51], a[32:35], v[92:95], v[48:51]
    v_lshlrev_b32 v110, 16, v215
    s_waitcnt lgkmcnt(1)
    v_mfma_f32_16x16x32_bf16 v[48:51], a[40:43], v[96:99], v[48:51]
    v_and_b32 v111, 0xffff0000, v215
    s_add_u32 m0, s21, 24576
    s_add_u32 s29, s25, 524288
    v_mfma_f32_16x16x32_bf16 v[52:55], a[44:47], v[96:99], v[52:55]
    buffer_load_dwordx4 v123, s[12:15], s29 offen lds
    v_add_f32 v104, 0x3727c5ac, v104
    v_mfma_f32_16x16x32_bf16 v[52:55], a[36:39], v[92:95], v[52:55]
    v_add_f32 v105, 0x3727c5ac, v105
    v_add_f32 v106, 0x3727c5ac, v106
    v_mfma_f32_16x16x32_bf16 v[52:55], a[28:31], v[88:91], v[52:55]
    ds_read_b128 v[88:91], v126 offset:8704
    v_add_f32 v107, 0x3727c5ac, v107
    v_mfma_f32_16x16x32_bf16 v[56:59], a[24:27], v[92:95], v[56:59]
    v_add_f32 v108, 0x3727c5ac, v108
    s_add_u32 m0, s21, 28672
    s_add_u32 s29, s25, 540672
    v_mfma_f32_16x16x32_bf16 v[56:59], a[32:35], v[96:99], v[56:59]
    buffer_load_dwordx4 v123, s[12:15], s29 offen lds
    s_waitcnt lgkmcnt(1)
    v_mfma_f32_16x16x32_bf16 v[56:59], a[40:43], v[100:103], v[56:59]
    v_add_f32 v109, 0x3727c5ac, v109
    v_add_f32 v110, 0x3727c5ac, v110
    v_mfma_f32_16x16x32_bf16 v[60:63], a[44:47], v[100:103], v[60:63]
    v_add_f32 v111, 0x3727c5ac, v111
    v_cvt_pk_bf16_f32 v240, v104, v105
    v_mfma_f32_16x16x32_bf16 v[60:63], a[36:39], v[96:99], v[60:63]
    v_cvt_pk_bf16_f32 v241, v106, v107
    s_add_u32 m0, s21, 32768
    s_add_u32 s29, s25, 1048576
    v_mfma_f32_16x16x32_bf16 v[60:63], a[28:31], v[92:95], v[60:63]
    ds_read_b128 v[92:95], v126 offset:10752
    buffer_load_dwordx4 v123, s[12:15], s29 offen lds
    v_mfma_f32_16x16x32_bf16 v[64:67], a[24:27], v[96:99], v[64:67]
    v_cvt_pk_bf16_f32 v242, v108, v109
    v_cvt_pk_bf16_f32 v243, v110, v111
    v_mfma_f32_16x16x32_bf16 v[64:67], a[32:35], v[100:103], v[64:67]
    v_lshlrev_b32 v104, 16, v240
    s_waitcnt lgkmcnt(1)
    v_mfma_f32_16x16x32_bf16 v[64:67], a[40:43], v[88:91], v[64:67]
    v_and_b32 v105, 0xffff0000, v240
    s_add_u32 m0, s21, 36864
    s_add_u32 s29, s25, 1064960
    v_mfma_f32_16x16x32_bf16 v[68:71], a[44:47], v[88:91], v[68:71]
    buffer_load_dwordx4 v123, s[12:15], s29 offen lds
    v_mfma_f32_16x16x32_bf16 v[68:71], a[36:39], v[100:103], v[68:71]
    v_mfma_f32_16x16x32_bf16 v[68:71], a[28:31], v[96:99], v[68:71]
    ds_read_b128 v[96:99], v126 offset:12800
    v_mfma_f32_16x16x32_bf16 v[72:75], a[24:27], v[100:103], v[72:75]
    s_waitcnt vmcnt(16)
    s_barrier
    v_mfma_f32_16x16x32_bf16 v[72:75], a[32:35], v[88:91], v[72:75]
    ds_read_b64_tr_b16 a[48:49], v121 offset:0
    s_waitcnt lgkmcnt(2)
    v_mfma_f32_16x16x32_bf16 v[72:75], a[40:43], v[92:95], v[72:75]
    ds_read_b64_tr_b16 a[50:51], v121 offset:1024
    s_add_u32 m0, s21, 40960
    s_add_u32 s29, s25, 32768
    v_mfma_f32_16x16x32_bf16 v[76:79], a[44:47], v[92:95], v[76:79]
    buffer_load_dwordx4 v123, s[12:15], s29 offen lds
    ds_read_b64_tr_b16 a[52:53], v122 offset:0
    v_mfma_f32_16x16x32_bf16 v[76:79], a[36:39], v[88:91], v[76:79]
    ds_read_b64_tr_b16 a[54:55], v122 offset:1024
    v_mfma_f32_16x16x32_bf16 v[76:79], a[28:31], v[100:103], v[76:79]
    ds_read_b128 v[100:103], v126 offset:14848
    ds_read_b64_tr_b16 a[56:57], v121 offset:8192
    v_mfma_f32_16x16x32_bf16 v[80:83], a[24:27], v[88:91], v[80:83]
    ds_read_b64_tr_b16 a[58:59], v121 offset:9216
    s_add_u32 m0, s21, 45056
    s_add_u32 s29, s25, 49152
    v_mfma_f32_16x16x32_bf16 v[80:83], a[32:35], v[92:95], v[80:83]
    buffer_load_dwordx4 v123, s[12:15], s29 offen lds
    s_waitcnt lgkmcnt(7)
    v_mfma_f32_16x16x32_bf16 v[80:83], a[40:43], v[96:99], v[80:83]
    ds_read_b64_tr_b16 a[60:61], v122 offset:8192
    v_mfma_f32_16x16x32_bf16 v[84:87], a[44:47], v[96:99], v[84:87]
    ds_read_b64_tr_b16 a[62:63], v122 offset:9216
    v_mfma_f32_16x16x32_bf16 v[84:87], a[36:39], v[92:95], v[84:87]
    ds_read_b64_tr_b16 a[64:65], v121 offset:16384
    s_add_u32 m0, s21, 49152
    s_add_u32 s29, s25, 557056
    v_mfma_f32_16x16x32_bf16 v[84:87], a[28:31], v[88:91], v[84:87]
    ds_read_b128 v[88:91], v120 offset:0
    buffer_load_dwordx4 v123, s[12:15], s29 offen lds
    v_mfma_f32_16x16x32_bf16 v[24:27], a[24:27], v[92:95], v[24:27]
    ds_read_b64_tr_b16 a[66:67], v121 offset:17408
    v_mfma_f32_16x16x32_bf16 v[24:27], a[32:35], v[96:99], v[24:27]
    ds_read_b64_tr_b16 a[68:69], v122 offset:16384
    s_waitcnt lgkmcnt(8)
    v_mfma_f32_16x16x32_bf16 v[24:27], a[40:43], v[100:103], v[24:27]
    ds_read_b64_tr_b16 a[70:71], v122 offset:17408
    s_add_u32 m0, s21, 53248
    s_add_u32 s29, s25, 573440
    v_mfma_f32_16x16x32_bf16 v[28:31], a[44:47], v[100:103], v[28:31]
    buffer_load_dwordx4 v123, s[12:15], s29 offen lds
    v_mfma_f32_16x16x32_bf16 v[28:31], a[36:39], v[96:99], v[28:31]
    v_mfma_f32_16x16x32_bf16 v[28:31], a[28:31], v[92:95], v[28:31]
    ds_read_b128 v[92:95], v120 offset:2048
    v_mfma_f32_16x16x32_bf16 v[32:35], a[24:27], v[96:99], v[32:35]
    s_add_u32 m0, s21, 57344
    s_add_u32 s29, s25, 1081344
    v_mfma_f32_16x16x32_bf16 v[32:35], a[32:35], v[100:103], v[32:35]
    buffer_load_dwordx4 v123, s[12:15], s29 offen lds
    v_mfma_f32_16x16x32_bf16 v[36:39], a[36:39], v[100:103], v[36:39]
    v_mfma_f32_16x16x32_bf16 v[36:39], a[28:31], v[96:99], v[36:39]
    ds_read_b128 v[96:99], v120 offset:4096
    s_waitcnt lgkmcnt(2)
    v_mfma_f32_16x16x32_bf16 v[8:11], a[24:27], v[100:103], v[8:11]
    s_add_u32 m0, s21, 61440
    s_add_u32 s29, s25, 1097728
    v_mfma_f32_16x16x32_bf16 v[12:15], a[28:31], v[100:103], v[12:15]
    ds_read_b128 v[100:103], v120 offset:6144
    v_mfma_f32_16x16x32_bf16 v[40:43], a[56:59], v[88:91], v[40:43]
    buffer_load_dwordx4 v123, s[12:15], s29 offen lds
    s_waitcnt lgkmcnt(2)
    v_mfma_f32_16x16x32_bf16 v[40:43], a[64:67], v[92:95], v[40:43]
    v_lshlrev_b32 v106, 16, v241
    v_and_b32 v107, 0xffff0000, v241
    v_mfma_f32_16x16x32_bf16 v[44:47], a[68:71], v[92:95], v[44:47]
    v_lshlrev_b32 v108, 16, v242
    v_and_b32 v109, 0xffff0000, v242
    v_mfma_f32_16x16x32_bf16 v[44:47], a[60:63], v[88:91], v[44:47]
    v_lshlrev_b32 v110, 16, v243
    s_add_u32 m0, s26, 98304
    s_add_u32 s29, s33, 128
    v_mfma_f32_16x16x32_bf16 v[48:51], a[48:51], v[88:91], v[48:51]
    buffer_load_dwordx4 v127, s[8:11], s29 offen lds
    v_and_b32 v111, 0xffff0000, v243
    v_mfma_f32_16x16x32_bf16 v[48:51], a[56:59], v[92:95], v[48:51]
    v_sqrt_f32 v104, v104
    s_waitcnt lgkmcnt(1)
    v_mfma_f32_16x16x32_bf16 v[48:51], a[64:67], v[96:99], v[48:51]
    v_sqrt_f32 v105, v105
    v_mfma_f32_16x16x32_bf16 v[52:55], a[68:71], v[96:99], v[52:55]
    v_sqrt_f32 v106, v106
    s_add_u32 m0, s26, 100352
    s_add_u32 s29, s33, 1152
    v_mfma_f32_16x16x32_bf16 v[52:55], a[60:63], v[92:95], v[52:55]
    buffer_load_dwordx4 v127, s[8:11], s29 offen lds
    v_sqrt_f32 v107, v107
    v_mfma_f32_16x16x32_bf16 v[52:55], a[52:55], v[88:91], v[52:55]
    ds_read_b128 v[88:91], v120 offset:8192
    v_sqrt_f32 v108, v108
    v_mfma_f32_16x16x32_bf16 v[56:59], a[48:51], v[92:95], v[56:59]
    v_sqrt_f32 v109, v109
    v_mfma_f32_16x16x32_bf16 v[56:59], a[56:59], v[96:99], v[56:59]
    v_sqrt_f32 v110, v110
    s_waitcnt lgkmcnt(1)
    v_mfma_f32_16x16x32_bf16 v[56:59], a[64:67], v[100:103], v[56:59]
    v_sqrt_f32 v111, v111
    s_add_u32 m0, s26, 102400
    s_add_u32 s29, s33, 2176
    v_mfma_f32_16x16x32_bf16 v[60:63], a[68:71], v[100:103], v[60:63]
    buffer_load_dwordx4 v127, s[8:11], s29 offen lds
    v_lshlrev_b32 v232, 16, v216
    v_mfma_f32_16x16x32_bf16 v[60:63], a[60:63], v[96:99], v[60:63]
    v_and_b32 v233, 0xffff0000, v216
    v_lshlrev_b32 v234, 16, v217
    v_mfma_f32_16x16x32_bf16 v[60:63], a[52:55], v[92:95], v[60:63]
    ds_read_b128 v[92:95], v120 offset:10240
    v_and_b32 v235, 0xffff0000, v217
    v_mfma_f32_16x16x32_bf16 v[64:67], a[48:51], v[96:99], v[64:67]
    v_lshlrev_b32 v236, 16, v218
    s_add_u32 m0, s26, 104448
    s_add_u32 s29, s33, 3200
    v_mfma_f32_16x16x32_bf16 v[64:67], a[56:59], v[100:103], v[64:67]
    buffer_load_dwordx4 v127, s[8:11], s29 offen lds
    s_waitcnt lgkmcnt(1)
    v_mfma_f32_16x16x32_bf16 v[64:67], a[64:67], v[88:91], v[64:67]
    v_and_b32 v237, 0xffff0000, v218
    v_lshlrev_b32 v238, 16, v219
    v_mfma_f32_16x16x32_bf16 v[68:71], a[68:71], v[88:91], v[68:71]
    v_and_b32 v239, 0xffff0000, v219
    v_cvt_pk_bf16_f32 v240, v104, v105
    v_mfma_f32_16x16x32_bf16 v[68:71], a[60:63], v[100:103], v[68:71]
    v_mfma_f32_16x16x32_bf16 v[68:71], a[52:55], v[96:99], v[68:71]
    ds_read_b128 v[96:99], v120 offset:12288
    v_mfma_f32_16x16x32_bf16 v[72:75], a[48:51], v[100:103], v[72:75]
    s_waitcnt vmcnt(20)
    s_barrier
    v_mfma_f32_16x16x32_bf16 v[72:75], a[56:59], v[88:91], v[72:75]
    ds_read_b64_tr_b16 a[72:73], v121 offset:24576
    s_waitcnt lgkmcnt(2)
    v_mfma_f32_16x16x32_bf16 v[72:75], a[64:67], v[92:95], v[72:75]
    ds_read_b64_tr_b16 a[74:75], v121 offset:25600
    s_add_u32 m0, s21, 114688
    s_add_u32 s29, s25, 65536
    v_mfma_f32_16x16x32_bf16 v[76:79], a[68:71], v[92:95], v[76:79]
    buffer_load_dwordx4 v123, s[12:15], s29 offen lds
    ds_read_b64_tr_b16 a[76:77], v122 offset:24576
    v_mfma_f32_16x16x32_bf16 v[76:79], a[60:63], v[88:91], v[76:79]
    ds_read_b64_tr_b16 a[78:79], v122 offset:25600
    v_mfma_f32_16x16x32_bf16 v[76:79], a[52:55], v[100:103], v[76:79]
    ds_read_b128 v[100:103], v120 offset:14336
    ds_read_b64_tr_b16 a[80:81], v121 offset:32768
    v_mfma_f32_16x16x32_bf16 v[80:83], a[48:51], v[88:91], v[80:83]
    ds_read_b64_tr_b16 a[82:83], v121 offset:33792
    s_add_u32 m0, s21, 118784
    s_add_u32 s29, s25, 81920
    v_mfma_f32_16x16x32_bf16 v[80:83], a[56:59], v[92:95], v[80:83]
    buffer_load_dwordx4 v123, s[12:15], s29 offen lds
    s_waitcnt lgkmcnt(7)
    v_mfma_f32_16x16x32_bf16 v[80:83], a[64:67], v[96:99], v[80:83]
    ds_read_b64_tr_b16 a[84:85], v122 offset:32768
    v_mfma_f32_16x16x32_bf16 v[84:87], a[68:71], v[96:99], v[84:87]
    ds_read_b64_tr_b16 a[86:87], v122 offset:33792
    v_mfma_f32_16x16x32_bf16 v[84:87], a[60:63], v[92:95], v[84:87]
    ds_read_b64_tr_b16 a[88:89], v121 offset:40960
    s_add_u32 m0, s21, 122880
    s_add_u32 s29, s25, 589824
    v_mfma_f32_16x16x32_bf16 v[84:87], a[52:55], v[88:91], v[84:87]
    ds_read_b128 v[88:91], v120 offset:512
    buffer_load_dwordx4 v123, s[12:15], s29 offen lds
    v_mfma_f32_16x16x32_bf16 v[24:27], a[48:51], v[92:95], v[24:27]
    ds_read_b64_tr_b16 a[90:91], v121 offset:41984
    v_mfma_f32_16x16x32_bf16 v[24:27], a[56:59], v[96:99], v[24:27]
    ds_read_b64_tr_b16 a[92:93], v122 offset:40960
    s_waitcnt lgkmcnt(8)
    v_mfma_f32_16x16x32_bf16 v[24:27], a[64:67], v[100:103], v[24:27]
    ds_read_b64_tr_b16 a[94:95], v122 offset:41984
    s_add_u32 m0, s21, 126976
    s_add_u32 s29, s25, 606208
    v_mfma_f32_16x16x32_bf16 v[28:31], a[68:71], v[100:103], v[28:31]
    buffer_load_dwordx4 v123, s[12:15], s29 offen lds
    v_mfma_f32_16x16x32_bf16 v[28:31], a[60:63], v[96:99], v[28:31]
    v_mfma_f32_16x16x32_bf16 v[28:31], a[52:55], v[92:95], v[28:31]
    ds_read_b128 v[92:95], v120 offset:2560
    v_mfma_f32_16x16x32_bf16 v[32:35], a[48:51], v[96:99], v[32:35]
    s_add_u32 m0, s21, 131072
    s_add_u32 s29, s25, 1114112
    v_mfma_f32_16x16x32_bf16 v[32:35], a[56:59], v[100:103], v[32:35]
    buffer_load_dwordx4 v123, s[12:15], s29 offen lds
    v_mfma_f32_16x16x32_bf16 v[36:39], a[60:63], v[100:103], v[36:39]
    v_mfma_f32_16x16x32_bf16 v[36:39], a[52:55], v[96:99], v[36:39]
    ds_read_b128 v[96:99], v120 offset:4608
    s_waitcnt lgkmcnt(2)
    v_mfma_f32_16x16x32_bf16 v[8:11], a[48:51], v[100:103], v[8:11]
    s_add_u32 m0, s21, 135168
    s_add_u32 s29, s25, 1130496
    v_mfma_f32_16x16x32_bf16 v[12:15], a[52:55], v[100:103], v[12:15]
    ds_read_b128 v[100:103], v120 offset:6656
    v_mfma_f32_16x16x32_bf16 v[40:43], a[80:83], v[88:91], v[40:43]
    buffer_load_dwordx4 v123, s[12:15], s29 offen lds
    s_waitcnt lgkmcnt(2)
    v_mfma_f32_16x16x32_bf16 v[40:43], a[88:91], v[92:95], v[40:43]
    v_cvt_pk_bf16_f32 v241, v106, v107
    v_cvt_pk_bf16_f32 v242, v108, v109
    v_mfma_f32_16x16x32_bf16 v[44:47], a[92:95], v[92:95], v[44:47]
    v_cvt_pk_bf16_f32 v243, v110, v111
    v_lshlrev_b32 v104, 16, v240
    v_mfma_f32_16x16x32_bf16 v[44:47], a[84:87], v[88:91], v[44:47]
    v_and_b32 v105, 0xffff0000, v240
    v_lshlrev_b32 v106, 16, v241
    v_mfma_f32_16x16x32_bf16 v[48:51], a[72:75], v[88:91], v[48:51]
    v_and_b32 v107, 0xffff0000, v241
    v_lshlrev_b32 v108, 16, v242
    v_mfma_f32_16x16x32_bf16 v[48:51], a[80:83], v[92:95], v[48:51]
    v_and_b32 v109, 0xffff0000, v242
    s_waitcnt lgkmcnt(1)
    v_mfma_f32_16x16x32_bf16 v[48:51], a[88:91], v[96:99], v[48:51]
    v_lshlrev_b32 v110, 16, v243
    v_and_b32 v111, 0xffff0000, v243
    v_mfma_f32_16x16x32_bf16 v[52:55], a[92:95], v[96:99], v[52:55]
    v_rcp_f32 v104, v104
    v_mfma_f32_16x16x32_bf16 v[52:55], a[84:87], v[92:95], v[52:55]
    v_rcp_f32 v105, v105
    v_mfma_f32_16x16x32_bf16 v[52:55], a[76:79], v[88:91], v[52:55]
    ds_read_b128 v[88:91], v120 offset:8704
    v_rcp_f32 v106, v106
    v_mfma_f32_16x16x32_bf16 v[56:59], a[72:75], v[92:95], v[56:59]
    v_rcp_f32 v107, v107
    v_mfma_f32_16x16x32_bf16 v[56:59], a[80:83], v[96:99], v[56:59]
    v_rcp_f32 v108, v108
    s_waitcnt lgkmcnt(1)
    v_mfma_f32_16x16x32_bf16 v[56:59], a[88:91], v[100:103], v[56:59]
    v_rcp_f32 v109, v109
    v_mfma_f32_16x16x32_bf16 v[60:63], a[92:95], v[100:103], v[60:63]
    v_rcp_f32 v110, v110
    v_mfma_f32_16x16x32_bf16 v[60:63], a[84:87], v[96:99], v[60:63]
    v_rcp_f32 v111, v111
    v_mfma_f32_16x16x32_bf16 v[60:63], a[76:79], v[92:95], v[60:63]
    ds_read_b128 v[92:95], v120 offset:10752
    v_lshlrev_b32 v224, 16, v208
    v_mfma_f32_16x16x32_bf16 v[64:67], a[72:75], v[96:99], v[64:67]
    v_and_b32 v225, 0xffff0000, v208
    v_lshlrev_b32 v226, 16, v209
    v_mfma_f32_16x16x32_bf16 v[64:67], a[80:83], v[100:103], v[64:67]
    v_and_b32 v227, 0xffff0000, v209
    s_waitcnt lgkmcnt(1)
    v_mfma_f32_16x16x32_bf16 v[64:67], a[88:91], v[88:91], v[64:67]
    v_mfma_f32_16x16x32_bf16 v[68:71], a[92:95], v[88:91], v[68:71]
    v_mfma_f32_16x16x32_bf16 v[68:71], a[84:87], v[100:103], v[68:71]
    v_mfma_f32_16x16x32_bf16 v[68:71], a[76:79], v[96:99], v[68:71]
    ds_read_b128 v[96:99], v120 offset:12800
    v_mfma_f32_16x16x32_bf16 v[72:75], a[72:75], v[100:103], v[72:75]
    s_waitcnt vmcnt(16)
    s_barrier
    v_mfma_f32_16x16x32_bf16 v[72:75], a[80:83], v[88:91], v[72:75]
    ds_read_b64_tr_b16 a[96:97], v124 offset:0
    s_waitcnt lgkmcnt(2)
    v_mfma_f32_16x16x32_bf16 v[72:75], a[88:91], v[92:95], v[72:75]
    ds_read_b64_tr_b16 a[98:99], v124 offset:1024
    s_add_u32 m0, s21, 139264
    s_add_u32 s29, s25, 98304
    v_mfma_f32_16x16x32_bf16 v[76:79], a[92:95], v[92:95], v[76:79]
    buffer_load_dwordx4 v123, s[12:15], s29 offen lds
    ds_read_b64_tr_b16 a[100:101], v125 offset:0
    v_mfma_f32_16x16x32_bf16 v[76:79], a[84:87], v[88:91], v[76:79]
    ds_read_b64_tr_b16 a[102:103], v125 offset:1024
    v_mfma_f32_16x16x32_bf16 v[76:79], a[76:79], v[100:103], v[76:79]
    ds_read_b128 v[100:103], v120 offset:14848
    ds_read_b64_tr_b16 a[104:105], v124 offset:8192
    v_mfma_f32_16x16x32_bf16 v[80:83], a[72:75], v[88:91], v[80:83]
    ds_read_b64_tr_b16 a[106:107], v124 offset:9216
    s_add_u32 m0, s21, 143360
    s_add_u32 s29, s25, 114688
    v_mfma_f32_16x16x32_bf16 v[80:83], a[80:83], v[92:95], v[80:83]
    buffer_load_dwordx4 v123, s[12:15], s29 offen lds
    s_waitcnt lgkmcnt(7)
    v_mfma_f32_16x16x32_bf16 v[80:83], a[88:91], v[96:99], v[80:83]
    ds_read_b64_tr_b16 a[108:109], v125 offset:8192
    v_mfma_f32_16x16x32_bf16 v[84:87], a[92:95], v[96:99], v[84:87]
    ds_read_b64_tr_b16 a[110:111], v125 offset:9216
    v_mfma_f32_16x16x32_bf16 v[84:87], a[84:87], v[92:95], v[84:87]
    ds_read_b64_tr_b16 a[112:113], v124 offset:16384
    s_add_u32 m0, s21, 147456
    s_add_u32 s29, s25, 622592
    v_mfma_f32_16x16x32_bf16 v[84:87], a[76:79], v[88:91], v[84:87]
    ds_read_b128 v[88:91], v120 offset:16384
    buffer_load_dwordx4 v123, s[12:15], s29 offen lds
    v_mfma_f32_16x16x32_bf16 v[24:27], a[72:75], v[92:95], v[24:27]
    ds_read_b64_tr_b16 a[114:115], v124 offset:17408
    v_mfma_f32_16x16x32_bf16 v[24:27], a[80:83], v[96:99], v[24:27]
    ds_read_b64_tr_b16 a[116:117], v125 offset:16384
    s_waitcnt lgkmcnt(8)
    v_mfma_f32_16x16x32_bf16 v[24:27], a[88:91], v[100:103], v[24:27]
    ds_read_b64_tr_b16 a[118:119], v125 offset:17408
    s_add_u32 m0, s21, 151552
    s_add_u32 s29, s25, 638976
    v_mfma_f32_16x16x32_bf16 v[28:31], a[92:95], v[100:103], v[28:31]
    buffer_load_dwordx4 v123, s[12:15], s29 offen lds
    v_mfma_f32_16x16x32_bf16 v[28:31], a[84:87], v[96:99], v[28:31]
    v_mfma_f32_16x16x32_bf16 v[28:31], a[76:79], v[92:95], v[28:31]
    ds_read_b128 v[92:95], v120 offset:18432
    v_mfma_f32_16x16x32_bf16 v[32:35], a[72:75], v[96:99], v[32:35]
    s_add_u32 m0, s21, 155648
    s_add_u32 s29, s25, 1146880
    v_mfma_f32_16x16x32_bf16 v[32:35], a[80:83], v[100:103], v[32:35]
    buffer_load_dwordx4 v123, s[12:15], s29 offen lds
    v_mfma_f32_16x16x32_bf16 v[36:39], a[84:87], v[100:103], v[36:39]
    v_mfma_f32_16x16x32_bf16 v[36:39], a[76:79], v[96:99], v[36:39]
    ds_read_b128 v[96:99], v120 offset:20480
    s_waitcnt lgkmcnt(2)
    v_mfma_f32_16x16x32_bf16 v[8:11], a[72:75], v[100:103], v[8:11]
    s_add_u32 m0, s21, 159744
    s_add_u32 s29, s25, 1163264
    v_mfma_f32_16x16x32_bf16 v[12:15], a[76:79], v[100:103], v[12:15]
    ds_read_b128 v[100:103], v120 offset:22528
    v_mfma_f32_16x16x32_bf16 v[40:43], a[104:107], v[88:91], v[40:43]
    buffer_load_dwordx4 v123, s[12:15], s29 offen lds
    s_waitcnt lgkmcnt(2)
    v_mfma_f32_16x16x32_bf16 v[40:43], a[112:115], v[92:95], v[40:43]
    v_lshlrev_b32 v228, 16, v210
    v_and_b32 v229, 0xffff0000, v210
    v_mfma_f32_16x16x32_bf16 v[44:47], a[116:119], v[92:95], v[44:47]
    v_lshlrev_b32 v230, 16, v211
    v_and_b32 v231, 0xffff0000, v211
    v_mfma_f32_16x16x32_bf16 v[44:47], a[108:111], v[88:91], v[44:47]
    v_cvt_pk_bf16_f32 v240, v104, v105
    s_add_u32 m0, s26, 0
    s_add_u32 s29, s34, 0
    v_mfma_f32_16x16x32_bf16 v[48:51], a[96:99], v[88:91], v[48:51]
    buffer_load_dwordx4 v127, s[8:11], s29 offen lds
    v_cvt_pk_bf16_f32 v241, v106, v107
    v_mfma_f32_16x16x32_bf16 v[48:51], a[104:107], v[92:95], v[48:51]
    v_cvt_pk_bf16_f32 v242, v108, v109
    s_waitcnt lgkmcnt(1)
    v_mfma_f32_16x16x32_bf16 v[48:51], a[112:115], v[96:99], v[48:51]
    v_cvt_pk_bf16_f32 v243, v110, v111
    v_lshlrev_b32 v104, 16, v240
    v_mfma_f32_16x16x32_bf16 v[52:55], a[116:119], v[96:99], v[52:55]
    v_and_b32 v105, 0xffff0000, v240
    s_add_u32 m0, s26, 2048
    s_add_u32 s29, s34, 1024
    v_mfma_f32_16x16x32_bf16 v[52:55], a[108:111], v[92:95], v[52:55]
    buffer_load_dwordx4 v127, s[8:11], s29 offen lds
    v_lshlrev_b32 v106, 16, v241
    v_mfma_f32_16x16x32_bf16 v[52:55], a[100:103], v[88:91], v[52:55]
    ds_read_b128 v[88:91], v120 offset:24576
    v_and_b32 v107, 0xffff0000, v241
    v_mfma_f32_16x16x32_bf16 v[56:59], a[96:99], v[92:95], v[56:59]
    v_lshlrev_b32 v108, 16, v242
    v_and_b32 v109, 0xffff0000, v242
    v_mfma_f32_16x16x32_bf16 v[56:59], a[104:107], v[96:99], v[56:59]
    v_lshlrev_b32 v110, 16, v243
    s_waitcnt lgkmcnt(1)
    v_mfma_f32_16x16x32_bf16 v[56:59], a[112:115], v[100:103], v[56:59]
    v_and_b32 v111, 0xffff0000, v243
    s_add_u32 m0, s26, 4096
    s_add_u32 s29, s34, 2048
    v_mfma_f32_16x16x32_bf16 v[60:63], a[116:119], v[100:103], v[60:63]
    buffer_load_dwordx4 v127, s[8:11], s29 offen lds
    v_mul_f32 v104, v104, v232
    v_mfma_f32_16x16x32_bf16 v[60:63], a[108:111], v[96:99], v[60:63]
    v_mul_f32 v105, v105, v233
    v_mul_f32 v106, v106, v234
    v_mfma_f32_16x16x32_bf16 v[60:63], a[100:103], v[92:95], v[60:63]
    ds_read_b128 v[92:95], v120 offset:26624
    v_mul_f32 v107, v107, v235
    v_mfma_f32_16x16x32_bf16 v[64:67], a[96:99], v[96:99], v[64:67]
    v_mul_f32 v108, v108, v236
    s_add_u32 m0, s26, 6144
    s_add_u32 s29, s34, 3072
    v_mfma_f32_16x16x32_bf16 v[64:67], a[104:107], v[100:103], v[64:67]
    buffer_load_dwordx4 v127, s[8:11], s29 offen lds
    s_waitcnt lgkmcnt(1)
    v_mfma_f32_16x16x32_bf16 v[64:67], a[112:115], v[88:91], v[64:67]
    v_mul_f32 v109, v109, v237
    v_mul_f32 v110, v110, v238
    v_mfma_f32_16x16x32_bf16 v[68:71], a[116:119], v[88:91], v[68:71]
    v_mfma_f32_16x16x32_bf16 v[68:71], a[108:111], v[100:103], v[68:71]
    v_mfma_f32_16x16x32_bf16 v[68:71], a[100:103], v[96:99], v[68:71]
    ds_read_b128 v[96:99], v120 offset:28672
    v_mfma_f32_16x16x32_bf16 v[72:75], a[96:99], v[100:103], v[72:75]
    s_waitcnt vmcnt(20)
    s_barrier
    v_mfma_f32_16x16x32_bf16 v[72:75], a[104:107], v[88:91], v[72:75]
    ds_read_b64_tr_b16 a[120:121], v124 offset:24576
    s_waitcnt lgkmcnt(2)
    v_mfma_f32_16x16x32_bf16 v[72:75], a[112:115], v[92:95], v[72:75]
    ds_read_b64_tr_b16 a[122:123], v124 offset:25600
    s_add_u32 m0, s21, 16384
    s_add_u32 s29, s30, 0
    v_mfma_f32_16x16x32_bf16 v[76:79], a[116:119], v[92:95], v[76:79]
    buffer_load_dwordx4 v123, s[12:15], s29 offen lds
    ds_read_b64_tr_b16 a[124:125], v125 offset:24576
    v_mfma_f32_16x16x32_bf16 v[76:79], a[108:111], v[88:91], v[76:79]
    ds_read_b64_tr_b16 a[126:127], v125 offset:25600
    v_mfma_f32_16x16x32_bf16 v[76:79], a[100:103], v[100:103], v[76:79]
    ds_read_b128 v[100:103], v120 offset:30720
    ds_read_b64_tr_b16 a[128:129], v124 offset:32768
    v_mfma_f32_16x16x32_bf16 v[80:83], a[96:99], v[88:91], v[80:83]
    ds_read_b64_tr_b16 a[130:131], v124 offset:33792
    s_add_u32 m0, s21, 20480
    s_add_u32 s29, s30, 16384
    v_mfma_f32_16x16x32_bf16 v[80:83], a[104:107], v[92:95], v[80:83]
    buffer_load_dwordx4 v123, s[12:15], s29 offen lds
    s_waitcnt lgkmcnt(7)
    v_mfma_f32_16x16x32_bf16 v[80:83], a[112:115], v[96:99], v[80:83]
    ds_read_b64_tr_b16 a[132:133], v125 offset:32768
    v_mfma_f32_16x16x32_bf16 v[84:87], a[116:119], v[96:99], v[84:87]
    ds_read_b64_tr_b16 a[134:135], v125 offset:33792
    v_mfma_f32_16x16x32_bf16 v[84:87], a[108:111], v[92:95], v[84:87]
    ds_read_b64_tr_b16 a[136:137], v124 offset:40960
    s_add_u32 m0, s21, 24576
    s_add_u32 s29, s30, 524288
    v_mfma_f32_16x16x32_bf16 v[84:87], a[100:103], v[88:91], v[84:87]
    ds_read_b128 v[88:91], v120 offset:16896
    buffer_load_dwordx4 v123, s[12:15], s29 offen lds
    v_mfma_f32_16x16x32_bf16 v[24:27], a[96:99], v[92:95], v[24:27]
    ds_read_b64_tr_b16 a[138:139], v124 offset:41984
    v_mfma_f32_16x16x32_bf16 v[24:27], a[104:107], v[96:99], v[24:27]
    ds_read_b64_tr_b16 a[140:141], v125 offset:40960
    s_waitcnt lgkmcnt(8)
    v_mfma_f32_16x16x32_bf16 v[24:27], a[112:115], v[100:103], v[24:27]
    ds_read_b64_tr_b16 a[142:143], v125 offset:41984
    s_add_u32 m0, s21, 28672
    s_add_u32 s29, s30, 540672
    v_mfma_f32_16x16x32_bf16 v[28:31], a[116:119], v[100:103], v[28:31]
    buffer_load_dwordx4 v123, s[12:15], s29 offen lds
    v_mfma_f32_16x16x32_bf16 v[28:31], a[108:111], v[96:99], v[28:31]
    v_mfma_f32_16x16x32_bf16 v[28:31], a[100:103], v[92:95], v[28:31]
    ds_read_b128 v[92:95], v120 offset:18944
    v_mfma_f32_16x16x32_bf16 v[32:35], a[96:99], v[96:99], v[32:35]
    s_add_u32 m0, s21, 32768
    s_add_u32 s29, s30, 1048576
    v_mfma_f32_16x16x32_bf16 v[32:35], a[104:107], v[100:103], v[32:35]
    buffer_load_dwordx4 v123, s[12:15], s29 offen lds
    v_mfma_f32_16x16x32_bf16 v[36:39], a[108:111], v[100:103], v[36:39]
    v_mfma_f32_16x16x32_bf16 v[36:39], a[100:103], v[96:99], v[36:39]
    ds_read_b128 v[96:99], v120 offset:20992
    s_waitcnt lgkmcnt(2)
    v_mfma_f32_16x16x32_bf16 v[8:11], a[96:99], v[100:103], v[8:11]
    s_add_u32 m0, s21, 36864
    s_add_u32 s29, s30, 1064960
    v_mfma_f32_16x16x32_bf16 v[12:15], a[100:103], v[100:103], v[12:15]
    ds_read_b128 v[100:103], v120 offset:23040
    v_mfma_f32_16x16x32_bf16 v[40:43], a[128:131], v[88:91], v[40:43]
    buffer_load_dwordx4 v123, s[12:15], s29 offen lds
    s_waitcnt lgkmcnt(2)
    v_mfma_f32_16x16x32_bf16 v[40:43], a[136:139], v[92:95], v[40:43]
    v_mul_f32 v111, v111, v239
    v_lshlrev_b32 v112, 16, v220
    v_mfma_f32_16x16x32_bf16 v[44:47], a[140:143], v[92:95], v[44:47]
    v_and_b32 v113, 0xffff0000, v220
    v_lshlrev_b32 v114, 16, v221
    v_mfma_f32_16x16x32_bf16 v[44:47], a[132:135], v[88:91], v[44:47]
    v_and_b32 v115, 0xffff0000, v221
    v_lshlrev_b32 v116, 16, v222
    v_mfma_f32_16x16x32_bf16 v[48:51], a[120:123], v[88:91], v[48:51]
    v_and_b32 v117, 0xffff0000, v222
    v_lshlrev_b32 v118, 16, v223
    v_mfma_f32_16x16x32_bf16 v[48:51], a[128:131], v[92:95], v[48:51]
    v_and_b32 v119, 0xffff0000, v223
    s_waitcnt lgkmcnt(1)
    v_mfma_f32_16x16x32_bf16 v[48:51], a[136:139], v[96:99], v[48:51]
    v_cvt_pk_bf16_f32 v240, v104, v105
    v_cvt_pk_bf16_f32 v241, v106, v107
    v_mfma_f32_16x16x32_bf16 v[52:55], a[140:143], v[96:99], v[52:55]
    v_cvt_pk_bf16_f32 v242, v108, v109
    v_cvt_pk_bf16_f32 v243, v110, v111
    v_mfma_f32_16x16x32_bf16 v[52:55], a[132:135], v[92:95], v[52:55]
    v_lshlrev_b32 v104, 16, v240
    v_and_b32 v105, 0xffff0000, v240
    v_mfma_f32_16x16x32_bf16 v[52:55], a[124:127], v[88:91], v[52:55]
    ds_read_b128 v[88:91], v120 offset:25088
    v_lshlrev_b32 v106, 16, v241
    v_mfma_f32_16x16x32_bf16 v[56:59], a[120:123], v[92:95], v[56:59]
    v_and_b32 v107, 0xffff0000, v241
    v_lshlrev_b32 v108, 16, v242
    v_mfma_f32_16x16x32_bf16 v[56:59], a[128:131], v[96:99], v[56:59]
    v_and_b32 v109, 0xffff0000, v242
    s_waitcnt lgkmcnt(1)
    v_mfma_f32_16x16x32_bf16 v[56:59], a[136:139], v[100:103], v[56:59]
    v_lshlrev_b32 v110, 16, v243
    v_and_b32 v111, 0xffff0000, v243
    v_mfma_f32_16x16x32_bf16 v[60:63], a[140:143], v[100:103], v[60:63]
    v_fma_f32 v112, -v224, v104, v112
    v_fma_f32 v113, -v225, v105, v113
    v_mfma_f32_16x16x32_bf16 v[60:63], a[132:135], v[96:99], v[60:63]
    v_mfma_f32_16x16x32_bf16 v[60:63], a[124:127], v[92:95], v[60:63]
    ds_read_b128 v[92:95], v120 offset:27136
    v_mfma_f32_16x16x32_bf16 v[64:67], a[120:123], v[96:99], v[64:67]
    v_mfma_f32_16x16x32_bf16 v[64:67], a[128:131], v[100:103], v[64:67]
    s_waitcnt lgkmcnt(1)
    v_mfma_f32_16x16x32_bf16 v[64:67], a[136:139], v[88:91], v[64:67]
    v_mfma_f32_16x16x32_bf16 v[68:71], a[140:143], v[88:91], v[68:71]
    v_mfma_f32_16x16x32_bf16 v[68:71], a[132:135], v[100:103], v[68:71]
    v_mfma_f32_16x16x32_bf16 v[68:71], a[124:127], v[96:99], v[68:71]
    ds_read_b128 v[96:99], v120 offset:29184
    v_mfma_f32_16x16x32_bf16 v[72:75], a[120:123], v[100:103], v[72:75]
    s_waitcnt vmcnt(16)
    s_barrier
    v_mfma_f32_16x16x32_bf16 v[72:75], a[128:131], v[88:91], v[72:75]
    ds_read_b64_tr_b16 a[144:145], v121 offset:0
    s_waitcnt lgkmcnt(2)
    v_mfma_f32_16x16x32_bf16 v[72:75], a[136:139], v[92:95], v[72:75]
    ds_read_b64_tr_b16 a[146:147], v121 offset:1024
    s_add_u32 m0, s21, 40960
    s_add_u32 s29, s30, 32768
    v_mfma_f32_16x16x32_bf16 v[76:79], a[140:143], v[92:95], v[76:79]
    buffer_load_dwordx4 v123, s[12:15], s29 offen lds
    ds_read_b64_tr_b16 a[148:149], v122 offset:0
    v_mfma_f32_16x16x32_bf16 v[76:79], a[132:135], v[88:91], v[76:79]
    ds_read_b64_tr_b16 a[150:151], v122 offset:1024
    v_mfma_f32_16x16x32_bf16 v[76:79], a[124:127], v[100:103], v[76:79]
    ds_read_b128 v[100:103], v120 offset:31232
    ds_read_b64_tr_b16 a[152:153], v121 offset:8192
    v_mfma_f32_16x16x32_bf16 v[80:83], a[120:123], v[88:91], v[80:83]
    ds_read_b64_tr_b16 a[154:155], v121 offset:9216
    s_add_u32 m0, s21, 45056
    s_add_u32 s29, s30, 49152
    v_mfma_f32_16x16x32_bf16 v[80:83], a[128:131], v[92:95], v[80:83]
    buffer_load_dwordx4 v123, s[12:15], s29 offen lds
    s_waitcnt lgkmcnt(7)
    v_mfma_f32_16x16x32_bf16 v[80:83], a[136:139], v[96:99], v[80:83]
    ds_read_b64_tr_b16 a[156:157], v122 offset:8192
    v_mfma_f32_16x16x32_bf16 v[84:87], a[140:143], v[96:99], v[84:87]
    ds_read_b64_tr_b16 a[158:159], v122 offset:9216
    v_mfma_f32_16x16x32_bf16 v[84:87], a[132:135], v[92:95], v[84:87]
    ds_read_b64_tr_b16 a[160:161], v121 offset:16384
    s_add_u32 m0, s21, 49152
    s_add_u32 s29, s30, 557056
    v_mfma_f32_16x16x32_bf16 v[84:87], a[124:127], v[88:91], v[84:87]
    ds_read_b128 v[88:91], v120 offset:32768
    buffer_load_dwordx4 v123, s[12:15], s29 offen lds
    v_mfma_f32_16x16x32_bf16 v[24:27], a[120:123], v[92:95], v[24:27]
    ds_read_b64_tr_b16 a[162:163], v121 offset:17408
    v_mfma_f32_16x16x32_bf16 v[24:27], a[128:131], v[96:99], v[24:27]
    ds_read_b64_tr_b16 a[164:165], v122 offset:16384
    s_waitcnt lgkmcnt(8)
    v_mfma_f32_16x16x32_bf16 v[24:27], a[136:139], v[100:103], v[24:27]
    ds_read_b64_tr_b16 a[166:167], v122 offset:17408
    s_add_u32 m0, s21, 53248
    s_add_u32 s29, s30, 573440
    v_mfma_f32_16x16x32_bf16 v[28:31], a[140:143], v[100:103], v[28:31]
    buffer_load_dwordx4 v123, s[12:15], s29 offen lds
    v_mfma_f32_16x16x32_bf16 v[28:31], a[132:135], v[96:99], v[28:31]
    v_mfma_f32_16x16x32_bf16 v[28:31], a[124:127], v[92:95], v[28:31]
    ds_read_b128 v[92:95], v120 offset:34816
    v_mfma_f32_16x16x32_bf16 v[32:35], a[120:123], v[96:99], v[32:35]
    s_add_u32 m0, s21, 57344
    s_add_u32 s29, s30, 1081344
    v_mfma_f32_16x16x32_bf16 v[32:35], a[128:131], v[100:103], v[32:35]
    buffer_load_dwordx4 v123, s[12:15], s29 offen lds
    v_mfma_f32_16x16x32_bf16 v[36:39], a[132:135], v[100:103], v[36:39]
    v_mfma_f32_16x16x32_bf16 v[36:39], a[124:127], v[96:99], v[36:39]
    ds_read_b128 v[96:99], v120 offset:36864
    s_waitcnt lgkmcnt(2)
    v_mfma_f32_16x16x32_bf16 v[8:11], a[120:123], v[100:103], v[8:11]
    s_add_u32 m0, s21, 61440
    s_add_u32 s29, s30, 1097728
    v_mfma_f32_16x16x32_bf16 v[12:15], a[124:127], v[100:103], v[12:15]
    ds_read_b128 v[100:103], v120 offset:38912
    v_mfma_f32_16x16x32_bf16 v[40:43], a[152:155], v[88:91], v[40:43]
    buffer_load_dwordx4 v123, s[12:15], s29 offen lds
    s_waitcnt lgkmcnt(2)
    v_mfma_f32_16x16x32_bf16 v[40:43], a[160:163], v[92:95], v[40:43]
    v_fma_f32 v114, -v226, v106, v114
    v_fma_f32 v115, -v227, v107, v115
    v_mfma_f32_16x16x32_bf16 v[44:47], a[164:167], v[92:95], v[44:47]
    v_fma_f32 v116, -v228, v108, v116
    v_fma_f32 v117, -v229, v109, v117
    v_mfma_f32_16x16x32_bf16 v[44:47], a[156:159], v[88:91], v[44:47]
    v_fma_f32 v118, -v230, v110, v118
    s_add_u32 m0, s26, 65536
    s_add_u32 s29, s34, 128
    v_mfma_f32_16x16x32_bf16 v[48:51], a[144:147], v[88:91], v[48:51]
    buffer_load_dwordx4 v127, s[8:11], s29 offen lds
    v_fma_f32 v119, -v231, v111, v119
    v_mfma_f32_16x16x32_bf16 v[48:51], a[152:155], v[92:95], v[48:51]
    v_mul_f32 v104, s28, v104
    s_waitcnt lgkmcnt(1)
    v_mfma_f32_16x16x32_bf16 v[48:51], a[160:163], v[96:99], v[48:51]
    v_mul_f32 v105, s28, v105
    v_mul_f32 v106, s28, v106
    v_mfma_f32_16x16x32_bf16 v[52:55], a[164:167], v[96:99], v[52:55]
    v_mul_f32 v107, s28, v107
    s_add_u32 m0, s26, 67584
    s_add_u32 s29, s34, 1152
    v_mfma_f32_16x16x32_bf16 v[52:55], a[156:159], v[92:95], v[52:55]
    buffer_load_dwordx4 v127, s[8:11], s29 offen lds
    v_mul_f32 v108, s28, v108
    v_mfma_f32_16x16x32_bf16 v[52:55], a[148:151], v[88:91], v[52:55]
    ds_read_b128 v[88:91], v120 offset:40960
    v_mul_f32 v109, s28, v109
    v_mfma_f32_16x16x32_bf16 v[56:59], a[144:147], v[92:95], v[56:59]
    v_mul_f32 v110, s28, v110
    v_mul_f32 v111, s28, v111
    v_mfma_f32_16x16x32_bf16 v[56:59], a[152:155], v[96:99], v[56:59]
    v_mul_f32 v112, s28, v112
    s_waitcnt lgkmcnt(1)
    v_mfma_f32_16x16x32_bf16 v[56:59], a[160:163], v[100:103], v[56:59]
    v_mul_f32 v113, s28, v113
    s_add_u32 m0, s26, 69632
    s_add_u32 s29, s34, 2176
    v_mfma_f32_16x16x32_bf16 v[60:63], a[164:167], v[100:103], v[60:63]
    buffer_load_dwordx4 v127, s[8:11], s29 offen lds
    v_mul_f32 v114, s28, v114
    v_mfma_f32_16x16x32_bf16 v[60:63], a[156:159], v[96:99], v[60:63]
    v_mul_f32 v115, s28, v115
    v_mul_f32 v116, s28, v116
    v_mfma_f32_16x16x32_bf16 v[60:63], a[148:151], v[92:95], v[60:63]
    ds_read_b128 v[92:95], v120 offset:43008
    v_mul_f32 v117, s28, v117
    v_mfma_f32_16x16x32_bf16 v[64:67], a[144:147], v[96:99], v[64:67]
    v_mul_f32 v118, s28, v118
    s_add_u32 m0, s26, 71680
    s_add_u32 s29, s34, 3200
    v_mfma_f32_16x16x32_bf16 v[64:67], a[152:155], v[100:103], v[64:67]
    buffer_load_dwordx4 v127, s[8:11], s29 offen lds
    s_waitcnt lgkmcnt(1)
    v_mfma_f32_16x16x32_bf16 v[64:67], a[160:163], v[88:91], v[64:67]
    v_mul_f32 v119, s28, v119
    v_mfma_f32_16x16x32_bf16 v[68:71], a[164:167], v[88:91], v[68:71]
    v_mfma_f32_16x16x32_bf16 v[68:71], a[156:159], v[100:103], v[68:71]
    v_mfma_f32_16x16x32_bf16 v[68:71], a[148:151], v[96:99], v[68:71]
    ds_read_b128 v[96:99], v120 offset:45056
    v_mfma_f32_16x16x32_bf16 v[72:75], a[144:147], v[100:103], v[72:75]
    s_waitcnt vmcnt(20)
    s_barrier
    v_mfma_f32_16x16x32_bf16 v[72:75], a[152:155], v[88:91], v[72:75]
    ds_read_b64_tr_b16 a[168:169], v121 offset:24576
    s_waitcnt lgkmcnt(2)
    v_mfma_f32_16x16x32_bf16 v[72:75], a[160:163], v[92:95], v[72:75]
    ds_read_b64_tr_b16 a[170:171], v121 offset:25600
    s_add_u32 m0, s21, 114688
    s_add_u32 s29, s30, 65536
    v_mfma_f32_16x16x32_bf16 v[76:79], a[164:167], v[92:95], v[76:79]
    buffer_load_dwordx4 v123, s[12:15], s29 offen lds
    ds_read_b64_tr_b16 a[172:173], v122 offset:24576
    v_mfma_f32_16x16x32_bf16 v[76:79], a[156:159], v[88:91], v[76:79]
    ds_read_b64_tr_b16 a[174:175], v122 offset:25600
    v_mfma_f32_16x16x32_bf16 v[76:79], a[148:151], v[100:103], v[76:79]
    ds_read_b128 v[100:103], v120 offset:47104
    ds_read_b64_tr_b16 a[176:177], v121 offset:32768
    v_mfma_f32_16x16x32_bf16 v[80:83], a[144:147], v[88:91], v[80:83]
    ds_read_b64_tr_b16 a[178:179], v121 offset:33792
    s_add_u32 m0, s21, 118784
    s_add_u32 s29, s30, 81920
    v_mfma_f32_16x16x32_bf16 v[80:83], a[152:155], v[92:95], v[80:83]
    buffer_load_dwordx4 v123, s[12:15], s29 offen lds
    s_waitcnt lgkmcnt(7)
    v_mfma_f32_16x16x32_bf16 v[80:83], a[160:163], v[96:99], v[80:83]
    ds_read_b64_tr_b16 a[180:181], v122 offset:32768
    v_mfma_f32_16x16x32_bf16 v[84:87], a[164:167], v[96:99], v[84:87]
    ds_read_b64_tr_b16 a[182:183], v122 offset:33792
    v_mfma_f32_16x16x32_bf16 v[84:87], a[156:159], v[92:95], v[84:87]
    ds_read_b64_tr_b16 a[184:185], v121 offset:40960
    s_add_u32 m0, s21, 122880
    s_add_u32 s29, s30, 589824
    v_mfma_f32_16x16x32_bf16 v[84:87], a[148:151], v[88:91], v[84:87]
    ds_read_b128 v[88:91], v120 offset:33280
    buffer_load_dwordx4 v123, s[12:15], s29 offen lds
    v_mfma_f32_16x16x32_bf16 v[24:27], a[144:147], v[92:95], v[24:27]
    ds_read_b64_tr_b16 a[186:187], v121 offset:41984
    v_mfma_f32_16x16x32_bf16 v[24:27], a[152:155], v[96:99], v[24:27]
    ds_read_b64_tr_b16 a[188:189], v122 offset:40960
    s_waitcnt lgkmcnt(8)
    v_mfma_f32_16x16x32_bf16 v[24:27], a[160:163], v[100:103], v[24:27]
    ds_read_b64_tr_b16 a[190:191], v122 offset:41984
    s_add_u32 m0, s21, 126976
    s_add_u32 s29, s30, 606208
    v_mfma_f32_16x16x32_bf16 v[28:31], a[164:167], v[100:103], v[28:31]
    buffer_load_dwordx4 v123, s[12:15], s29 offen lds
    v_mfma_f32_16x16x32_bf16 v[28:31], a[156:159], v[96:99], v[28:31]
    v_mfma_f32_16x16x32_bf16 v[28:31], a[148:151], v[92:95], v[28:31]
    ds_read_b128 v[92:95], v120 offset:35328
    v_mfma_f32_16x16x32_bf16 v[32:35], a[144:147], v[96:99], v[32:35]
    s_add_u32 m0, s21, 131072
    s_add_u32 s29, s30, 1114112
    v_mfma_f32_16x16x32_bf16 v[32:35], a[152:155], v[100:103], v[32:35]
    buffer_load_dwordx4 v123, s[12:15], s29 offen lds
    v_mfma_f32_16x16x32_bf16 v[36:39], a[156:159], v[100:103], v[36:39]
    v_mfma_f32_16x16x32_bf16 v[36:39], a[148:151], v[96:99], v[36:39]
    ds_read_b128 v[96:99], v120 offset:37376
    s_waitcnt lgkmcnt(2)
    v_mfma_f32_16x16x32_bf16 v[8:11], a[144:147], v[100:103], v[8:11]
    s_add_u32 m0, s21, 135168
    s_add_u32 s29, s30, 1130496
    v_mfma_f32_16x16x32_bf16 v[12:15], a[148:151], v[100:103], v[12:15]
    ds_read_b128 v[100:103], v120 offset:39424
    v_mfma_f32_16x16x32_bf16 v[40:43], a[176:179], v[88:91], v[40:43]
    buffer_load_dwordx4 v123, s[12:15], s29 offen lds
    s_waitcnt lgkmcnt(2)
    v_mfma_f32_16x16x32_bf16 v[40:43], a[184:187], v[92:95], v[40:43]
    v_mfma_f32_16x16x32_bf16 v[44:47], a[188:191], v[92:95], v[44:47]
    v_mfma_f32_16x16x32_bf16 v[44:47], a[180:183], v[88:91], v[44:47]
    s_mov_b32 s29, L_steady-L_pc
    v_mfma_f32_16x16x32_bf16 v[48:51], a[168:171], v[88:91], v[48:51]
    buffer_load_dword v254, v0, s[64:67], s29 offen
    v_mfma_f32_16x16x32_bf16 v[48:51], a[176:179], v[92:95], v[48:51]
    s_waitcnt lgkmcnt(1)
    v_mfma_f32_16x16x32_bf16 v[48:51], a[184:187], v[96:99], v[48:51]
    v_mfma_f32_16x16x32_bf16 v[52:55], a[188:191], v[96:99], v[52:55]
    v_mfma_f32_16x16x32_bf16 v[52:55], a[180:183], v[92:95], v[52:55]
    v_mfma_f32_16x16x32_bf16 v[52:55], a[172:175], v[88:91], v[52:55]
    ds_read_b128 v[88:91], v120 offset:41472
    v_mfma_f32_16x16x32_bf16 v[56:59], a[168:171], v[92:95], v[56:59]
    v_mfma_f32_16x16x32_bf16 v[56:59], a[176:179], v[96:99], v[56:59]
    s_waitcnt lgkmcnt(1)
    v_mfma_f32_16x16x32_bf16 v[56:59], a[184:187], v[100:103], v[56:59]
    v_mfma_f32_16x16x32_bf16 v[60:63], a[188:191], v[100:103], v[60:63]
    v_mfma_f32_16x16x32_bf16 v[60:63], a[180:183], v[96:99], v[60:63]
    v_mfma_f32_16x16x32_bf16 v[60:63], a[172:175], v[92:95], v[60:63]
    ds_read_b128 v[92:95], v120 offset:43520
    v_mfma_f32_16x16x32_bf16 v[64:67], a[168:171], v[96:99], v[64:67]
    v_mfma_f32_16x16x32_bf16 v[64:67], a[176:179], v[100:103], v[64:67]
    s_waitcnt lgkmcnt(1)
    v_mfma_f32_16x16x32_bf16 v[64:67], a[184:187], v[88:91], v[64:67]
    v_mfma_f32_16x16x32_bf16 v[68:71], a[188:191], v[88:91], v[68:71]
    v_mfma_f32_16x16x32_bf16 v[68:71], a[180:183], v[100:103], v[68:71]
    v_mfma_f32_16x16x32_bf16 v[68:71], a[172:175], v[96:99], v[68:71]
    ds_read_b128 v[96:99], v120 offset:45568
    v_mfma_f32_16x16x32_bf16 v[72:75], a[168:171], v[100:103], v[72:75]
    s_waitcnt vmcnt(17)
    s_barrier
    v_mfma_f32_16x16x32_bf16 v[72:75], a[176:179], v[88:91], v[72:75]
    ds_read_b64_tr_b16 a[192:193], v124 offset:0
    s_waitcnt lgkmcnt(2)
    v_mfma_f32_16x16x32_bf16 v[72:75], a[184:187], v[92:95], v[72:75]
    ds_read_b64_tr_b16 a[194:195], v124 offset:1024
    s_add_u32 m0, s21, 139264
    s_add_u32 s29, s30, 98304
    v_mfma_f32_16x16x32_bf16 v[76:79], a[188:191], v[92:95], v[76:79]
    buffer_load_dwordx4 v123, s[12:15], s29 offen lds
    ds_read_b64_tr_b16 a[196:197], v125 offset:0
    v_mfma_f32_16x16x32_bf16 v[76:79], a[180:183], v[88:91], v[76:79]
    ds_read_b64_tr_b16 a[198:199], v125 offset:1024
    v_mfma_f32_16x16x32_bf16 v[76:79], a[172:175], v[100:103], v[76:79]
    ds_read_b128 v[100:103], v120 offset:47616
    ds_read_b64_tr_b16 a[200:201], v124 offset:8192
    v_mfma_f32_16x16x32_bf16 v[80:83], a[168:171], v[88:91], v[80:83]
    ds_read_b64_tr_b16 a[202:203], v124 offset:9216
    s_add_u32 m0, s21, 143360
    s_add_u32 s29, s30, 114688
    v_mfma_f32_16x16x32_bf16 v[80:83], a[176:179], v[92:95], v[80:83]
    buffer_load_dwordx4 v123, s[12:15], s29 offen lds
    s_waitcnt lgkmcnt(7)
    v_mfma_f32_16x16x32_bf16 v[80:83], a[184:187], v[96:99], v[80:83]
    ds_read_b64_tr_b16 a[204:205], v125 offset:8192
    v_mfma_f32_16x16x32_bf16 v[84:87], a[188:191], v[96:99], v[84:87]
    ds_read_b64_tr_b16 a[206:207], v125 offset:9216
    v_mfma_f32_16x16x32_bf16 v[84:87], a[180:183], v[92:95], v[84:87]
    ds_read_b64_tr_b16 a[208:209], v124 offset:16384
    s_add_u32 m0, s21, 147456
    s_add_u32 s29, s30, 622592
    v_mfma_f32_16x16x32_bf16 v[84:87], a[172:175], v[88:91], v[84:87]
    ds_read_b128 v[88:91], v126 offset:0
    buffer_load_dwordx4 v123, s[12:15], s29 offen lds
    v_mfma_f32_16x16x32_bf16 v[24:27], a[168:171], v[92:95], v[24:27]
    ds_read_b64_tr_b16 a[210:211], v124 offset:17408
    v_mfma_f32_16x16x32_bf16 v[24:27], a[176:179], v[96:99], v[24:27]
    ds_read_b64_tr_b16 a[212:213], v125 offset:16384
    s_waitcnt lgkmcnt(8)
    v_mfma_f32_16x16x32_bf16 v[24:27], a[184:187], v[100:103], v[24:27]
    ds_read_b64_tr_b16 a[214:215], v125 offset:17408
    s_add_u32 m0, s21, 151552
    s_add_u32 s29, s30, 638976
    v_mfma_f32_16x16x32_bf16 v[28:31], a[188:191], v[100:103], v[28:31]
    buffer_load_dwordx4 v123, s[12:15], s29 offen lds
    v_mfma_f32_16x16x32_bf16 v[28:31], a[180:183], v[96:99], v[28:31]
    v_mfma_f32_16x16x32_bf16 v[28:31], a[172:175], v[92:95], v[28:31]
    ds_read_b128 v[92:95], v126 offset:2048
    v_mfma_f32_16x16x32_bf16 v[32:35], a[168:171], v[96:99], v[32:35]
    s_add_u32 m0, s21, 155648
    s_add_u32 s29, s30, 1146880
    v_mfma_f32_16x16x32_bf16 v[32:35], a[176:179], v[100:103], v[32:35]
    buffer_load_dwordx4 v123, s[12:15], s29 offen lds
    v_mfma_f32_16x16x32_bf16 v[36:39], a[180:183], v[100:103], v[36:39]
    v_mfma_f32_16x16x32_bf16 v[36:39], a[172:175], v[96:99], v[36:39]
    ds_read_b128 v[96:99], v126 offset:4096
    s_waitcnt lgkmcnt(2)
    v_mfma_f32_16x16x32_bf16 v[8:11], a[168:171], v[100:103], v[8:11]
    s_add_u32 m0, s21, 159744
    s_add_u32 s29, s30, 1163264
    v_mfma_f32_16x16x32_bf16 v[12:15], a[172:175], v[100:103], v[12:15]
    ds_read_b128 v[100:103], v126 offset:6144
    v_mfma_f32_16x16x32_bf16 v[40:43], a[200:203], v[88:91], v[40:43]
    buffer_load_dwordx4 v123, s[12:15], s29 offen lds
    s_waitcnt lgkmcnt(2)
    v_mfma_f32_16x16x32_bf16 v[40:43], a[208:211], v[92:95], v[40:43]
    v_mfma_f32_16x16x32_bf16 v[44:47], a[212:215], v[92:95], v[44:47]
    v_mfma_f32_16x16x32_bf16 v[44:47], a[204:207], v[88:91], v[44:47]
    s_add_u32 m0, s26, 81920
    s_add_u32 s29, s35, 0
    v_mfma_f32_16x16x32_bf16 v[48:51], a[192:195], v[88:91], v[48:51]
    buffer_load_dwordx4 v127, s[8:11], s29 offen lds
    v_mfma_f32_16x16x32_bf16 v[48:51], a[200:203], v[92:95], v[48:51]
    s_waitcnt lgkmcnt(1)
    v_mfma_f32_16x16x32_bf16 v[48:51], a[208:211], v[96:99], v[48:51]
    v_mfma_f32_16x16x32_bf16 v[52:55], a[212:215], v[96:99], v[52:55]
    s_add_u32 m0, s26, 83968
    s_add_u32 s29, s35, 1024
    v_mfma_f32_16x16x32_bf16 v[52:55], a[204:207], v[92:95], v[52:55]
    buffer_load_dwordx4 v127, s[8:11], s29 offen lds
    v_mfma_f32_16x16x32_bf16 v[52:55], a[196:199], v[88:91], v[52:55]
    ds_read_b128 v[88:91], v126 offset:8192
    v_mfma_f32_16x16x32_bf16 v[56:59], a[192:195], v[92:95], v[56:59]
    v_mfma_f32_16x16x32_bf16 v[56:59], a[200:203], v[96:99], v[56:59]
    s_add_u32 m0, s26, 86016
    s_add_u32 s29, s35, 2048
    s_waitcnt lgkmcnt(1)
    v_mfma_f32_16x16x32_bf16 v[56:59], a[208:211], v[100:103], v[56:59]
    buffer_load_dwordx4 v127, s[8:11], s29 offen lds
    v_mfma_f32_16x16x32_bf16 v[60:63], a[212:215], v[100:103], v[60:63]
    v_mfma_f32_16x16x32_bf16 v[60:63], a[204:207], v[96:99], v[60:63]
    v_mfma_f32_16x16x32_bf16 v[60:63], a[196:199], v[92:95], v[60:63]
    ds_read_b128 v[92:95], v126 offset:10240
    s_add_u32 m0, s26, 88064
    s_add_u32 s29, s35, 3072
    v_mfma_f32_16x16x32_bf16 v[64:67], a[192:195], v[96:99], v[64:67]
    buffer_load_dwordx4 v127, s[8:11], s29 offen lds
    v_mfma_f32_16x16x32_bf16 v[64:67], a[200:203], v[100:103], v[64:67]
    s_waitcnt lgkmcnt(1)
    v_mfma_f32_16x16x32_bf16 v[64:67], a[208:211], v[88:91], v[64:67]
    v_mfma_f32_16x16x32_bf16 v[68:71], a[212:215], v[88:91], v[68:71]
    v_mfma_f32_16x16x32_bf16 v[68:71], a[204:207], v[100:103], v[68:71]
    v_mfma_f32_16x16x32_bf16 v[68:71], a[196:199], v[96:99], v[68:71]
    ds_read_b128 v[96:99], v126 offset:12288
    v_mfma_f32_16x16x32_bf16 v[72:75], a[192:195], v[100:103], v[72:75]
    s_waitcnt vmcnt(21)
    s_barrier
    v_mfma_f32_16x16x32_bf16 v[72:75], a[200:203], v[88:91], v[72:75]
    ds_read_b64_tr_b16 a[216:217], v124 offset:24576
    s_waitcnt lgkmcnt(2)
    v_mfma_f32_16x16x32_bf16 v[72:75], a[208:211], v[92:95], v[72:75]
    ds_read_b64_tr_b16 a[218:219], v124 offset:25600
    s_add_u32 m0, s21, 16384
    s_add_u32 s29, s31, 0
    v_mfma_f32_16x16x32_bf16 v[76:79], a[212:215], v[92:95], v[76:79]
    buffer_load_dwordx4 v123, s[12:15], s29 offen lds
    ds_read_b64_tr_b16 a[220:221], v125 offset:24576
    v_mfma_f32_16x16x32_bf16 v[76:79], a[204:207], v[88:91], v[76:79]
    ds_read_b64_tr_b16 a[222:223], v125 offset:25600
    v_mfma_f32_16x16x32_bf16 v[76:79], a[196:199], v[100:103], v[76:79]
    ds_read_b128 v[100:103], v126 offset:14336
    ds_read_b64_tr_b16 a[224:225], v124 offset:32768
    v_mfma_f32_16x16x32_bf16 v[80:83], a[192:195], v[88:91], v[80:83]
    ds_read_b64_tr_b16 a[226:227], v124 offset:33792
    s_add_u32 m0, s21, 20480
    s_add_u32 s29, s31, 16384
    v_mfma_f32_16x16x32_bf16 v[80:83], a[200:203], v[92:95], v[80:83]
    buffer_load_dwordx4 v123, s[12:15], s29 offen lds
    s_waitcnt lgkmcnt(7)
    v_mfma_f32_16x16x32_bf16 v[80:83], a[208:211], v[96:99], v[80:83]
    ds_read_b64_tr_b16 a[228:229], v125 offset:32768
    v_mfma_f32_16x16x32_bf16 v[84:87], a[212:215], v[96:99], v[84:87]
    ds_read_b64_tr_b16 a[230:231], v125 offset:33792
    v_mfma_f32_16x16x32_bf16 v[84:87], a[204:207], v[92:95], v[84:87]
    ds_read_b64_tr_b16 a[232:233], v124 offset:40960
    s_add_u32 m0, s21, 24576
    s_add_u32 s29, s31, 524288
    v_mfma_f32_16x16x32_bf16 v[84:87], a[196:199], v[88:91], v[84:87]
    ds_read_b128 v[88:91], v126 offset:512
    buffer_load_dwordx4 v123, s[12:15], s29 offen lds
    v_mfma_f32_16x16x32_bf16 v[24:27], a[192:195], v[92:95], v[24:27]
    ds_read_b64_tr_b16 a[234:235], v124 offset:41984
    v_mfma_f32_16x16x32_bf16 v[24:27], a[200:203], v[96:99], v[24:27]
    ds_read_b64_tr_b16 a[236:237], v125 offset:40960
    s_waitcnt lgkmcnt(8)
    v_mfma_f32_16x16x32_bf16 v[24:27], a[208:211], v[100:103], v[24:27]
    ds_read_b64_tr_b16 a[238:239], v125 offset:41984
    s_add_u32 m0, s21, 28672
    s_add_u32 s29, s31, 540672
    v_mfma_f32_16x16x32_bf16 v[28:31], a[212:215], v[100:103], v[28:31]
    buffer_load_dwordx4 v123, s[12:15], s29 offen lds
    v_mfma_f32_16x16x32_bf16 v[28:31], a[204:207], v[96:99], v[28:31]
    v_mfma_f32_16x16x32_bf16 v[28:31], a[196:199], v[92:95], v[28:31]
    ds_read_b128 v[92:95], v126 offset:2560
    v_mfma_f32_16x16x32_bf16 v[32:35], a[192:195], v[96:99], v[32:35]
    s_add_u32 m0, s21, 32768
    s_add_u32 s29, s31, 1048576
    v_mfma_f32_16x16x32_bf16 v[32:35], a[200:203], v[100:103], v[32:35]
    buffer_load_dwordx4 v123, s[12:15], s29 offen lds
    v_mfma_f32_16x16x32_bf16 v[36:39], a[204:207], v[100:103], v[36:39]
    v_mfma_f32_16x16x32_bf16 v[36:39], a[196:199], v[96:99], v[36:39]
    ds_read_b128 v[96:99], v126 offset:4608
    s_waitcnt lgkmcnt(2)
    v_mfma_f32_16x16x32_bf16 v[8:11], a[192:195], v[100:103], v[8:11]
    s_add_u32 m0, s21, 36864
    s_add_u32 s29, s31, 1064960
    v_mfma_f32_16x16x32_bf16 v[12:15], a[196:199], v[100:103], v[12:15]
    ds_read_b128 v[100:103], v126 offset:6656
    v_mfma_f32_16x16x32_bf16 v[40:43], a[224:227], v[88:91], v[40:43]
    buffer_load_dwordx4 v123, s[12:15], s29 offen lds
    s_waitcnt lgkmcnt(2)
    v_mfma_f32_16x16x32_bf16 v[40:43], a[232:235], v[92:95], v[40:43]
    v_mfma_f32_16x16x32_bf16 v[44:47], a[236:239], v[92:95], v[44:47]
    v_mfma_f32_16x16x32_bf16 v[44:47], a[228:231], v[88:91], v[44:47]
    v_mfma_f32_16x16x32_bf16 v[48:51], a[216:219], v[88:91], v[48:51]
    v_mfma_f32_16x16x32_bf16 v[48:51], a[224:227], v[92:95], v[48:51]
    s_waitcnt lgkmcnt(1)
    v_mfma_f32_16x16x32_bf16 v[48:51], a[232:235], v[96:99], v[48:51]
    v_mfma_f32_16x16x32_bf16 v[52:55], a[236:239], v[96:99], v[52:55]
    v_mfma_f32_16x16x32_bf16 v[52:55], a[228:231], v[92:95], v[52:55]
    v_mfma_f32_16x16x32_bf16 v[52:55], a[220:223], v[88:91], v[52:55]
    ds_read_b128 v[88:91], v126 offset:8704
    v_mfma_f32_16x16x32_bf16 v[56:59], a[216:219], v[92:95], v[56:59]
    v_mfma_f32_16x16x32_bf16 v[56:59], a[224:227], v[96:99], v[56:59]
    s_waitcnt lgkmcnt(1)
    v_mfma_f32_16x16x32_bf16 v[56:59], a[232:235], v[100:103], v[56:59]
    v_mfma_f32_16x16x32_bf16 v[60:63], a[236:239], v[100:103], v[60:63]
    v_mfma_f32_16x16x32_bf16 v[60:63], a[228:231], v[96:99], v[60:63]
    v_mfma_f32_16x16x32_bf16 v[60:63], a[220:223], v[92:95], v[60:63]
    ds_read_b128 v[92:95], v126 offset:10752
    v_mfma_f32_16x16x32_bf16 v[64:67], a[216:219], v[96:99], v[64:67]
    v_mfma_f32_16x16x32_bf16 v[64:67], a[224:227], v[100:103], v[64:67]
    s_waitcnt lgkmcnt(1)
    v_mfma_f32_16x16x32_bf16 v[64:67], a[232:235], v[88:91], v[64:67]
    v_mfma_f32_16x16x32_bf16 v[68:71], a[236:239], v[88:91], v[68:71]
    v_mfma_f32_16x16x32_bf16 v[68:71], a[228:231], v[100:103], v[68:71]
    v_mfma_f32_16x16x32_bf16 v[68:71], a[220:223], v[96:99], v[68:71]
    ds_read_b128 v[96:99], v126 offset:12800
    v_mfma_f32_16x16x32_bf16 v[72:75], a[216:219], v[100:103], v[72:75]
    s_waitcnt vmcnt(17)
    s_barrier
    v_mfma_f32_16x16x32_bf16 v[72:75], a[224:227], v[88:91], v[72:75]
    ds_read_b64_tr_b16 a[240:241], v121 offset:0
    s_waitcnt lgkmcnt(2)
    v_mfma_f32_16x16x32_bf16 v[72:75], a[232:235], v[92:95], v[72:75]
    ds_read_b64_tr_b16 a[242:243], v121 offset:1024
    s_add_u32 m0, s21, 40960
    s_add_u32 s29, s31, 32768
    v_mfma_f32_16x16x32_bf16 v[76:79], a[236:239], v[92:95], v[76:79]
    buffer_load_dwordx4 v123, s[12:15], s29 offen lds
    ds_read_b64_tr_b16 a[244:245], v122 offset:0
    v_mfma_f32_16x16x32_bf16 v[76:79], a[228:231], v[88:91], v[76:79]
    ds_read_b64_tr_b16 a[246:247], v122 offset:1024
    v_mfma_f32_16x16x32_bf16 v[76:79], a[220:223], v[100:103], v[76:79]
    ds_read_b128 v[100:103], v126 offset:14848
    ds_read_b64_tr_b16 a[248:249], v121 offset:8192
    v_mfma_f32_16x16x32_bf16 v[80:83], a[216:219], v[88:91], v[80:83]
    ds_read_b64_tr_b16 a[250:251], v121 offset:9216
    s_add_u32 m0, s21, 45056
    s_add_u32 s29, s31, 49152
    v_mfma_f32_16x16x32_bf16 v[80:83], a[224:227], v[92:95], v[80:83]
    buffer_load_dwordx4 v123, s[12:15], s29 offen lds
    s_waitcnt lgkmcnt(7)
    v_mfma_f32_16x16x32_bf16 v[80:83], a[232:235], v[96:99], v[80:83]
    ds_read_b64_tr_b16 a[252:253], v122 offset:8192
    v_mfma_f32_16x16x32_bf16 v[84:87], a[236:239], v[96:99], v[84:87]
    ds_read_b64_tr_b16 a[254:255], v122 offset:9216
    v_mfma_f32_16x16x32_bf16 v[84:87], a[228:231], v[92:95], v[84:87]
    ds_read_b64_tr_b16 v[128:129], v121 offset:16384
    s_add_u32 m0, s21, 49152
    s_add_u32 s29, s31, 557056
    v_mfma_f32_16x16x32_bf16 v[84:87], a[220:223], v[88:91], v[84:87]
    ds_read_b128 v[88:91], v120 offset:0
    buffer_load_dwordx4 v123, s[12:15], s29 offen lds
    v_mfma_f32_16x16x32_bf16 v[24:27], a[216:219], v[92:95], v[24:27]
    ds_read_b64_tr_b16 v[130:131], v121 offset:17408
    v_mfma_f32_16x16x32_bf16 v[24:27], a[224:227], v[96:99], v[24:27]
    ds_read_b64_tr_b16 v[132:133], v122 offset:16384
    s_waitcnt lgkmcnt(8)
    v_mfma_f32_16x16x32_bf16 v[24:27], a[232:235], v[100:103], v[24:27]
    ds_read_b64_tr_b16 v[134:135], v122 offset:17408
    s_add_u32 m0, s21, 53248
    s_add_u32 s29, s31, 573440
    v_mfma_f32_16x16x32_bf16 v[28:31], a[236:239], v[100:103], v[28:31]
    buffer_load_dwordx4 v123, s[12:15], s29 offen lds
    v_mfma_f32_16x16x32_bf16 v[28:31], a[228:231], v[96:99], v[28:31]
    v_mfma_f32_16x16x32_bf16 v[28:31], a[220:223], v[92:95], v[28:31]
    ds_read_b128 v[92:95], v120 offset:2048
    v_mfma_f32_16x16x32_bf16 v[32:35], a[216:219], v[96:99], v[32:35]
    s_add_u32 m0, s21, 57344
    s_add_u32 s29, s31, 1081344
    v_mfma_f32_16x16x32_bf16 v[32:35], a[224:227], v[100:103], v[32:35]
    buffer_load_dwordx4 v123, s[12:15], s29 offen lds
    v_mfma_f32_16x16x32_bf16 v[36:39], a[228:231], v[100:103], v[36:39]
    v_mfma_f32_16x16x32_bf16 v[36:39], a[220:223], v[96:99], v[36:39]
    ds_read_b128 v[96:99], v120 offset:4096
    s_waitcnt lgkmcnt(2)
    v_mfma_f32_16x16x32_bf16 v[8:11], a[216:219], v[100:103], v[8:11]
    s_add_u32 m0, s21, 61440
    s_add_u32 s29, s31, 1097728
    v_mfma_f32_16x16x32_bf16 v[12:15], a[220:223], v[100:103], v[12:15]
    ds_read_b128 v[100:103], v120 offset:6144
    v_mfma_f32_16x16x32_bf16 v[40:43], a[248:251], v[88:91], v[40:43]
    buffer_load_dwordx4 v123, s[12:15], s29 offen lds
    s_waitcnt lgkmcnt(2)
    v_mfma_f32_16x16x32_bf16 v[40:43], v[128:131], v[92:95], v[40:43]
    v_mfma_f32_16x16x32_bf16 v[44:47], v[132:135], v[92:95], v[44:47]
    v_mfma_f32_16x16x32_bf16 v[44:47], a[252:255], v[88:91], v[44:47]
    s_add_u32 m0, s26, 98304
    s_add_u32 s29, s35, 128
    v_mfma_f32_16x16x32_bf16 v[48:51], a[240:243], v[88:91], v[48:51]
    buffer_load_dwordx4 v127, s[8:11], s29 offen lds
    v_mfma_f32_16x16x32_bf16 v[48:51], a[248:251], v[92:95], v[48:51]
    s_waitcnt lgkmcnt(1)
    v_mfma_f32_16x16x32_bf16 v[48:51], v[128:131], v[96:99], v[48:51]
    v_mfma_f32_16x16x32_bf16 v[52:55], v[132:135], v[96:99], v[52:55]
    s_add_u32 m0, s26, 100352
    s_add_u32 s29, s35, 1152
    v_mfma_f32_16x16x32_bf16 v[52:55], a[252:255], v[92:95], v[52:55]
    buffer_load_dwordx4 v127, s[8:11], s29 offen lds
    v_mfma_f32_16x16x32_bf16 v[52:55], a[244:247], v[88:91], v[52:55]
    ds_read_b128 v[88:91], v120 offset:8192
    v_mfma_f32_16x16x32_bf16 v[56:59], a[240:243], v[92:95], v[56:59]
    v_mfma_f32_16x16x32_bf16 v[56:59], a[248:251], v[96:99], v[56:59]
    s_add_u32 m0, s26, 102400
    s_add_u32 s29, s35, 2176
    s_waitcnt lgkmcnt(1)
    v_mfma_f32_16x16x32_bf16 v[56:59], v[128:131], v[100:103], v[56:59]
    buffer_load_dwordx4 v127, s[8:11], s29 offen lds
    v_mfma_f32_16x16x32_bf16 v[60:63], v[132:135], v[100:103], v[60:63]
    v_mfma_f32_16x16x32_bf16 v[60:63], a[252:255], v[96:99], v[60:63]
    v_mfma_f32_16x16x32_bf16 v[60:63], a[244:247], v[92:95], v[60:63]
    ds_read_b128 v[92:95], v120 offset:10240
    s_add_u32 m0, s26, 104448
    s_add_u32 s29, s35, 3200
    v_mfma_f32_16x16x32_bf16 v[64:67], a[240:243], v[96:99], v[64:67]
    buffer_load_dwordx4 v127, s[8:11], s29 offen lds
    v_mfma_f32_16x16x32_bf16 v[64:67], a[248:251], v[100:103], v[64:67]
    s_waitcnt lgkmcnt(1)
    v_mfma_f32_16x16x32_bf16 v[64:67], v[128:131], v[88:91], v[64:67]
    v_mfma_f32_16x16x32_bf16 v[68:71], v[132:135], v[88:91], v[68:71]
    v_mfma_f32_16x16x32_bf16 v[68:71], a[252:255], v[100:103], v[68:71]
    v_mfma_f32_16x16x32_bf16 v[68:71], a[244:247], v[96:99], v[68:71]
    ds_read_b128 v[96:99], v120 offset:12288
    v_mfma_f32_16x16x32_bf16 v[72:75], a[240:243], v[100:103], v[72:75]
    s_waitcnt vmcnt(20)
    s_barrier
    v_mfma_f32_16x16x32_bf16 v[72:75], a[248:251], v[88:91], v[72:75]
    ds_read_b64_tr_b16 v[136:137], v121 offset:24576
    s_waitcnt lgkmcnt(2)
    v_mfma_f32_16x16x32_bf16 v[72:75], v[128:131], v[92:95], v[72:75]
    ds_read_b64_tr_b16 v[138:139], v121 offset:25600
    s_add_u32 m0, s21, 114688
    s_add_u32 s29, s31, 65536
    v_mfma_f32_16x16x32_bf16 v[76:79], v[132:135], v[92:95], v[76:79]
    buffer_load_dwordx4 v123, s[12:15], s29 offen lds
    ds_read_b64_tr_b16 v[140:141], v122 offset:24576
    v_mfma_f32_16x16x32_bf16 v[76:79], a[252:255], v[88:91], v[76:79]
    ds_read_b64_tr_b16 v[142:143], v122 offset:25600
    v_mfma_f32_16x16x32_bf16 v[76:79], a[244:247], v[100:103], v[76:79]
    ds_read_b128 v[100:103], v120 offset:14336
    ds_read_b64_tr_b16 v[144:145], v121 offset:32768
    v_mfma_f32_16x16x32_bf16 v[80:83], a[240:243], v[88:91], v[80:83]
    ds_read_b64_tr_b16 v[146:147], v121 offset:33792
    s_add_u32 m0, s21, 118784
    s_add_u32 s29, s31, 81920
    v_mfma_f32_16x16x32_bf16 v[80:83], a[248:251], v[92:95], v[80:83]
    buffer_load_dwordx4 v123, s[12:15], s29 offen lds
    s_waitcnt lgkmcnt(7)
    v_mfma_f32_16x16x32_bf16 v[80:83], v[128:131], v[96:99], v[80:83]
    ds_read_b64_tr_b16 v[148:149], v122 offset:32768
    v_mfma_f32_16x16x32_bf16 v[84:87], v[132:135], v[96:99], v[84:87]
    ds_read_b64_tr_b16 v[150:151], v122 offset:33792
    v_mfma_f32_16x16x32_bf16 v[84:87], a[252:255], v[92:95], v[84:87]
    ds_read_b64_tr_b16 v[152:153], v121 offset:40960
    s_add_u32 m0, s21, 122880
    s_add_u32 s29, s31, 589824
    v_mfma_f32_16x16x32_bf16 v[84:87], a[244:247], v[88:91], v[84:87]
    ds_read_b128 v[88:91], v120 offset:512
    buffer_load_dwordx4 v123, s[12:15], s29 offen lds
    v_mfma_f32_16x16x32_bf16 v[24:27], a[240:243], v[92:95], v[24:27]
    ds_read_b64_tr_b16 v[154:155], v121 offset:41984
    v_mfma_f32_16x16x32_bf16 v[24:27], a[248:251], v[96:99], v[24:27]
    ds_read_b64_tr_b16 v[156:157], v122 offset:40960
    s_waitcnt lgkmcnt(8)
    v_mfma_f32_16x16x32_bf16 v[24:27], v[128:131], v[100:103], v[24:27]
    ds_read_b64_tr_b16 v[158:159], v122 offset:41984
    s_add_u32 m0, s21, 126976
    s_add_u32 s29, s31, 606208
    v_mfma_f32_16x16x32_bf16 v[28:31], v[132:135], v[100:103], v[28:31]
    buffer_load_dwordx4 v123, s[12:15], s29 offen lds
    v_mfma_f32_16x16x32_bf16 v[28:31], a[252:255], v[96:99], v[28:31]
    v_mfma_f32_16x16x32_bf16 v[28:31], a[244:247], v[92:95], v[28:31]
    ds_read_b128 v[92:95], v120 offset:2560
    v_mfma_f32_16x16x32_bf16 v[32:35], a[240:243], v[96:99], v[32:35]
    s_add_u32 m0, s21, 131072
    s_add_u32 s29, s31, 1114112
    v_mfma_f32_16x16x32_bf16 v[32:35], a[248:251], v[100:103], v[32:35]
    buffer_load_dwordx4 v123, s[12:15], s29 offen lds
    v_mfma_f32_16x16x32_bf16 v[36:39], a[252:255], v[100:103], v[36:39]
    v_mfma_f32_16x16x32_bf16 v[36:39], a[244:247], v[96:99], v[36:39]
    ds_read_b128 v[96:99], v120 offset:4608
    s_waitcnt lgkmcnt(2)
    v_mfma_f32_16x16x32_bf16 v[8:11], a[240:243], v[100:103], v[8:11]
    s_add_u32 m0, s21, 135168
    s_add_u32 s29, s31, 1130496
    v_mfma_f32_16x16x32_bf16 v[12:15], a[244:247], v[100:103], v[12:15]
    ds_read_b128 v[100:103], v120 offset:6656
    v_mfma_f32_16x16x32_bf16 v[40:43], v[144:147], v[88:91], v[40:43]
    buffer_load_dwordx4 v123, s[12:15], s29 offen lds
    s_waitcnt lgkmcnt(2)
    v_mfma_f32_16x16x32_bf16 v[40:43], v[152:155], v[92:95], v[40:43]
    v_mfma_f32_16x16x32_bf16 v[44:47], v[156:159], v[92:95], v[44:47]
    v_mfma_f32_16x16x32_bf16 v[44:47], v[148:151], v[88:91], v[44:47]
    s_add_u32 m0, s21, 0
    s_mov_b32 s29, 8192
    v_mfma_f32_16x16x32_bf16 v[48:51], v[136:139], v[88:91], v[48:51]
    buffer_load_dwordx4 v4, s[8:11], s29 offen lds
    v_mfma_f32_16x16x32_bf16 v[48:51], v[144:147], v[92:95], v[48:51]
    s_waitcnt lgkmcnt(1)
    v_mfma_f32_16x16x32_bf16 v[48:51], v[152:155], v[96:99], v[48:51]
    v_mfma_f32_16x16x32_bf16 v[52:55], v[156:159], v[96:99], v[52:55]
    s_add_u32 m0, s21, 4096
    v_mfma_f32_16x16x32_bf16 v[52:55], v[148:151], v[92:95], v[52:55]
    buffer_load_dwordx4 v5, s[8:11], s29 offen lds
    v_mfma_f32_16x16x32_bf16 v[52:55], v[140:143], v[88:91], v[52:55]
    ds_read_b128 v[88:91], v120 offset:8704
    v_mfma_f32_16x16x32_bf16 v[56:59], v[136:139], v[92:95], v[56:59]
    v_mfma_f32_16x16x32_bf16 v[56:59], v[144:147], v[96:99], v[56:59]
    s_add_u32 m0, s21, 8192
    s_waitcnt lgkmcnt(1)
    v_mfma_f32_16x16x32_bf16 v[56:59], v[152:155], v[100:103], v[56:59]
    buffer_load_dwordx4 v6, s[8:11], s29 offen lds
    v_mfma_f32_16x16x32_bf16 v[60:63], v[156:159], v[100:103], v[60:63]
    v_mfma_f32_16x16x32_bf16 v[60:63], v[148:151], v[96:99], v[60:63]
    v_mfma_f32_16x16x32_bf16 v[60:63], v[140:143], v[92:95], v[60:63]
    ds_read_b128 v[92:95], v120 offset:10752
    s_add_u32 m0, s21, 12288
    v_mfma_f32_16x16x32_bf16 v[64:67], v[136:139], v[96:99], v[64:67]
    buffer_load_dwordx4 v7, s[8:11], s29 offen lds
    v_mfma_f32_16x16x32_bf16 v[64:67], v[144:147], v[100:103], v[64:67]
    s_waitcnt lgkmcnt(1)
    v_mfma_f32_16x16x32_bf16 v[64:67], v[152:155], v[88:91], v[64:67]
    v_mfma_f32_16x16x32_bf16 v[68:71], v[156:159], v[88:91], v[68:71]
    v_mfma_f32_16x16x32_bf16 v[68:71], v[148:151], v[100:103], v[68:71]
    v_mfma_f32_16x16x32_bf16 v[68:71], v[140:143], v[96:99], v[68:71]
    ds_read_b128 v[96:99], v120 offset:12800
    v_mfma_f32_16x16x32_bf16 v[72:75], v[136:139], v[100:103], v[72:75]
    s_waitcnt vmcnt(20)
    s_barrier
    v_mfma_f32_16x16x32_bf16 v[72:75], v[144:147], v[88:91], v[72:75]
    ds_read_b64_tr_b16 v[160:161], v124 offset:0
    s_waitcnt lgkmcnt(2)
    v_mfma_f32_16x16x32_bf16 v[72:75], v[152:155], v[92:95], v[72:75]
    ds_read_b64_tr_b16 v[162:163], v124 offset:1024
    s_add_u32 m0, s21, 139264
    s_add_u32 s29, s31, 98304
    v_mfma_f32_16x16x32_bf16 v[76:79], v[156:159], v[92:95], v[76:79]
    buffer_load_dwordx4 v123, s[12:15], s29 offen lds
    ds_read_b64_tr_b16 v[164:165], v125 offset:0
    v_mfma_f32_16x16x32_bf16 v[76:79], v[148:151], v[88:91], v[76:79]
    ds_read_b64_tr_b16 v[166:167], v125 offset:1024
    v_mfma_f32_16x16x32_bf16 v[76:79], v[140:143], v[100:103], v[76:79]
    ds_read_b128 v[100:103], v120 offset:14848
    ds_read_b64_tr_b16 v[168:169], v124 offset:8192
    v_mfma_f32_16x16x32_bf16 v[80:83], v[136:139], v[88:91], v[80:83]
    ds_read_b64_tr_b16 v[170:171], v124 offset:9216
    s_add_u32 m0, s21, 143360
    s_add_u32 s29, s31, 114688
    v_mfma_f32_16x16x32_bf16 v[80:83], v[144:147], v[92:95], v[80:83]
    buffer_load_dwordx4 v123, s[12:15], s29 offen lds
    s_waitcnt lgkmcnt(7)
    v_mfma_f32_16x16x32_bf16 v[80:83], v[152:155], v[96:99], v[80:83]
    ds_read_b64_tr_b16 v[172:173], v125 offset:8192
    v_mfma_f32_16x16x32_bf16 v[84:87], v[156:159], v[96:99], v[84:87]
    ds_read_b64_tr_b16 v[174:175], v125 offset:9216
    v_mfma_f32_16x16x32_bf16 v[84:87], v[148:151], v[92:95], v[84:87]
    ds_read_b64_tr_b16 v[176:177], v124 offset:16384
    s_add_u32 m0, s21, 147456
    s_add_u32 s29, s31, 622592
    v_mfma_f32_16x16x32_bf16 v[84:87], v[140:143], v[88:91], v[84:87]
    ds_read_b128 v[88:91], v120 offset:16384
    buffer_load_dwordx4 v123, s[12:15], s29 offen lds
    v_mfma_f32_16x16x32_bf16 v[24:27], v[136:139], v[92:95], v[24:27]
    ds_read_b64_tr_b16 v[178:179], v124 offset:17408
    v_mfma_f32_16x16x32_bf16 v[24:27], v[144:147], v[96:99], v[24:27]
    ds_read_b64_tr_b16 v[180:181], v125 offset:16384
    s_waitcnt lgkmcnt(8)
    v_mfma_f32_16x16x32_bf16 v[24:27], v[152:155], v[100:103], v[24:27]
    ds_read_b64_tr_b16 v[182:183], v125 offset:17408
    s_add_u32 m0, s21, 151552
    s_add_u32 s29, s31, 638976
    v_mfma_f32_16x16x32_bf16 v[28:31], v[156:159], v[100:103], v[28:31]
    buffer_load_dwordx4 v123, s[12:15], s29 offen lds
    v_mfma_f32_16x16x32_bf16 v[28:31], v[148:151], v[96:99], v[28:31]
    v_mfma_f32_16x16x32_bf16 v[28:31], v[140:143], v[92:95], v[28:31]
    ds_read_b128 v[92:95], v120 offset:18432
    v_mfma_f32_16x16x32_bf16 v[32:35], v[136:139], v[96:99], v[32:35]
    s_add_u32 m0, s21, 155648
    s_add_u32 s29, s31, 1146880
    v_mfma_f32_16x16x32_bf16 v[32:35], v[144:147], v[100:103], v[32:35]
    buffer_load_dwordx4 v123, s[12:15], s29 offen lds
    v_mfma_f32_16x16x32_bf16 v[36:39], v[148:151], v[100:103], v[36:39]
    v_mfma_f32_16x16x32_bf16 v[36:39], v[140:143], v[96:99], v[36:39]
    ds_read_b128 v[96:99], v120 offset:20480
    s_waitcnt lgkmcnt(2)
    v_mfma_f32_16x16x32_bf16 v[8:11], v[136:139], v[100:103], v[8:11]
    s_add_u32 m0, s21, 159744
    s_add_u32 s29, s31, 1163264
    v_mfma_f32_16x16x32_bf16 v[12:15], v[140:143], v[100:103], v[12:15]
    ds_read_b128 v[100:103], v120 offset:22528
    v_mfma_f32_16x16x32_bf16 v[40:43], v[168:171], v[88:91], v[40:43]
    buffer_load_dwordx4 v123, s[12:15], s29 offen lds
    s_waitcnt lgkmcnt(2)
    v_mfma_f32_16x16x32_bf16 v[40:43], v[176:179], v[92:95], v[40:43]
    v_mfma_f32_16x16x32_bf16 v[44:47], v[180:183], v[92:95], v[44:47]
    v_mfma_f32_16x16x32_bf16 v[44:47], v[172:175], v[88:91], v[44:47]
    v_mfma_f32_16x16x32_bf16 v[48:51], v[160:163], v[88:91], v[48:51]
    v_mfma_f32_16x16x32_bf16 v[48:51], v[168:171], v[92:95], v[48:51]
    s_waitcnt lgkmcnt(1)
    v_mfma_f32_16x16x32_bf16 v[48:51], v[176:179], v[96:99], v[48:51]
    v_mfma_f32_16x16x32_bf16 v[52:55], v[180:183], v[96:99], v[52:55]
    v_mfma_f32_16x16x32_bf16 v[52:55], v[172:175], v[92:95], v[52:55]
    v_mfma_f32_16x16x32_bf16 v[52:55], v[164:167], v[88:91], v[52:55]
    ds_read_b128 v[88:91], v120 offset:24576
    v_mfma_f32_16x16x32_bf16 v[56:59], v[160:163], v[92:95], v[56:59]
    v_mfma_f32_16x16x32_bf16 v[56:59], v[168:171], v[96:99], v[56:59]
    s_waitcnt lgkmcnt(1)
    v_mfma_f32_16x16x32_bf16 v[56:59], v[176:179], v[100:103], v[56:59]
    v_mfma_f32_16x16x32_bf16 v[60:63], v[180:183], v[100:103], v[60:63]
    v_mfma_f32_16x16x32_bf16 v[60:63], v[172:175], v[96:99], v[60:63]
    v_mfma_f32_16x16x32_bf16 v[60:63], v[164:167], v[92:95], v[60:63]
    ds_read_b128 v[92:95], v120 offset:26624
    v_mfma_f32_16x16x32_bf16 v[64:67], v[160:163], v[96:99], v[64:67]
    v_mfma_f32_16x16x32_bf16 v[64:67], v[168:171], v[100:103], v[64:67]
    s_waitcnt lgkmcnt(1)
    v_mfma_f32_16x16x32_bf16 v[64:67], v[176:179], v[88:91], v[64:67]
    v_mfma_f32_16x16x32_bf16 v[68:71], v[180:183], v[88:91], v[68:71]
    v_mfma_f32_16x16x32_bf16 v[68:71], v[172:175], v[100:103], v[68:71]
    v_mfma_f32_16x16x32_bf16 v[68:71], v[164:167], v[96:99], v[68:71]
    ds_read_b128 v[96:99], v120 offset:28672
    v_mfma_f32_16x16x32_bf16 v[72:75], v[160:163], v[100:103], v[72:75]
    s_waitcnt vmcnt(20)
    s_barrier
    v_mfma_f32_16x16x32_bf16 v[72:75], v[168:171], v[88:91], v[72:75]
    ds_read_b64_tr_b16 v[184:185], v124 offset:24576
    s_waitcnt lgkmcnt(2)
    v_mfma_f32_16x16x32_bf16 v[72:75], v[176:179], v[92:95], v[72:75]
    ds_read_b64_tr_b16 v[186:187], v124 offset:25600
    s_add_u32 m0, s21, 16384
    s_mov_b32 s29, 9216
    v_mfma_f32_16x16x32_bf16 v[76:79], v[180:183], v[92:95], v[76:79]
    buffer_load_dwordx4 v4, s[8:11], s29 offen lds
    ds_read_b64_tr_b16 v[188:189], v125 offset:24576
    v_mfma_f32_16x16x32_bf16 v[76:79], v[172:175], v[88:91], v[76:79]
    ds_read_b64_tr_b16 v[190:191], v125 offset:25600
    v_mfma_f32_16x16x32_bf16 v[76:79], v[164:167], v[100:103], v[76:79]
    ds_read_b128 v[100:103], v120 offset:30720
    ds_read_b64_tr_b16 v[192:193], v124 offset:32768
    v_mfma_f32_16x16x32_bf16 v[80:83], v[160:163], v[88:91], v[80:83]
    ds_read_b64_tr_b16 v[194:195], v124 offset:33792
    v_mfma_f32_16x16x32_bf16 v[80:83], v[168:171], v[92:95], v[80:83]
    ds_read_b64_tr_b16 v[196:197], v125 offset:32768
    s_waitcnt lgkmcnt(8)
    v_mfma_f32_16x16x32_bf16 v[80:83], v[176:179], v[96:99], v[80:83]
    ds_read_b64_tr_b16 v[198:199], v125 offset:33792
    v_mfma_f32_16x16x32_bf16 v[84:87], v[180:183], v[96:99], v[84:87]
    ds_read_b64_tr_b16 v[200:201], v124 offset:40960
    v_mfma_f32_16x16x32_bf16 v[84:87], v[172:175], v[92:95], v[84:87]
    ds_read_b64_tr_b16 v[202:203], v124 offset:41984
    v_mfma_f32_16x16x32_bf16 v[84:87], v[164:167], v[88:91], v[84:87]
    ds_read_b128 v[88:91], v120 offset:16896
    ds_read_b64_tr_b16 v[204:205], v125 offset:40960
    v_mfma_f32_16x16x32_bf16 v[24:27], v[160:163], v[92:95], v[24:27]
    ds_read_b64_tr_b16 v[206:207], v125 offset:41984
    s_add_u32 m0, s21, 20480
    v_mfma_f32_16x16x32_bf16 v[24:27], v[168:171], v[96:99], v[24:27]
    buffer_load_dwordx4 v5, s[8:11], s29 offen lds
    s_waitcnt lgkmcnt(9)
    v_mfma_f32_16x16x32_bf16 v[24:27], v[176:179], v[100:103], v[24:27]
    v_mfma_f32_16x16x32_bf16 v[28:31], v[180:183], v[100:103], v[28:31]
    v_mfma_f32_16x16x32_bf16 v[28:31], v[172:175], v[96:99], v[28:31]
    v_mfma_f32_16x16x32_bf16 v[28:31], v[164:167], v[92:95], v[28:31]
    ds_read_b128 v[92:95], v120 offset:18944
    v_mfma_f32_16x16x32_bf16 v[32:35], v[160:163], v[96:99], v[32:35]
    v_mfma_f32_16x16x32_bf16 v[32:35], v[168:171], v[100:103], v[32:35]
    v_mfma_f32_16x16x32_bf16 v[36:39], v[172:175], v[100:103], v[36:39]
    v_mfma_f32_16x16x32_bf16 v[36:39], v[164:167], v[96:99], v[36:39]
    ds_read_b128 v[96:99], v120 offset:20992
    s_waitcnt lgkmcnt(2)
    v_mfma_f32_16x16x32_bf16 v[8:11], v[160:163], v[100:103], v[8:11]
    s_add_u32 m0, s21, 24576
    v_mfma_f32_16x16x32_bf16 v[12:15], v[164:167], v[100:103], v[12:15]
    ds_read_b128 v[100:103], v120 offset:23040
    v_mfma_f32_16x16x32_bf16 v[40:43], v[192:195], v[88:91], v[40:43]
    buffer_load_dwordx4 v6, s[8:11], s29 offen lds
    s_waitcnt lgkmcnt(2)
    v_mfma_f32_16x16x32_bf16 v[40:43], v[200:203], v[92:95], v[40:43]
    v_mfma_f32_16x16x32_bf16 v[44:47], v[204:207], v[92:95], v[44:47]
    v_mfma_f32_16x16x32_bf16 v[44:47], v[196:199], v[88:91], v[44:47]
    v_mfma_f32_16x16x32_bf16 v[48:51], v[184:187], v[88:91], v[48:51]
    v_mfma_f32_16x16x32_bf16 v[48:51], v[192:195], v[92:95], v[48:51]
    s_waitcnt lgkmcnt(1)
    v_mfma_f32_16x16x32_bf16 v[48:51], v[200:203], v[96:99], v[48:51]
    v_mfma_f32_16x16x32_bf16 v[52:55], v[204:207], v[96:99], v[52:55]
    v_mfma_f32_16x16x32_bf16 v[52:55], v[196:199], v[92:95], v[52:55]
    v_mfma_f32_16x16x32_bf16 v[52:55], v[188:191], v[88:91], v[52:55]
    ds_read_b128 v[88:91], v120 offset:25088
    s_add_u32 m0, s21, 28672
    v_mfma_f32_16x16x32_bf16 v[56:59], v[184:187], v[92:95], v[56:59]
    buffer_load_dwordx4 v7, s[8:11], s29 offen lds
    v_mfma_f32_16x16x32_bf16 v[56:59], v[192:195], v[96:99], v[56:59]
    s_waitcnt lgkmcnt(1)
    v_mfma_f32_16x16x32_bf16 v[56:59], v[200:203], v[100:103], v[56:59]
    v_mfma_f32_16x16x32_bf16 v[60:63], v[204:207], v[100:103], v[60:63]
    v_mfma_f32_16x16x32_bf16 v[60:63], v[196:199], v[96:99], v[60:63]
    v_mfma_f32_16x16x32_bf16 v[60:63], v[188:191], v[92:95], v[60:63]
    ds_read_b128 v[92:95], v120 offset:27136
    v_mfma_f32_16x16x32_bf16 v[64:67], v[184:187], v[96:99], v[64:67]
    v_mfma_f32_16x16x32_bf16 v[64:67], v[192:195], v[100:103], v[64:67]
    s_waitcnt lgkmcnt(1)
    v_mfma_f32_16x16x32_bf16 v[64:67], v[200:203], v[88:91], v[64:67]
    v_mfma_f32_16x16x32_bf16 v[68:71], v[204:207], v[88:91], v[68:71]
    v_mfma_f32_16x16x32_bf16 v[68:71], v[196:199], v[100:103], v[68:71]
    v_mfma_f32_16x16x32_bf16 v[68:71], v[188:191], v[96:99], v[68:71]
    ds_read_b128 v[96:99], v120 offset:29184
    v_mfma_f32_16x16x32_bf16 v[72:75], v[184:187], v[100:103], v[72:75]
    s_waitcnt vmcnt(14)
    s_barrier
    v_mfma_f32_16x16x32_bf16 v[72:75], v[192:195], v[88:91], v[72:75]
    ds_read_b64_tr_b16 v[208:209], v121 offset:0
    s_waitcnt lgkmcnt(2)
    v_mfma_f32_16x16x32_bf16 v[72:75], v[200:203], v[92:95], v[72:75]
    ds_read_b64_tr_b16 v[210:211], v121 offset:1024
    s_add_u32 m0, s21, 32768
    s_mov_b32 s29, 10240
    v_mfma_f32_16x16x32_bf16 v[76:79], v[204:207], v[92:95], v[76:79]
    buffer_load_dwordx4 v4, s[8:11], s29 offen lds
    ds_read_b64_tr_b16 v[212:213], v122 offset:0
    v_mfma_f32_16x16x32_bf16 v[76:79], v[196:199], v[88:91], v[76:79]
    ds_read_b64_tr_b16 v[214:215], v122 offset:1024
    v_mfma_f32_16x16x32_bf16 v[76:79], v[188:191], v[100:103], v[76:79]
    ds_read_b128 v[100:103], v120 offset:31232
    ds_read_b64_tr_b16 v[216:217], v121 offset:8192
    v_mfma_f32_16x16x32_bf16 v[80:83], v[184:187], v[88:91], v[80:83]
    ds_read_b64_tr_b16 v[218:219], v121 offset:9216
    v_mfma_f32_16x16x32_bf16 v[80:83], v[192:195], v[92:95], v[80:83]
    ds_read_b64_tr_b16 v[220:221], v122 offset:8192
    s_waitcnt lgkmcnt(8)
    v_mfma_f32_16x16x32_bf16 v[80:83], v[200:203], v[96:99], v[80:83]
    ds_read_b64_tr_b16 v[222:223], v122 offset:9216
    v_mfma_f32_16x16x32_bf16 v[84:87], v[204:207], v[96:99], v[84:87]
    ds_read_b64_tr_b16 v[224:225], v121 offset:16384
    v_mfma_f32_16x16x32_bf16 v[84:87], v[196:199], v[92:95], v[84:87]
    ds_read_b64_tr_b16 v[226:227], v121 offset:17408
    v_mfma_f32_16x16x32_bf16 v[84:87], v[188:191], v[88:91], v[84:87]
    ds_read_b128 v[88:91], v120 offset:32768
    ds_read_b64_tr_b16 v[228:229], v122 offset:16384
    v_mfma_f32_16x16x32_bf16 v[24:27], v[184:187], v[92:95], v[24:27]
    ds_read_b64_tr_b16 v[230:231], v122 offset:17408
    s_add_u32 m0, s21, 36864
    v_mfma_f32_16x16x32_bf16 v[24:27], v[192:195], v[96:99], v[24:27]
    buffer_load_dwordx4 v5, s[8:11], s29 offen lds
    s_waitcnt lgkmcnt(9)
    v_mfma_f32_16x16x32_bf16 v[24:27], v[200:203], v[100:103], v[24:27]
    v_mfma_f32_16x16x32_bf16 v[28:31], v[204:207], v[100:103], v[28:31]
    v_mfma_f32_16x16x32_bf16 v[28:31], v[196:199], v[96:99], v[28:31]
    v_mfma_f32_16x16x32_bf16 v[28:31], v[188:191], v[92:95], v[28:31]
    ds_read_b128 v[92:95], v120 offset:34816
    v_mfma_f32_16x16x32_bf16 v[32:35], v[184:187], v[96:99], v[32:35]
    v_mfma_f32_16x16x32_bf16 v[32:35], v[192:195], v[100:103], v[32:35]
    v_mfma_f32_16x16x32_bf16 v[36:39], v[196:199], v[100:103], v[36:39]
    v_mfma_f32_16x16x32_bf16 v[36:39], v[188:191], v[96:99], v[36:39]
    ds_read_b128 v[96:99], v120 offset:36864
    s_waitcnt lgkmcnt(2)
    v_mfma_f32_16x16x32_bf16 v[8:11], v[184:187], v[100:103], v[8:11]
    s_add_u32 m0, s21, 40960
    v_mfma_f32_16x16x32_bf16 v[12:15], v[188:191], v[100:103], v[12:15]
    ds_read_b128 v[100:103], v120 offset:38912
    v_mfma_f32_16x16x32_bf16 v[40:43], v[216:219], v[88:91], v[40:43]
    buffer_load_dwordx4 v6, s[8:11], s29 offen lds
    s_waitcnt lgkmcnt(2)
    v_mfma_f32_16x16x32_bf16 v[40:43], v[224:227], v[92:95], v[40:43]
    v_mfma_f32_16x16x32_bf16 v[44:47], v[228:231], v[92:95], v[44:47]
    v_mfma_f32_16x16x32_bf16 v[44:47], v[220:223], v[88:91], v[44:47]
    v_mfma_f32_16x16x32_bf16 v[48:51], v[208:211], v[88:91], v[48:51]
    v_mfma_f32_16x16x32_bf16 v[48:51], v[216:219], v[92:95], v[48:51]
    s_waitcnt lgkmcnt(1)
    v_mfma_f32_16x16x32_bf16 v[48:51], v[224:227], v[96:99], v[48:51]
    v_mfma_f32_16x16x32_bf16 v[52:55], v[228:231], v[96:99], v[52:55]
    v_mfma_f32_16x16x32_bf16 v[52:55], v[220:223], v[92:95], v[52:55]
    v_mfma_f32_16x16x32_bf16 v[52:55], v[212:215], v[88:91], v[52:55]
    ds_read_b128 v[88:91], v120 offset:40960
    s_add_u32 m0, s21, 45056
    v_mfma_f32_16x16x32_bf16 v[56:59], v[208:211], v[92:95], v[56:59]
    buffer_load_dwordx4 v7, s[8:11], s29 offen lds
    v_mfma_f32_16x16x32_bf16 v[56:59], v[216:219], v[96:99], v[56:59]
    s_waitcnt lgkmcnt(1)
    v_mfma_f32_16x16x32_bf16 v[56:59], v[224:227], v[100:103], v[56:59]
    v_mfma_f32_16x16x32_bf16 v[60:63], v[228:231], v[100:103], v[60:63]
    v_mfma_f32_16x16x32_bf16 v[60:63], v[220:223], v[96:99], v[60:63]
    v_mfma_f32_16x16x32_bf16 v[60:63], v[212:215], v[92:95], v[60:63]
    ds_read_b128 v[92:95], v120 offset:43008
    v_mfma_f32_16x16x32_bf16 v[64:67], v[208:211], v[96:99], v[64:67]
    v_mfma_f32_16x16x32_bf16 v[64:67], v[216:219], v[100:103], v[64:67]
    s_waitcnt lgkmcnt(1)
    v_mfma_f32_16x16x32_bf16 v[64:67], v[224:227], v[88:91], v[64:67]
    v_mfma_f32_16x16x32_bf16 v[68:71], v[228:231], v[88:91], v[68:71]
    s_add_u32 m0, s21, 49152
    s_mov_b32 s29, 11264
    v_mfma_f32_16x16x32_bf16 v[68:71], v[220:223], v[100:103], v[68:71]
    buffer_load_dwordx4 v4, s[8:11], s29 offen lds
    v_mfma_f32_16x16x32_bf16 v[68:71], v[212:215], v[96:99], v[68:71]
    ds_read_b128 v[96:99], v120 offset:45056
    v_mfma_f32_16x16x32_bf16 v[72:75], v[208:211], v[100:103], v[72:75]
    s_waitcnt vmcnt(9)
    s_barrier
    v_mfma_f32_16x16x32_bf16 v[72:75], v[216:219], v[88:91], v[72:75]
    ds_read_b64_tr_b16 v[232:233], v121 offset:24576
    s_waitcnt lgkmcnt(2)
    v_mfma_f32_16x16x32_bf16 v[72:75], v[224:227], v[92:95], v[72:75]
    ds_read_b64_tr_b16 v[234:235], v121 offset:25600
    v_mfma_f32_16x16x32_bf16 v[76:79], v[228:231], v[92:95], v[76:79]
    ds_read_b64_tr_b16 v[236:237], v122 offset:24576
    v_mfma_f32_16x16x32_bf16 v[76:79], v[220:223], v[88:91], v[76:79]
    ds_read_b64_tr_b16 v[238:239], v122 offset:25600
    v_mfma_f32_16x16x32_bf16 v[76:79], v[212:215], v[100:103], v[76:79]
    ds_read_b128 v[100:103], v120 offset:47104
    ds_read_b64_tr_b16 v[240:241], v121 offset:32768
    v_mfma_f32_16x16x32_bf16 v[80:83], v[208:211], v[88:91], v[80:83]
    ds_read_b64_tr_b16 v[242:243], v121 offset:33792
    v_mfma_f32_16x16x32_bf16 v[80:83], v[216:219], v[92:95], v[80:83]
    ds_read_b64_tr_b16 v[244:245], v122 offset:32768
    s_waitcnt lgkmcnt(8)
    v_mfma_f32_16x16x32_bf16 v[80:83], v[224:227], v[96:99], v[80:83]
    ds_read_b64_tr_b16 v[246:247], v122 offset:33792
    s_add_u32 m0, s21, 53248
    v_mfma_f32_16x16x32_bf16 v[84:87], v[228:231], v[96:99], v[84:87]
    buffer_load_dwordx4 v5, s[8:11], s29 offen lds
    ds_read_b64_tr_b16 v[248:249], v121 offset:40960
    v_mfma_f32_16x16x32_bf16 v[84:87], v[220:223], v[92:95], v[84:87]
    ds_read_b64_tr_b16 v[250:251], v121 offset:41984
    v_mfma_f32_16x16x32_bf16 v[84:87], v[212:215], v[88:91], v[84:87]
    ds_read_b128 v[88:91], v120 offset:33280
    ds_read_b64_tr_b16 v[252:253], v122 offset:40960
    v_mfma_f32_16x16x32_bf16 v[24:27], v[208:211], v[92:95], v[24:27]
    ds_read_b64_tr_b16 v[254:255], v122 offset:41984
    v_mfma_f32_16x16x32_bf16 v[24:27], v[216:219], v[96:99], v[24:27]
    s_waitcnt lgkmcnt(9)
    v_mfma_f32_16x16x32_bf16 v[24:27], v[224:227], v[100:103], v[24:27]
    v_mfma_f32_16x16x32_bf16 v[28:31], v[228:231], v[100:103], v[28:31]
    v_mfma_f32_16x16x32_bf16 v[28:31], v[220:223], v[96:99], v[28:31]
    v_mfma_f32_16x16x32_bf16 v[28:31], v[212:215], v[92:95], v[28:31]
    ds_read_b128 v[92:95], v120 offset:35328
    v_mfma_f32_16x16x32_bf16 v[32:35], v[208:211], v[96:99], v[32:35]
    s_add_u32 m0, s21, 57344
    v_mfma_f32_16x16x32_bf16 v[32:35], v[216:219], v[100:103], v[32:35]
    buffer_load_dwordx4 v6, s[8:11], s29 offen lds
    v_mfma_f32_16x16x32_bf16 v[36:39], v[220:223], v[100:103], v[36:39]
    v_mfma_f32_16x16x32_bf16 v[36:39], v[212:215], v[96:99], v[36:39]
    ds_read_b128 v[96:99], v120 offset:37376
    s_waitcnt lgkmcnt(2)
    v_mfma_f32_16x16x32_bf16 v[8:11], v[208:211], v[100:103], v[8:11]
    v_mfma_f32_16x16x32_bf16 v[12:15], v[212:215], v[100:103], v[12:15]
    ds_read_b128 v[100:103], v120 offset:39424
    v_mfma_f32_16x16x32_bf16 v[40:43], v[240:243], v[88:91], v[40:43]
    s_waitcnt lgkmcnt(2)
    v_mfma_f32_16x16x32_bf16 v[40:43], v[248:251], v[92:95], v[40:43]
    v_mfma_f32_16x16x32_bf16 v[44:47], v[252:255], v[92:95], v[44:47]
    v_mfma_f32_16x16x32_bf16 v[44:47], v[244:247], v[88:91], v[44:47]
    v_mfma_f32_16x16x32_bf16 v[48:51], v[232:235], v[88:91], v[48:51]
    s_add_u32 m0, s21, 61440
    v_mfma_f32_16x16x32_bf16 v[48:51], v[240:243], v[92:95], v[48:51]
    buffer_load_dwordx4 v7, s[8:11], s29 offen lds
    s_waitcnt lgkmcnt(1)
    v_mfma_f32_16x16x32_bf16 v[48:51], v[248:251], v[96:99], v[48:51]
    v_mfma_f32_16x16x32_bf16 v[52:55], v[252:255], v[96:99], v[52:55]
    v_mfma_f32_16x16x32_bf16 v[52:55], v[244:247], v[92:95], v[52:55]
    v_mfma_f32_16x16x32_bf16 v[52:55], v[236:239], v[88:91], v[52:55]
    ds_read_b128 v[88:91], v120 offset:41472
    v_mfma_f32_16x16x32_bf16 v[56:59], v[232:235], v[92:95], v[56:59]
    v_mfma_f32_16x16x32_bf16 v[56:59], v[240:243], v[96:99], v[56:59]
    s_waitcnt lgkmcnt(1)
    v_mfma_f32_16x16x32_bf16 v[56:59], v[248:251], v[100:103], v[56:59]
    v_mfma_f32_16x16x32_bf16 v[60:63], v[252:255], v[100:103], v[60:63]
    v_mfma_f32_16x16x32_bf16 v[60:63], v[244:247], v[96:99], v[60:63]
    s_add_u32 m0, s21, 65536
    s_mov_b32 s29, 12288
    v_mfma_f32_16x16x32_bf16 v[60:63], v[236:239], v[92:95], v[60:63]
    ds_read_b128 v[92:95], v120 offset:43520
    buffer_load_dwordx4 v4, s[8:11], s29 offen lds
    v_mfma_f32_16x16x32_bf16 v[64:67], v[232:235], v[96:99], v[64:67]
    v_mfma_f32_16x16x32_bf16 v[64:67], v[240:243], v[100:103], v[64:67]
    s_waitcnt lgkmcnt(1)
    v_mfma_f32_16x16x32_bf16 v[64:67], v[248:251], v[88:91], v[64:67]
    v_mfma_f32_16x16x32_bf16 v[68:71], v[252:255], v[88:91], v[68:71]
    v_mfma_f32_16x16x32_bf16 v[68:71], v[244:247], v[100:103], v[68:71]
    v_mfma_f32_16x16x32_bf16 v[68:71], v[236:239], v[96:99], v[68:71]
    ds_read_b128 v[96:99], v120 offset:45568
    v_mfma_f32_16x16x32_bf16 v[72:75], v[232:235], v[100:103], v[72:75]
    v_mfma_f32_16x16x32_bf16 v[72:75], v[240:243], v[88:91], v[72:75]
    s_waitcnt lgkmcnt(1)
    v_mfma_f32_16x16x32_bf16 v[72:75], v[248:251], v[92:95], v[72:75]
    s_add_u32 m0, s21, 69632
    v_mfma_f32_16x16x32_bf16 v[76:79], v[252:255], v[92:95], v[76:79]
    buffer_load_dwordx4 v5, s[8:11], s29 offen lds
    v_mfma_f32_16x16x32_bf16 v[76:79], v[244:247], v[88:91], v[76:79]
    v_mfma_f32_16x16x32_bf16 v[76:79], v[236:239], v[100:103], v[76:79]
    ds_read_b128 v[100:103], v120 offset:47616
    v_mfma_f32_16x16x32_bf16 v[80:83], v[232:235], v[88:91], v[80:83]
    v_mfma_f32_16x16x32_bf16 v[80:83], v[240:243], v[92:95], v[80:83]
    s_waitcnt lgkmcnt(1)
    v_mfma_f32_16x16x32_bf16 v[80:83], v[248:251], v[96:99], v[80:83]
    v_mfma_f32_16x16x32_bf16 v[84:87], v[252:255], v[96:99], v[84:87]
    v_mfma_f32_16x16x32_bf16 v[84:87], v[244:247], v[92:95], v[84:87]
    v_mfma_f32_16x16x32_bf16 v[84:87], v[236:239], v[88:91], v[84:87]
    ds_read_b128 v[88:91], v1 offset:0
    v_mfma_f32_16x16x32_bf16 v[24:27], v[232:235], v[92:95], v[24:27]
    s_add_u32 m0, s21, 73728
    v_mfma_f32_16x16x32_bf16 v[24:27], v[240:243], v[96:99], v[24:27]
    buffer_load_dwordx4 v6, s[8:11], s29 offen lds
    s_waitcnt lgkmcnt(1)
    v_mfma_f32_16x16x32_bf16 v[24:27], v[248:251], v[100:103], v[24:27]
    v_mfma_f32_16x16x32_bf16 v[28:31], v[252:255], v[100:103], v[28:31]
    v_mfma_f32_16x16x32_bf16 v[28:31], v[244:247], v[96:99], v[28:31]
    v_mfma_f32_16x16x32_bf16 v[28:31], v[236:239], v[92:95], v[28:31]
    ds_read_b128 v[92:95], v1 offset:256
    v_mfma_f32_16x16x32_bf16 v[32:35], v[232:235], v[96:99], v[32:35]
    v_mfma_f32_16x16x32_bf16 v[32:35], v[240:243], v[100:103], v[32:35]
    v_mfma_f32_16x16x32_bf16 v[36:39], v[244:247], v[100:103], v[36:39]
    v_mfma_f32_16x16x32_bf16 v[36:39], v[236:239], v[96:99], v[36:39]
    ds_read_b128 v[96:99], v1 offset:512
    v_mfma_f32_16x16x32_bf16 v[8:11], v[232:235], v[100:103], v[8:11]
    s_add_u32 m0, s21, 77824
    v_mfma_f32_16x16x32_bf16 v[12:15], v[236:239], v[100:103], v[12:15]
    ds_read_b128 v[100:103], v1 offset:768
L_steady:
    s_waitcnt lgkmcnt(3)
    v_mfma_f32_16x16x32_bf16 v[16:19], a[0:3], v[88:91], 0
    buffer_load_dwordx4 v7, s[8:11], s29 offen lds
    s_waitcnt lgkmcnt(2)
    v_mfma_f32_16x16x32_bf16 v[16:19], a[24:27], v[92:95], v[16:19]
    s_waitcnt vmcnt(12)
    s_barrier
    v_mfma_f32_16x16x32_bf16 v[20:23], a[28:31], v[92:95], 0
    v_mfma_f32_16x16x32_bf16 v[20:23], a[4:7], v[88:91], v[20:23]
    v_mfma_f32_16x16x32_bf16 v[8:11], a[8:11], v[88:91], v[8:11]
    v_mfma_f32_16x16x32_bf16 v[8:11], a[32:35], v[92:95], v[8:11]
    v_mfma_f32_16x16x32_bf16 v[12:15], a[36:39], v[92:95], v[12:15]
    v_mfma_f32_16x16x32_bf16 v[12:15], a[12:15], v[88:91], v[12:15]
    v_mfma_f32_16x16x32_bf16 v[32:35], a[16:19], v[88:91], v[32:35]
    v_fma_f32 v40, v40, v104, v112
    s_add_u32 m0, s21, 81920
    s_mov_b32 s29, 13312
    v_mfma_f32_16x16x32_bf16 v[32:35], a[40:43], v[92:95], v[32:35]
    buffer_load_dwordx4 v4, s[8:11], s29 offen lds
    v_mfma_f32_16x16x32_bf16 v[36:39], a[44:47], v[92:95], v[36:39]
    v_fma_f32 v41, v41, v105, v113
    v_mfma_f32_16x16x32_bf16 v[36:39], a[20:23], v[88:91], v[36:39]
    ds_read_b128 v[88:91], v1 offset:4096
    s_waitcnt lgkmcnt(2)
    v_mfma_f32_16x16x32_bf16 v[16:19], a[48:51], v[96:99], v[16:19]
    ds_read_b128 v[92:95], v1 offset:4352
    s_waitcnt lgkmcnt(2)
    v_mfma_f32_16x16x32_bf16 v[16:19], a[72:75], v[100:103], v[16:19]
    v_fma_f32 v42, v42, v106, v114
    v_mfma_f32_16x16x32_bf16 v[20:23], a[76:79], v[100:103], v[20:23]
    v_fma_f32 v43, v43, v107, v115
    v_mfma_f32_16x16x32_bf16 v[20:23], a[52:55], v[96:99], v[20:23]
    v_exp_f32 v120, v40
    v_mfma_f32_16x16x32_bf16 v[8:11], a[56:59], v[96:99], v[8:11]
    v_exp_f32 v121, v41
    v_mfma_f32_16x16x32_bf16 v[8:11], a[80:83], v[100:103], v[8:11]
    v_exp_f32 v122, v42
    s_add_u32 m0, s21, 86016
    v_mfma_f32_16x16x32_bf16 v[12:15], a[84:87], v[100:103], v[12:15]
    buffer_load_dwordx4 v5, s[8:11], s29 offen lds
    v_mfma_f32_16x16x32_bf16 v[12:15], a[60:63], v[96:99], v[12:15]
    v_exp_f32 v123, v43
    v_mfma_f32_16x16x32_bf16 v[32:35], a[64:67], v[96:99], v[32:35]
    v_fma_f32 v120, v120, s28, s28
    v_mfma_f32_16x16x32_bf16 v[32:35], a[88:91], v[100:103], v[32:35]
    v_fma_f32 v121, v121, s28, s28
    v_mfma_f32_16x16x32_bf16 v[36:39], a[92:95], v[100:103], v[36:39]
    v_fma_f32 v122, v122, s28, s28
    v_mfma_f32_16x16x32_bf16 v[36:39], a[68:71], v[96:99], v[36:39]
    ds_read_b128 v[96:99], v1 offset:4608
    s_waitcnt lgkmcnt(2)
    v_mfma_f32_16x16x32_bf16 v[16:19], a[96:99], v[88:91], v[16:19]
    ds_read_b128 v[100:103], v1 offset:4864
    s_waitcnt lgkmcnt(2)
    v_mfma_f32_16x16x32_bf16 v[16:19], a[120:123], v[92:95], v[16:19]
    v_fma_f32 v123, v123, s28, s28
    v_mfma_f32_16x16x32_bf16 v[20:23], a[124:127], v[92:95], v[20:23]
    v_rcp_f32 v120, v120
    s_add_u32 m0, s21, 90112
    v_mfma_f32_16x16x32_bf16 v[20:23], a[100:103], v[88:91], v[20:23]
    buffer_load_dwordx4 v6, s[8:11], s29 offen lds
    v_mfma_f32_16x16x32_bf16 v[8:11], a[104:107], v[88:91], v[8:11]
    v_rcp_f32 v121, v121
    v_mfma_f32_16x16x32_bf16 v[8:11], a[128:131], v[92:95], v[8:11]
    v_rcp_f32 v122, v122
    v_mfma_f32_16x16x32_bf16 v[12:15], a[132:135], v[92:95], v[12:15]
    v_rcp_f32 v123, v123
    v_mfma_f32_16x16x32_bf16 v[12:15], a[108:111], v[88:91], v[12:15]
    v_mul_f32 v40, v40, v120
    v_mfma_f32_16x16x32_bf16 v[32:35], a[112:115], v[88:91], v[32:35]
    v_mul_f32 v41, v41, v121
    v_mfma_f32_16x16x32_bf16 v[32:35], a[136:139], v[92:95], v[32:35]
    v_mul_f32 v42, v42, v122
    v_mfma_f32_16x16x32_bf16 v[36:39], a[140:143], v[92:95], v[36:39]
    v_mul_f32 v43, v43, v123
    v_mfma_f32_16x16x32_bf16 v[36:39], a[116:119], v[88:91], v[36:39]
    ds_read_b128 v[88:91], v1 offset:8192
    s_waitcnt lgkmcnt(2)
    v_mfma_f32_16x16x32_bf16 v[16:19], a[144:147], v[96:99], v[16:19]
    ds_read_b128 v[92:95], v1 offset:8448
    s_waitcnt lgkmcnt(2)
    v_mfma_f32_16x16x32_bf16 v[16:19], a[168:171], v[100:103], v[16:19]
    v_cvt_pk_bf16_f32 v40, v40, v41
    s_add_u32 m0, s21, 94208
    v_mfma_f32_16x16x32_bf16 v[20:23], a[172:175], v[100:103], v[20:23]
    buffer_load_dwordx4 v7, s[8:11], s29 offen lds
    v_mfma_f32_16x16x32_bf16 v[20:23], a[148:151], v[96:99], v[20:23]
    v_cvt_pk_bf16_f32 v41, v42, v43
    v_mfma_f32_16x16x32_bf16 v[8:11], a[152:155], v[96:99], v[8:11]
    v_fma_f32 v24, v24, v104, v112
    v_mfma_f32_16x16x32_bf16 v[8:11], a[176:179], v[100:103], v[8:11]
    v_fma_f32 v25, v25, v105, v113
    v_mfma_f32_16x16x32_bf16 v[12:15], a[180:183], v[100:103], v[12:15]
    v_fma_f32 v26, v26, v106, v114
    v_mfma_f32_16x16x32_bf16 v[12:15], a[156:159], v[96:99], v[12:15]
    v_fma_f32 v27, v27, v107, v115
    v_mfma_f32_16x16x32_bf16 v[32:35], a[160:163], v[96:99], v[32:35]
    v_fma_f32 v28, v28, v108, v116
    v_mfma_f32_16x16x32_bf16 v[32:35], a[184:187], v[100:103], v[32:35]
    v_fma_f32 v29, v29, v109, v117
    v_mfma_f32_16x16x32_bf16 v[36:39], a[188:191], v[100:103], v[36:39]
    v_fma_f32 v30, v30, v110, v118
    s_add_u32 m0, s21, 98304
    s_mov_b32 s29, 14336
    v_mfma_f32_16x16x32_bf16 v[36:39], a[164:167], v[96:99], v[36:39]
    ds_read_b128 v[96:99], v1 offset:8704
    s_waitcnt lgkmcnt(2)
    v_mfma_f32_16x16x32_bf16 v[16:19], a[192:195], v[88:91], v[16:19]
    ds_read_b128 v[100:103], v1 offset:8960
    s_waitcnt lgkmcnt(2)
    v_mfma_f32_16x16x32_bf16 v[16:19], a[216:219], v[92:95], v[16:19]
    buffer_load_dwordx4 v4, s[8:11], s29 offen lds
    v_mfma_f32_16x16x32_bf16 v[20:23], a[220:223], v[92:95], v[20:23]
    v_fma_f32 v31, v31, v111, v119
    v_mfma_f32_16x16x32_bf16 v[20:23], a[196:199], v[88:91], v[20:23]
    v_exp_f32 v120, v24
    v_mfma_f32_16x16x32_bf16 v[8:11], a[200:203], v[88:91], v[8:11]
    v_exp_f32 v121, v25
    v_mfma_f32_16x16x32_bf16 v[8:11], a[224:227], v[92:95], v[8:11]
    v_exp_f32 v122, v26
    v_mfma_f32_16x16x32_bf16 v[12:15], a[228:231], v[92:95], v[12:15]
    v_exp_f32 v123, v27
    v_mfma_f32_16x16x32_bf16 v[12:15], a[204:207], v[88:91], v[12:15]
    v_exp_f32 v124, v28
    v_mfma_f32_16x16x32_bf16 v[32:35], a[208:211], v[88:91], v[32:35]
    v_exp_f32 v125, v29
    v_mfma_f32_16x16x32_bf16 v[32:35], a[232:235], v[92:95], v[32:35]
    v_exp_f32 v126, v30
    v_mfma_f32_16x16x32_bf16 v[36:39], a[236:239], v[92:95], v[36:39]
    v_exp_f32 v127, v31
    v_mfma_f32_16x16x32_bf16 v[36:39], a[212:215], v[88:91], v[36:39]
    ds_read_b128 v[88:91], v1 offset:12288
    s_waitcnt lgkmcnt(2)
    v_mfma_f32_16x16x32_bf16 v[16:19], a[240:243], v[96:99], v[16:19]
    ds_read_b128 v[92:95], v1 offset:12544
    s_waitcnt lgkmcnt(2)
    v_mfma_f32_16x16x32_bf16 v[16:19], v[136:139], v[100:103], v[16:19]
    v_fma_f32 v120, v120, s28, s28
    v_mfma_f32_16x16x32_bf16 v[20:23], v[140:143], v[100:103], v[20:23]
    v_fma_f32 v121, v121, s28, s28
    v_mfma_f32_16x16x32_bf16 v[20:23], a[244:247], v[96:99], v[20:23]
    v_fma_f32 v122, v122, s28, s28
    v_mfma_f32_16x16x32_bf16 v[8:11], a[248:251], v[96:99], v[8:11]
    v_fma_f32 v123, v123, s28, s28
    v_mfma_f32_16x16x32_bf16 v[8:11], v[144:147], v[100:103], v[8:11]
    v_fma_f32 v124, v124, s28, s28
    v_mfma_f32_16x16x32_bf16 v[12:15], v[148:151], v[100:103], v[12:15]
    v_fma_f32 v125, v125, s28, s28
    v_mfma_f32_16x16x32_bf16 v[12:15], a[252:255], v[96:99], v[12:15]
    v_fma_f32 v126, v126, s28, s28
    v_mfma_f32_16x16x32_bf16 v[32:35], v[128:131], v[96:99], v[32:35]
    v_fma_f32 v127, v127, s28, s28
    v_mfma_f32_16x16x32_bf16 v[32:35], v[152:155], v[100:103], v[32:35]
    v_rcp_f32 v120, v120
    v_mfma_f32_16x16x32_bf16 v[36:39], v[156:159], v[100:103], v[36:39]
    v_rcp_f32 v121, v121
    v_mfma_f32_16x16x32_bf16 v[36:39], v[132:135], v[96:99], v[36:39]
    ds_read_b128 v[96:99], v1 offset:12800
    s_waitcnt lgkmcnt(2)
    v_mfma_f32_16x16x32_bf16 v[16:19], v[160:163], v[88:91], v[16:19]
    ds_read_b128 v[100:103], v1 offset:13056
    s_waitcnt lgkmcnt(2)
    v_mfma_f32_16x16x32_bf16 v[16:19], v[184:187], v[92:95], v[16:19]
    v_rcp_f32 v122, v122
    v_mfma_f32_16x16x32_bf16 v[20:23], v[188:191], v[92:95], v[20:23]
    v_rcp_f32 v123, v123
    v_mfma_f32_16x16x32_bf16 v[20:23], v[164:167], v[88:91], v[20:23]
    v_rcp_f32 v124, v124
    v_mfma_f32_16x16x32_bf16 v[8:11], v[168:171], v[88:91], v[8:11]
    v_rcp_f32 v125, v125
    v_mfma_f32_16x16x32_bf16 v[8:11], v[192:195], v[92:95], v[8:11]
    v_rcp_f32 v126, v126
    v_mfma_f32_16x16x32_bf16 v[12:15], v[196:199], v[92:95], v[12:15]
    v_rcp_f32 v127, v127
    v_mfma_f32_16x16x32_bf16 v[12:15], v[172:175], v[88:91], v[12:15]
    v_mul_f32 v24, v24, v120
    v_mfma_f32_16x16x32_bf16 v[32:35], v[176:179], v[88:91], v[32:35]
    v_mul_f32 v25, v25, v121
    v_mfma_f32_16x16x32_bf16 v[32:35], v[200:203], v[92:95], v[32:35]
    v_mul_f32 v26, v26, v122
    v_mfma_f32_16x16x32_bf16 v[36:39], v[204:207], v[92:95], v[36:39]
    v_mul_f32 v27, v27, v123
    v_mfma_f32_16x16x32_bf16 v[36:39], v[180:183], v[88:91], v[36:39]
    ds_read_b128 v[88:91], v1 offset:16384
    s_waitcnt lgkmcnt(2)
    v_mfma_f32_16x16x32_bf16 v[16:19], v[208:211], v[96:99], v[16:19]
    ds_read_b128 v[92:95], v1 offset:16640
    s_waitcnt lgkmcnt(2)
    v_mfma_f32_16x16x32_bf16 v[16:19], v[232:235], v[100:103], v[16:19]
    v_mul_f32 v28, v28, v124
    v_mfma_f32_16x16x32_bf16 v[20:23], v[236:239], v[100:103], v[20:23]
    v_mul_f32 v29, v29, v125
    v_mfma_f32_16x16x32_bf16 v[20:23], v[212:215], v[96:99], v[20:23]
    v_mul_f32 v30, v30, v126
    v_mfma_f32_16x16x32_bf16 v[8:11], v[216:219], v[96:99], v[8:11]
    v_mul_f32 v31, v31, v127
    v_mfma_f32_16x16x32_bf16 v[8:11], v[240:243], v[100:103], v[8:11]
    v_cvt_pk_bf16_f32 v24, v24, v25
    v_mfma_f32_16x16x32_bf16 v[12:15], v[244:247], v[100:103], v[12:15]
    v_cvt_pk_bf16_f32 v25, v26, v27
    v_mfma_f32_16x16x32_bf16 v[12:15], v[220:223], v[96:99], v[12:15]
    v_cvt_pk_bf16_f32 v26, v28, v29
    v_mfma_f32_16x16x32_bf16 v[32:35], v[224:227], v[96:99], v[32:35]
    v_cvt_pk_bf16_f32 v27, v30, v31
    v_mfma_f32_16x16x32_bf16 v[32:35], v[248:251], v[100:103], v[32:35]
    v_mfma_f32_16x16x32_bf16 v[36:39], v[252:255], v[100:103], v[36:39]
    v_permlane16_swap_b32 v24, v26
    v_mfma_f32_16x16x32_bf16 v[36:39], v[228:231], v[96:99], v[36:39]
    ds_read_b128 v[96:99], v1 offset:16896
    s_nop 1
    v_permlane16_swap_b32 v25, v27
    s_mov_b32 s22, 6144
    s_nop 1
    buffer_store_dwordx4 v[24:27], v3, s[16:19], s22 offen nt
    s_nop 1
    s_waitcnt lgkmcnt(2)
    v_mfma_f32_16x16x32_bf16 v[24:27], a[0:3], v[88:91], 0
    ds_read_b128 v[100:103], v1 offset:17152
    s_waitcnt lgkmcnt(2)
    v_mfma_f32_16x16x32_bf16 v[24:27], a[24:27], v[92:95], v[24:27]
    s_waitcnt vmcnt(14)
    v_fma_f32 v44, v44, v108, v116
    v_mfma_f32_16x16x32_bf16 v[28:31], a[28:31], v[92:95], 0
    s_barrier
    s_add_u32 m0, s21, 102400
    v_mfma_f32_16x16x32_bf16 v[28:31], a[4:7], v[88:91], v[28:31]
    buffer_load_dwordx4 v5, s[8:11], s29 offen lds
    v_mfma_f32_16x16x32_bf16 v[16:19], a[8:11], v[88:91], v[16:19]
    v_fma_f32 v45, v45, v109, v117
    v_mfma_f32_16x16x32_bf16 v[16:19], a[32:35], v[92:95], v[16:19]
    v_fma_f32 v46, v46, v110, v118
    v_mfma_f32_16x16x32_bf16 v[20:23], a[36:39], v[92:95], v[20:23]
    v_fma_f32 v47, v47, v111, v119
    v_mfma_f32_16x16x32_bf16 v[20:23], a[12:15], v[88:91], v[20:23]
    v_exp_f32 v124, v44
    v_mfma_f32_16x16x32_bf16 v[8:11], a[16:19], v[88:91], v[8:11]
    v_exp_f32 v125, v45
    v_mfma_f32_16x16x32_bf16 v[8:11], a[40:43], v[92:95], v[8:11]
    v_exp_f32 v126, v46
    v_mfma_f32_16x16x32_bf16 v[12:15], a[44:47], v[92:95], v[12:15]
    v_exp_f32 v127, v47
    v_mfma_f32_16x16x32_bf16 v[12:15], a[20:23], v[88:91], v[12:15]
    ds_read_b128 v[88:91], v1 offset:20480
    s_waitcnt lgkmcnt(2)
    v_mfma_f32_16x16x32_bf16 v[24:27], a[48:51], v[96:99], v[24:27]
    ds_read_b128 v[92:95], v1 offset:20736
    s_waitcnt lgkmcnt(2)
    v_mfma_f32_16x16x32_bf16 v[24:27], a[72:75], v[100:103], v[24:27]
    v_fma_f32 v124, v124, s28, s28
    s_add_u32 m0, s21, 106496
    v_mfma_f32_16x16x32_bf16 v[28:31], a[76:79], v[100:103], v[28:31]
    buffer_load_dwordx4 v6, s[8:11], s29 offen lds
    v_mfma_f32_16x16x32_bf16 v[28:31], a[52:55], v[96:99], v[28:31]
    v_fma_f32 v125, v125, s28, s28
    v_mfma_f32_16x16x32_bf16 v[16:19], a[56:59], v[96:99], v[16:19]
    v_fma_f32 v126, v126, s28, s28
    v_mfma_f32_16x16x32_bf16 v[16:19], a[80:83], v[100:103], v[16:19]
    v_fma_f32 v127, v127, s28, s28
    v_mfma_f32_16x16x32_bf16 v[20:23], a[84:87], v[100:103], v[20:23]
    v_rcp_f32 v124, v124
    v_mfma_f32_16x16x32_bf16 v[20:23], a[60:63], v[96:99], v[20:23]
    v_rcp_f32 v125, v125
    v_mfma_f32_16x16x32_bf16 v[8:11], a[64:67], v[96:99], v[8:11]
    v_rcp_f32 v126, v126
    v_mfma_f32_16x16x32_bf16 v[8:11], a[88:91], v[100:103], v[8:11]
    v_rcp_f32 v127, v127
    v_mfma_f32_16x16x32_bf16 v[12:15], a[92:95], v[100:103], v[12:15]
    v_mul_f32 v44, v44, v124
    s_add_u32 m0, s21, 110592
    v_mfma_f32_16x16x32_bf16 v[12:15], a[68:71], v[96:99], v[12:15]
    ds_read_b128 v[96:99], v1 offset:20992
    s_waitcnt lgkmcnt(2)
    v_mfma_f32_16x16x32_bf16 v[24:27], a[96:99], v[88:91], v[24:27]
    ds_read_b128 v[100:103], v1 offset:21248
    s_waitcnt lgkmcnt(2)
    v_mfma_f32_16x16x32_bf16 v[24:27], a[120:123], v[92:95], v[24:27]
    buffer_load_dwordx4 v7, s[8:11], s29 offen lds
    v_mfma_f32_16x16x32_bf16 v[28:31], a[124:127], v[92:95], v[28:31]
    v_mul_f32 v45, v45, v125
    v_mfma_f32_16x16x32_bf16 v[28:31], a[100:103], v[88:91], v[28:31]
    v_mul_f32 v46, v46, v126
    v_mfma_f32_16x16x32_bf16 v[16:19], a[104:107], v[88:91], v[16:19]
    v_mul_f32 v47, v47, v127
    v_mfma_f32_16x16x32_bf16 v[16:19], a[128:131], v[92:95], v[16:19]
    v_cvt_pk_bf16_f32 v42, v44, v45
    v_mfma_f32_16x16x32_bf16 v[20:23], a[132:135], v[92:95], v[20:23]
    v_cvt_pk_bf16_f32 v43, v46, v47
    v_mfma_f32_16x16x32_bf16 v[20:23], a[108:111], v[88:91], v[20:23]
    v_mfma_f32_16x16x32_bf16 v[8:11], a[112:115], v[88:91], v[8:11]
    v_permlane16_swap_b32 v40, v42
    v_mfma_f32_16x16x32_bf16 v[8:11], a[136:139], v[92:95], v[8:11]
    v_permlane16_swap_b32 v41, v43
    s_add_u32 m0, s21, 114688
    s_mov_b32 s29, 15360
    v_mfma_f32_16x16x32_bf16 v[12:15], a[140:143], v[92:95], v[12:15]
    buffer_load_dwordx4 v4, s[8:11], s29 offen lds
    s_mov_b32 s22, 0
    v_mfma_f32_16x16x32_bf16 v[12:15], a[116:119], v[88:91], v[12:15]
    ds_read_b128 v[88:91], v1 offset:24576
    s_waitcnt lgkmcnt(2)
    v_mfma_f32_16x16x32_bf16 v[24:27], a[144:147], v[96:99], v[24:27]
    ds_read_b128 v[92:95], v1 offset:24832
    s_waitcnt lgkmcnt(2)
    v_mfma_f32_16x16x32_bf16 v[24:27], a[168:171], v[100:103], v[24:27]
    buffer_store_dwordx4 v[40:43], v3, s[16:19], s22 offen nt
    v_mfma_f32_16x16x32_bf16 v[28:31], a[172:175], v[100:103], v[28:31]
    v_fma_f32 v32, v32, v104, v112
    v_mfma_f32_16x16x32_bf16 v[28:31], a[148:151], v[96:99], v[28:31]
    v_fma_f32 v33, v33, v105, v113
    v_mfma_f32_16x16x32_bf16 v[16:19], a[152:155], v[96:99], v[16:19]
    v_fma_f32 v34, v34, v106, v114
    v_mfma_f32_16x16x32_bf16 v[16:19], a[176:179], v[100:103], v[16:19]
    v_fma_f32 v35, v35, v107, v115
    v_mfma_f32_16x16x32_bf16 v[20:23], a[180:183], v[100:103], v[20:23]
    v_fma_f32 v36, v36, v108, v116
    s_add_u32 m0, s21, 118784
    v_mfma_f32_16x16x32_bf16 v[20:23], a[156:159], v[96:99], v[20:23]
    buffer_load_dwordx4 v5, s[8:11], s29 offen lds
    v_mfma_f32_16x16x32_bf16 v[8:11], a[160:163], v[96:99], v[8:11]
    v_fma_f32 v37, v37, v109, v117
    v_mfma_f32_16x16x32_bf16 v[8:11], a[184:187], v[100:103], v[8:11]
    v_fma_f32 v38, v38, v110, v118
    v_mfma_f32_16x16x32_bf16 v[12:15], a[188:191], v[100:103], v[12:15]
    v_fma_f32 v39, v39, v111, v119
    v_mfma_f32_16x16x32_bf16 v[12:15], a[164:167], v[96:99], v[12:15]
    ds_read_b128 v[96:99], v1 offset:25088
    s_waitcnt lgkmcnt(2)
    v_mfma_f32_16x16x32_bf16 v[24:27], a[192:195], v[88:91], v[24:27]
    ds_read_b128 v[100:103], v1 offset:25344
    s_waitcnt lgkmcnt(2)
    v_mfma_f32_16x16x32_bf16 v[24:27], a[216:219], v[92:95], v[24:27]
    v_exp_f32 v120, v32
    v_mfma_f32_16x16x32_bf16 v[28:31], a[220:223], v[92:95], v[28:31]
    v_exp_f32 v121, v33
    v_mfma_f32_16x16x32_bf16 v[28:31], a[196:199], v[88:91], v[28:31]
    v_exp_f32 v122, v34
    s_add_u32 m0, s21, 122880
    v_mfma_f32_16x16x32_bf16 v[16:19], a[200:203], v[88:91], v[16:19]
    buffer_load_dwordx4 v6, s[8:11], s29 offen lds
    v_mfma_f32_16x16x32_bf16 v[16:19], a[224:227], v[92:95], v[16:19]
    v_exp_f32 v123, v35
    v_mfma_f32_16x16x32_bf16 v[20:23], a[228:231], v[92:95], v[20:23]
    v_exp_f32 v124, v36
    v_mfma_f32_16x16x32_bf16 v[20:23], a[204:207], v[88:91], v[20:23]
    v_exp_f32 v125, v37
    v_mfma_f32_16x16x32_bf16 v[8:11], a[208:211], v[88:91], v[8:11]
    v_exp_f32 v126, v38
    v_mfma_f32_16x16x32_bf16 v[8:11], a[232:235], v[92:95], v[8:11]
    v_exp_f32 v127, v39
    v_mfma_f32_16x16x32_bf16 v[12:15], a[236:239], v[92:95], v[12:15]
    v_fma_f32 v120, v120, s28, s28
    v_mfma_f32_16x16x32_bf16 v[12:15], a[212:215], v[88:91], v[12:15]
    ds_read_b128 v[88:91], v1 offset:28672
    s_waitcnt lgkmcnt(2)
    v_mfma_f32_16x16x32_bf16 v[24:27], a[240:243], v[96:99], v[24:27]
    ds_read_b128 v[92:95], v1 offset:28928
    s_waitcnt lgkmcnt(2)
    v_mfma_f32_16x16x32_bf16 v[24:27], v[136:139], v[100:103], v[24:27]
    v_fma_f32 v121, v121, s28, s28
    v_mfma_f32_16x16x32_bf16 v[28:31], v[140:143], v[100:103], v[28:31]
    v_fma_f32 v122, v122, s28, s28
    v_mfma_f32_16x16x32_bf16 v[28:31], a[244:247], v[96:99], v[28:31]
    v_fma_f32 v123, v123, s28, s28
    v_mfma_f32_16x16x32_bf16 v[16:19], a[248:251], v[96:99], v[16:19]
    v_fma_f32 v124, v124, s28, s28
    v_mfma_f32_16x16x32_bf16 v[16:19], v[144:147], v[100:103], v[16:19]
    v_fma_f32 v125, v125, s28, s28
    v_mfma_f32_16x16x32_bf16 v[20:23], v[148:151], v[100:103], v[20:23]
    v_fma_f32 v126, v126, s28, s28
    v_mfma_f32_16x16x32_bf16 v[20:23], a[252:255], v[96:99], v[20:23]
    v_fma_f32 v127, v127, s28, s28
    v_mfma_f32_16x16x32_bf16 v[8:11], v[128:131], v[96:99], v[8:11]
    v_rcp_f32 v120, v120
    v_mfma_f32_16x16x32_bf16 v[8:11], v[152:155], v[100:103], v[8:11]
    v_rcp_f32 v121, v121
    v_mfma_f32_16x16x32_bf16 v[12:15], v[156:159], v[100:103], v[12:15]
    v_rcp_f32 v122, v122
    v_mfma_f32_16x16x32_bf16 v[12:15], v[132:135], v[96:99], v[12:15]
    ds_read_b128 v[96:99], v1 offset:29184
    s_waitcnt lgkmcnt(2)
    v_mfma_f32_16x16x32_bf16 v[24:27], v[160:163], v[88:91], v[24:27]
    ds_read_b128 v[100:103], v1 offset:29440
    s_waitcnt lgkmcnt(2)
    v_mfma_f32_16x16x32_bf16 v[24:27], v[184:187], v[92:95], v[24:27]
    v_rcp_f32 v123, v123
    v_mfma_f32_16x16x32_bf16 v[28:31], v[188:191], v[92:95], v[28:31]
    v_rcp_f32 v124, v124
    v_mfma_f32_16x16x32_bf16 v[28:31], v[164:167], v[88:91], v[28:31]
    v_rcp_f32 v125, v125
    v_mfma_f32_16x16x32_bf16 v[16:19], v[168:171], v[88:91], v[16:19]
    v_rcp_f32 v126, v126
    v_mfma_f32_16x16x32_bf16 v[16:19], v[192:195], v[92:95], v[16:19]
    v_rcp_f32 v127, v127
    v_mfma_f32_16x16x32_bf16 v[20:23], v[196:199], v[92:95], v[20:23]
    v_mul_f32 v32, v32, v120
    v_mfma_f32_16x16x32_bf16 v[20:23], v[172:175], v[88:91], v[20:23]
    v_mul_f32 v33, v33, v121
    v_mfma_f32_16x16x32_bf16 v[8:11], v[176:179], v[88:91], v[8:11]
    v_mul_f32 v34, v34, v122
    v_mfma_f32_16x16x32_bf16 v[8:11], v[200:203], v[92:95], v[8:11]
    v_mul_f32 v35, v35, v123
    v_mfma_f32_16x16x32_bf16 v[12:15], v[204:207], v[92:95], v[12:15]
    v_mul_f32 v36, v36, v124
    v_mfma_f32_16x16x32_bf16 v[12:15], v[180:183], v[88:91], v[12:15]
    ds_read_b128 v[88:91], v1 offset:32768
    s_waitcnt lgkmcnt(2)
    v_mfma_f32_16x16x32_bf16 v[24:27], v[208:211], v[96:99], v[24:27]
    ds_read_b128 v[92:95], v1 offset:33024
    s_waitcnt lgkmcnt(2)
    v_mfma_f32_16x16x32_bf16 v[24:27], v[232:235], v[100:103], v[24:27]
    v_mul_f32 v37, v37, v125
    v_mfma_f32_16x16x32_bf16 v[28:31], v[236:239], v[100:103], v[28:31]
    v_mul_f32 v38, v38, v126
    v_mfma_f32_16x16x32_bf16 v[28:31], v[212:215], v[96:99], v[28:31]
    v_mul_f32 v39, v39, v127
    v_mfma_f32_16x16x32_bf16 v[16:19], v[216:219], v[96:99], v[16:19]
    v_cvt_pk_bf16_f32 v32, v32, v33
    v_mfma_f32_16x16x32_bf16 v[16:19], v[240:243], v[100:103], v[16:19]
    v_cvt_pk_bf16_f32 v33, v34, v35
    v_mfma_f32_16x16x32_bf16 v[20:23], v[244:247], v[100:103], v[20:23]
    v_cvt_pk_bf16_f32 v34, v36, v37
    v_mfma_f32_16x16x32_bf16 v[20:23], v[220:223], v[96:99], v[20:23]
    v_cvt_pk_bf16_f32 v35, v38, v39
    v_mfma_f32_16x16x32_bf16 v[8:11], v[224:227], v[96:99], v[8:11]
    v_mfma_f32_16x16x32_bf16 v[8:11], v[248:251], v[100:103], v[8:11]
    v_permlane16_swap_b32 v32, v34
    v_mfma_f32_16x16x32_bf16 v[12:15], v[252:255], v[100:103], v[12:15]
    v_permlane16_swap_b32 v33, v35
    s_mov_b32 s22, 7168
    v_mfma_f32_16x16x32_bf16 v[12:15], v[228:231], v[96:99], v[12:15]
    ds_read_b128 v[96:99], v1 offset:33280
    s_nop 1
    buffer_store_dwordx4 v[32:35], v3, s[16:19], s22 offen nt
    s_nop 1
    s_waitcnt lgkmcnt(2)
    v_mfma_f32_16x16x32_bf16 v[32:35], a[0:3], v[88:91], 0
    ds_read_b128 v[100:103], v1 offset:33536
    s_waitcnt lgkmcnt(2)
    v_mfma_f32_16x16x32_bf16 v[32:35], a[24:27], v[92:95], v[32:35]
    s_waitcnt vmcnt(14)
    v_fma_f32 v48, v48, v104, v112
    v_mfma_f32_16x16x32_bf16 v[36:39], a[28:31], v[92:95], 0
    s_barrier
    s_add_u32 m0, s21, 126976
    v_mfma_f32_16x16x32_bf16 v[36:39], a[4:7], v[88:91], v[36:39]
    buffer_load_dwordx4 v7, s[8:11], s29 offen lds
    v_mfma_f32_16x16x32_bf16 v[24:27], a[8:11], v[88:91], v[24:27]
    v_fma_f32 v49, v49, v105, v113
    v_mfma_f32_16x16x32_bf16 v[24:27], a[32:35], v[92:95], v[24:27]
    v_fma_f32 v50, v50, v106, v114
    v_mfma_f32_16x16x32_bf16 v[28:31], a[36:39], v[92:95], v[28:31]
    v_fma_f32 v51, v51, v107, v115
    v_mfma_f32_16x16x32_bf16 v[28:31], a[12:15], v[88:91], v[28:31]
    v_exp_f32 v120, v48
    v_mfma_f32_16x16x32_bf16 v[16:19], a[16:19], v[88:91], v[16:19]
    v_exp_f32 v121, v49
    v_mfma_f32_16x16x32_bf16 v[16:19], a[40:43], v[92:95], v[16:19]
    v_exp_f32 v122, v50
    v_mfma_f32_16x16x32_bf16 v[20:23], a[44:47], v[92:95], v[20:23]
    v_exp_f32 v123, v51
    v_mfma_f32_16x16x32_bf16 v[20:23], a[20:23], v[88:91], v[20:23]
    ds_read_b128 v[88:91], v1 offset:36864
    s_waitcnt lgkmcnt(2)
    v_mfma_f32_16x16x32_bf16 v[32:35], a[48:51], v[96:99], v[32:35]
    ds_read_b128 v[92:95], v1 offset:37120
    s_waitcnt lgkmcnt(2)
    v_mfma_f32_16x16x32_bf16 v[32:35], a[72:75], v[100:103], v[32:35]
    v_fma_f32 v120, v120, s28, s28
    s_add_u32 m0, s21, 131072
    s_mov_b32 s29, L_steady+16384-L_pc
    v_mfma_f32_16x16x32_bf16 v[36:39], a[76:79], v[100:103], v[36:39]
    buffer_load_dword v0, s[64:67], s29 offen lds
    v_mfma_f32_16x16x32_bf16 v[36:39], a[52:55], v[96:99], v[36:39]
    v_fma_f32 v121, v121, s28, s28
    v_mfma_f32_16x16x32_bf16 v[24:27], a[56:59], v[96:99], v[24:27]
    v_fma_f32 v122, v122, s28, s28
    v_mfma_f32_16x16x32_bf16 v[24:27], a[80:83], v[100:103], v[24:27]
    v_fma_f32 v123, v123, s28, s28
    v_mfma_f32_16x16x32_bf16 v[28:31], a[84:87], v[100:103], v[28:31]
    v_rcp_f32 v120, v120
    v_mfma_f32_16x16x32_bf16 v[28:31], a[60:63], v[96:99], v[28:31]
    v_rcp_f32 v121, v121
    v_mfma_f32_16x16x32_bf16 v[16:19], a[64:67], v[96:99], v[16:19]
    v_rcp_f32 v122, v122
    v_mfma_f32_16x16x32_bf16 v[16:19], a[88:91], v[100:103], v[16:19]
    v_rcp_f32 v123, v123
    v_mfma_f32_16x16x32_bf16 v[20:23], a[92:95], v[100:103], v[20:23]
    v_mul_f32 v48, v48, v120
    s_add_u32 m0, s21, 0
    s_mov_b32 s29, 16384
    v_mfma_f32_16x16x32_bf16 v[20:23], a[68:71], v[96:99], v[20:23]
    ds_read_b128 v[96:99], v1 offset:37376
    s_waitcnt lgkmcnt(2)
    v_mfma_f32_16x16x32_bf16 v[32:35], a[96:99], v[88:91], v[32:35]
    ds_read_b128 v[100:103], v1 offset:37632
    s_waitcnt lgkmcnt(2)
    v_mfma_f32_16x16x32_bf16 v[32:35], a[120:123], v[92:95], v[32:35]
    buffer_load_dwordx4 v4, s[8:11], s29 offen lds
    v_mfma_f32_16x16x32_bf16 v[36:39], a[124:127], v[92:95], v[36:39]
    v_mul_f32 v49, v49, v121
    v_mfma_f32_16x16x32_bf16 v[36:39], a[100:103], v[88:91], v[36:39]
    v_mul_f32 v50, v50, v122
    v_mfma_f32_16x16x32_bf16 v[24:27], a[104:107], v[88:91], v[24:27]
    v_mul_f32 v51, v51, v123
    v_mfma_f32_16x16x32_bf16 v[24:27], a[128:131], v[92:95], v[24:27]
    v_cvt_pk_bf16_f32 v48, v48, v49
    v_mfma_f32_16x16x32_bf16 v[28:31], a[132:135], v[92:95], v[28:31]
    v_cvt_pk_bf16_f32 v49, v50, v51
    v_mfma_f32_16x16x32_bf16 v[28:31], a[108:111], v[88:91], v[28:31]
    v_fma_f32 v8, v8, v104, v112
    v_mfma_f32_16x16x32_bf16 v[16:19], a[112:115], v[88:91], v[16:19]
    v_fma_f32 v9, v9, v105, v113
    v_mfma_f32_16x16x32_bf16 v[16:19], a[136:139], v[92:95], v[16:19]
    v_fma_f32 v10, v10, v106, v114
    s_add_u32 m0, s21, 4096
    v_mfma_f32_16x16x32_bf16 v[20:23], a[140:143], v[92:95], v[20:23]
    buffer_load_dwordx4 v5, s[8:11], s29 offen lds
    v_mfma_f32_16x16x32_bf16 v[20:23], a[116:119], v[88:91], v[20:23]
    ds_read_b128 v[88:91], v1 offset:40960
    s_waitcnt lgkmcnt(2)
    v_mfma_f32_16x16x32_bf16 v[32:35], a[144:147], v[96:99], v[32:35]
    ds_read_b128 v[92:95], v1 offset:41216
    s_waitcnt lgkmcnt(2)
    v_mfma_f32_16x16x32_bf16 v[32:35], a[168:171], v[100:103], v[32:35]
    v_fma_f32 v11, v11, v107, v115
    v_mfma_f32_16x16x32_bf16 v[36:39], a[172:175], v[100:103], v[36:39]
    v_fma_f32 v12, v12, v108, v116
    v_mfma_f32_16x16x32_bf16 v[36:39], a[148:151], v[96:99], v[36:39]
    v_fma_f32 v13, v13, v109, v117
    v_mfma_f32_16x16x32_bf16 v[24:27], a[152:155], v[96:99], v[24:27]
    v_fma_f32 v14, v14, v110, v118
    v_mfma_f32_16x16x32_bf16 v[24:27], a[176:179], v[100:103], v[24:27]
    v_fma_f32 v15, v15, v111, v119
    v_mfma_f32_16x16x32_bf16 v[28:31], a[180:183], v[100:103], v[28:31]
    v_exp_f32 v120, v8
    s_add_u32 m0, s21, 8192
    v_mfma_f32_16x16x32_bf16 v[28:31], a[156:159], v[96:99], v[28:31]
    buffer_load_dwordx4 v6, s[8:11], s29 offen lds
    v_mfma_f32_16x16x32_bf16 v[16:19], a[160:163], v[96:99], v[16:19]
    v_exp_f32 v121, v9
    v_mfma_f32_16x16x32_bf16 v[16:19], a[184:187], v[100:103], v[16:19]
    v_exp_f32 v122, v10
    v_mfma_f32_16x16x32_bf16 v[20:23], a[188:191], v[100:103], v[20:23]
    v_exp_f32 v123, v11
    v_mfma_f32_16x16x32_bf16 v[20:23], a[164:167], v[96:99], v[20:23]
    ds_read_b128 v[96:99], v1 offset:41472
    s_waitcnt lgkmcnt(2)
    v_mfma_f32_16x16x32_bf16 v[32:35], a[192:195], v[88:91], v[32:35]
    ds_read_b128 v[100:103], v1 offset:41728
    s_waitcnt lgkmcnt(2)
    v_mfma_f32_16x16x32_bf16 v[32:35], a[216:219], v[92:95], v[32:35]
    v_exp_f32 v124, v12
    v_mfma_f32_16x16x32_bf16 v[36:39], a[220:223], v[92:95], v[36:39]
    v_exp_f32 v125, v13
    v_mfma_f32_16x16x32_bf16 v[36:39], a[196:199], v[88:91], v[36:39]
    v_exp_f32 v126, v14
    s_add_u32 m0, s21, 12288
    v_mfma_f32_16x16x32_bf16 v[24:27], a[200:203], v[88:91], v[24:27]
    buffer_load_dwordx4 v7, s[8:11], s29 offen lds
    v_mfma_f32_16x16x32_bf16 v[24:27], a[224:227], v[92:95], v[24:27]
    v_exp_f32 v127, v15
    v_mfma_f32_16x16x32_bf16 v[28:31], a[228:231], v[92:95], v[28:31]
    v_fma_f32 v120, v120, s28, s28
    v_mfma_f32_16x16x32_bf16 v[28:31], a[204:207], v[88:91], v[28:31]
    v_fma_f32 v121, v121, s28, s28
    v_mfma_f32_16x16x32_bf16 v[16:19], a[208:211], v[88:91], v[16:19]
    v_fma_f32 v122, v122, s28, s28
    v_mfma_f32_16x16x32_bf16 v[16:19], a[232:235], v[92:95], v[16:19]
    v_fma_f32 v123, v123, s28, s28
    v_mfma_f32_16x16x32_bf16 v[20:23], a[236:239], v[92:95], v[20:23]
    v_fma_f32 v124, v124, s28, s28
    v_mfma_f32_16x16x32_bf16 v[20:23], a[212:215], v[88:91], v[20:23]
    ds_read_b128 v[88:91], v1 offset:45056
    s_waitcnt lgkmcnt(2)
    v_mfma_f32_16x16x32_bf16 v[32:35], a[240:243], v[96:99], v[32:35]
    ds_read_b128 v[92:95], v1 offset:45312
    s_waitcnt lgkmcnt(2)
    v_mfma_f32_16x16x32_bf16 v[32:35], v[136:139], v[100:103], v[32:35]
    v_fma_f32 v125, v125, s28, s28
    v_mfma_f32_16x16x32_bf16 v[36:39], v[140:143], v[100:103], v[36:39]
    v_fma_f32 v126, v126, s28, s28
    v_mfma_f32_16x16x32_bf16 v[36:39], a[244:247], v[96:99], v[36:39]
    v_fma_f32 v127, v127, s28, s28
    v_mfma_f32_16x16x32_bf16 v[24:27], a[248:251], v[96:99], v[24:27]
    v_rcp_f32 v120, v120
    v_mfma_f32_16x16x32_bf16 v[24:27], v[144:147], v[100:103], v[24:27]
    v_rcp_f32 v121, v121
    v_mfma_f32_16x16x32_bf16 v[28:31], v[148:151], v[100:103], v[28:31]
    v_rcp_f32 v122, v122
    v_mfma_f32_16x16x32_bf16 v[28:31], a[252:255], v[96:99], v[28:31]
    v_rcp_f32 v123, v123
    v_mfma_f32_16x16x32_bf16 v[16:19], v[128:131], v[96:99], v[16:19]
    v_rcp_f32 v124, v124
    v_mfma_f32_16x16x32_bf16 v[16:19], v[152:155], v[100:103], v[16:19]
    v_rcp_f32 v125, v125
    v_mfma_f32_16x16x32_bf16 v[20:23], v[156:159], v[100:103], v[20:23]
    v_rcp_f32 v126, v126
    v_mfma_f32_16x16x32_bf16 v[20:23], v[132:135], v[96:99], v[20:23]
    ds_read_b128 v[96:99], v1 offset:45568
    s_waitcnt lgkmcnt(2)
    v_mfma_f32_16x16x32_bf16 v[32:35], v[160:163], v[88:91], v[32:35]
    ds_read_b128 v[100:103], v1 offset:45824
    s_waitcnt lgkmcnt(2)
    v_mfma_f32_16x16x32_bf16 v[32:35], v[184:187], v[92:95], v[32:35]
    v_rcp_f32 v127, v127
    v_mfma_f32_16x16x32_bf16 v[36:39], v[188:191], v[92:95], v[36:39]
    v_mul_f32 v8, v8, v120
    v_mfma_f32_16x16x32_bf16 v[36:39], v[164:167], v[88:91], v[36:39]
    v_mul_f32 v9, v9, v121
    v_mfma_f32_16x16x32_bf16 v[24:27], v[168:171], v[88:91], v[24:27]
    v_mul_f32 v10, v10, v122
    v_mfma_f32_16x16x32_bf16 v[24:27], v[192:195], v[92:95], v[24:27]
    v_mul_f32 v11, v11, v123
    v_mfma_f32_16x16x32_bf16 v[28:31], v[196:199], v[92:95], v[28:31]
    v_mul_f32 v12, v12, v124
    v_mfma_f32_16x16x32_bf16 v[28:31], v[172:175], v[88:91], v[28:31]
    v_mul_f32 v13, v13, v125
    v_mfma_f32_16x16x32_bf16 v[16:19], v[176:179], v[88:91], v[16:19]
    v_mul_f32 v14, v14, v126
    v_mfma_f32_16x16x32_bf16 v[16:19], v[200:203], v[92:95], v[16:19]
    v_mul_f32 v15, v15, v127
    v_mfma_f32_16x16x32_bf16 v[20:23], v[204:207], v[92:95], v[20:23]
    v_cvt_pk_bf16_f32 v8, v8, v9
    v_mfma_f32_16x16x32_bf16 v[20:23], v[180:183], v[88:91], v[20:23]
    ds_read_b128 v[88:91], v1 offset:49152
    s_waitcnt lgkmcnt(2)
    v_mfma_f32_16x16x32_bf16 v[32:35], v[208:211], v[96:99], v[32:35]
    ds_read_b128 v[92:95], v1 offset:49408
    s_waitcnt lgkmcnt(2)
    v_mfma_f32_16x16x32_bf16 v[32:35], v[232:235], v[100:103], v[32:35]
    v_cvt_pk_bf16_f32 v9, v10, v11
    v_mfma_f32_16x16x32_bf16 v[36:39], v[236:239], v[100:103], v[36:39]
    v_cvt_pk_bf16_f32 v10, v12, v13
    v_mfma_f32_16x16x32_bf16 v[36:39], v[212:215], v[96:99], v[36:39]
    v_cvt_pk_bf16_f32 v11, v14, v15
    v_mfma_f32_16x16x32_bf16 v[24:27], v[216:219], v[96:99], v[24:27]
    v_mfma_f32_16x16x32_bf16 v[24:27], v[240:243], v[100:103], v[24:27]
    v_permlane16_swap_b32 v8, v10
    v_mfma_f32_16x16x32_bf16 v[28:31], v[244:247], v[100:103], v[28:31]
    v_permlane16_swap_b32 v9, v11
    s_mov_b32 s22, 8192
    v_mfma_f32_16x16x32_bf16 v[28:31], v[220:223], v[96:99], v[28:31]
    buffer_store_dwordx4 v[8:11], v3, s[16:19], s22 offen nt
    v_mfma_f32_16x16x32_bf16 v[16:19], v[224:227], v[96:99], v[16:19]
    v_mfma_f32_16x16x32_bf16 v[16:19], v[248:251], v[100:103], v[16:19]
    v_mfma_f32_16x16x32_bf16 v[20:23], v[252:255], v[100:103], v[20:23]
    v_mfma_f32_16x16x32_bf16 v[20:23], v[228:231], v[96:99], v[20:23]
    ds_read_b128 v[96:99], v1 offset:49664
    s_waitcnt lgkmcnt(2)
    v_mfma_f32_16x16x32_bf16 v[8:11], a[0:3], v[88:91], 0
    ds_read_b128 v[100:103], v1 offset:49920
    s_waitcnt lgkmcnt(2)
    v_mfma_f32_16x16x32_bf16 v[8:11], a[24:27], v[92:95], v[8:11]
    v_fma_f32 v52, v52, v108, v116
    s_add_u32 m0, s21, 16384
    s_mov_b32 s29, 17408
    v_mfma_f32_16x16x32_bf16 v[12:15], a[28:31], v[92:95], 0
    buffer_load_dwordx4 v4, s[8:11], s29 offen lds
    v_mfma_f32_16x16x32_bf16 v[12:15], a[4:7], v[88:91], v[12:15]
    v_fma_f32 v53, v53, v109, v117
    v_mfma_f32_16x16x32_bf16 v[32:35], a[8:11], v[88:91], v[32:35]
    v_fma_f32 v54, v54, v110, v118
    v_mfma_f32_16x16x32_bf16 v[32:35], a[32:35], v[92:95], v[32:35]
    v_fma_f32 v55, v55, v111, v119
    v_mfma_f32_16x16x32_bf16 v[36:39], a[36:39], v[92:95], v[36:39]
    v_exp_f32 v124, v52
    v_mfma_f32_16x16x32_bf16 v[36:39], a[12:15], v[88:91], v[36:39]
    v_exp_f32 v125, v53
    v_mfma_f32_16x16x32_bf16 v[24:27], a[16:19], v[88:91], v[24:27]
    v_exp_f32 v126, v54
    v_mfma_f32_16x16x32_bf16 v[24:27], a[40:43], v[92:95], v[24:27]
    v_exp_f32 v127, v55
    v_mfma_f32_16x16x32_bf16 v[28:31], a[44:47], v[92:95], v[28:31]
    v_fma_f32 v124, v124, s28, s28
    s_add_u32 m0, s21, 20480
    v_mfma_f32_16x16x32_bf16 v[28:31], a[20:23], v[88:91], v[28:31]
    ds_read_b128 v[88:91], v1 offset:53248
    s_waitcnt lgkmcnt(2)
    v_mfma_f32_16x16x32_bf16 v[8:11], a[48:51], v[96:99], v[8:11]
    ds_read_b128 v[92:95], v1 offset:53504
    s_waitcnt lgkmcnt(2)
    v_mfma_f32_16x16x32_bf16 v[8:11], a[72:75], v[100:103], v[8:11]
    buffer_load_dwordx4 v5, s[8:11], s29 offen lds
    v_mfma_f32_16x16x32_bf16 v[12:15], a[76:79], v[100:103], v[12:15]
    v_fma_f32 v125, v125, s28, s28
    v_mfma_f32_16x16x32_bf16 v[12:15], a[52:55], v[96:99], v[12:15]
    v_fma_f32 v126, v126, s28, s28
    v_mfma_f32_16x16x32_bf16 v[32:35], a[56:59], v[96:99], v[32:35]
    v_fma_f32 v127, v127, s28, s28
    v_mfma_f32_16x16x32_bf16 v[32:35], a[80:83], v[100:103], v[32:35]
    v_rcp_f32 v124, v124
    v_mfma_f32_16x16x32_bf16 v[36:39], a[84:87], v[100:103], v[36:39]
    v_rcp_f32 v125, v125
    v_mfma_f32_16x16x32_bf16 v[36:39], a[60:63], v[96:99], v[36:39]
    v_rcp_f32 v126, v126
    v_mfma_f32_16x16x32_bf16 v[24:27], a[64:67], v[96:99], v[24:27]
    v_rcp_f32 v127, v127
    v_mfma_f32_16x16x32_bf16 v[24:27], a[88:91], v[100:103], v[24:27]
    v_mul_f32 v52, v52, v124
    s_add_u32 m0, s21, 24576
    v_mfma_f32_16x16x32_bf16 v[28:31], a[92:95], v[100:103], v[28:31]
    buffer_load_dwordx4 v6, s[8:11], s29 offen lds
    v_mfma_f32_16x16x32_bf16 v[28:31], a[68:71], v[96:99], v[28:31]
    ds_read_b128 v[96:99], v1 offset:53760
    s_waitcnt lgkmcnt(2)
    v_mfma_f32_16x16x32_bf16 v[8:11], a[96:99], v[88:91], v[8:11]
    ds_read_b128 v[100:103], v1 offset:54016
    s_waitcnt lgkmcnt(2)
    v_mfma_f32_16x16x32_bf16 v[8:11], a[120:123], v[92:95], v[8:11]
    v_mul_f32 v53, v53, v125
    v_mfma_f32_16x16x32_bf16 v[12:15], a[124:127], v[92:95], v[12:15]
    v_mul_f32 v54, v54, v126
    v_mfma_f32_16x16x32_bf16 v[12:15], a[100:103], v[88:91], v[12:15]
    v_mul_f32 v55, v55, v127
    v_mfma_f32_16x16x32_bf16 v[32:35], a[104:107], v[88:91], v[32:35]
    v_cvt_pk_bf16_f32 v50, v52, v53
    v_mfma_f32_16x16x32_bf16 v[32:35], a[128:131], v[92:95], v[32:35]
    v_cvt_pk_bf16_f32 v51, v54, v55
    v_mfma_f32_16x16x32_bf16 v[36:39], a[132:135], v[92:95], v[36:39]
    s_add_u32 m0, s21, 28672
    v_mfma_f32_16x16x32_bf16 v[36:39], a[108:111], v[88:91], v[36:39]
    buffer_load_dwordx4 v7, s[8:11], s29 offen lds
    v_mfma_f32_16x16x32_bf16 v[24:27], a[112:115], v[88:91], v[24:27]
    v_permlane16_swap_b32 v48, v50
    v_mfma_f32_16x16x32_bf16 v[24:27], a[136:139], v[92:95], v[24:27]
    v_permlane16_swap_b32 v49, v51
    s_mov_b32 s22, 1024
    v_mfma_f32_16x16x32_bf16 v[28:31], a[140:143], v[92:95], v[28:31]
    buffer_store_dwordx4 v[48:51], v3, s[16:19], s22 offen nt
    v_mfma_f32_16x16x32_bf16 v[28:31], a[116:119], v[88:91], v[28:31]
    ds_read_b128 v[88:91], v1 offset:57344
    s_waitcnt lgkmcnt(2)
    v_mfma_f32_16x16x32_bf16 v[8:11], a[144:147], v[96:99], v[8:11]
    ds_read_b128 v[92:95], v1 offset:57600
    s_waitcnt lgkmcnt(2)
    v_mfma_f32_16x16x32_bf16 v[8:11], a[168:171], v[100:103], v[8:11]
    v_fma_f32 v16, v16, v104, v112
    v_mfma_f32_16x16x32_bf16 v[12:15], a[172:175], v[100:103], v[12:15]
    v_fma_f32 v17, v17, v105, v113
    v_mfma_f32_16x16x32_bf16 v[12:15], a[148:151], v[96:99], v[12:15]
    v_fma_f32 v18, v18, v106, v114
    v_mfma_f32_16x16x32_bf16 v[32:35], a[152:155], v[96:99], v[32:35]
    v_fma_f32 v19, v19, v107, v115
    v_mfma_f32_16x16x32_bf16 v[32:35], a[176:179], v[100:103], v[32:35]
    v_fma_f32 v20, v20, v108, v116
    v_mfma_f32_16x16x32_bf16 v[36:39], a[180:183], v[100:103], v[36:39]
    v_fma_f32 v21, v21, v109, v117
    v_mfma_f32_16x16x32_bf16 v[36:39], a[156:159], v[96:99], v[36:39]
    v_fma_f32 v22, v22, v110, v118
    v_mfma_f32_16x16x32_bf16 v[24:27], a[160:163], v[96:99], v[24:27]
    v_fma_f32 v23, v23, v111, v119
    v_mfma_f32_16x16x32_bf16 v[24:27], a[184:187], v[100:103], v[24:27]
    v_exp_f32 v120, v16
    v_mfma_f32_16x16x32_bf16 v[28:31], a[188:191], v[100:103], v[28:31]
    v_exp_f32 v121, v17
    v_mfma_f32_16x16x32_bf16 v[28:31], a[164:167], v[96:99], v[28:31]
    ds_read_b128 v[96:99], v1 offset:57856
    s_waitcnt lgkmcnt(2)
    v_mfma_f32_16x16x32_bf16 v[8:11], a[192:195], v[88:91], v[8:11]
    ds_read_b128 v[100:103], v1 offset:58112
    s_waitcnt lgkmcnt(2)
    v_mfma_f32_16x16x32_bf16 v[8:11], a[216:219], v[92:95], v[8:11]
    v_exp_f32 v122, v18
    v_mfma_f32_16x16x32_bf16 v[12:15], a[220:223], v[92:95], v[12:15]
    v_exp_f32 v123, v19
    v_mfma_f32_16x16x32_bf16 v[12:15], a[196:199], v[88:91], v[12:15]
    v_exp_f32 v124, v20
    v_mfma_f32_16x16x32_bf16 v[32:35], a[200:203], v[88:91], v[32:35]
    v_exp_f32 v125, v21
    v_mfma_f32_16x16x32_bf16 v[32:35], a[224:227], v[92:95], v[32:35]
    v_exp_f32 v126, v22
    v_mfma_f32_16x16x32_bf16 v[36:39], a[228:231], v[92:95], v[36:39]
    v_exp_f32 v127, v23
    v_mfma_f32_16x16x32_bf16 v[36:39], a[204:207], v[88:91], v[36:39]
    v_fma_f32 v120, v120, s28, s28
    v_mfma_f32_16x16x32_bf16 v[24:27], a[208:211], v[88:91], v[24:27]
    v_fma_f32 v121, v121, s28, s28
    v_mfma_f32_16x16x32_bf16 v[24:27], a[232:235], v[92:95], v[24:27]
    v_fma_f32 v122, v122, s28, s28
    v_mfma_f32_16x16x32_bf16 v[28:31], a[236:239], v[92:95], v[28:31]
    v_fma_f32 v123, v123, s28, s28
    v_mfma_f32_16x16x32_bf16 v[28:31], a[212:215], v[88:91], v[28:31]
    ds_read_b128 v[88:91], v1 offset:61440
    s_waitcnt lgkmcnt(2)
    v_mfma_f32_16x16x32_bf16 v[8:11], a[240:243], v[96:99], v[8:11]
    ds_read_b128 v[92:95], v1 offset:61696
    s_waitcnt lgkmcnt(2)
    v_mfma_f32_16x16x32_bf16 v[8:11], v[136:139], v[100:103], v[8:11]
    v_fma_f32 v124, v124, s28, s28
    v_mfma_f32_16x16x32_bf16 v[12:15], v[140:143], v[100:103], v[12:15]
    v_fma_f32 v125, v125, s28, s28
    v_mfma_f32_16x16x32_bf16 v[12:15], a[244:247], v[96:99], v[12:15]
    v_fma_f32 v126, v126, s28, s28
    v_mfma_f32_16x16x32_bf16 v[32:35], a[248:251], v[96:99], v[32:35]
    v_fma_f32 v127, v127, s28, s28
    v_mfma_f32_16x16x32_bf16 v[32:35], v[144:147], v[100:103], v[32:35]
    v_rcp_f32 v120, v120
    v_mfma_f32_16x16x32_bf16 v[36:39], v[148:151], v[100:103], v[36:39]
    v_rcp_f32 v121, v121
    v_mfma_f32_16x16x32_bf16 v[36:39], a[252:255], v[96:99], v[36:39]
    v_rcp_f32 v122, v122
    v_mfma_f32_16x16x32_bf16 v[24:27], v[128:131], v[96:99], v[24:27]
    v_rcp_f32 v123, v123
    v_mfma_f32_16x16x32_bf16 v[24:27], v[152:155], v[100:103], v[24:27]
    v_rcp_f32 v124, v124
    v_mfma_f32_16x16x32_bf16 v[28:31], v[156:159], v[100:103], v[28:31]
    v_rcp_f32 v125, v125
    v_mfma_f32_16x16x32_bf16 v[28:31], v[132:135], v[96:99], v[28:31]
    ds_read_b128 v[96:99], v1 offset:61952
    s_waitcnt lgkmcnt(2)
    v_mfma_f32_16x16x32_bf16 v[8:11], v[160:163], v[88:91], v[8:11]
    ds_read_b128 v[100:103], v1 offset:62208
    s_waitcnt lgkmcnt(2)
    v_mfma_f32_16x16x32_bf16 v[8:11], v[184:187], v[92:95], v[8:11]
    v_rcp_f32 v126, v126
    v_mfma_f32_16x16x32_bf16 v[12:15], v[188:191], v[92:95], v[12:15]
    v_rcp_f32 v127, v127
    v_mfma_f32_16x16x32_bf16 v[12:15], v[164:167], v[88:91], v[12:15]
    v_mul_f32 v16, v16, v120
    v_mfma_f32_16x16x32_bf16 v[32:35], v[168:171], v[88:91], v[32:35]
    v_mul_f32 v17, v17, v121
    v_mfma_f32_16x16x32_bf16 v[32:35], v[192:195], v[92:95], v[32:35]
    v_mul_f32 v18, v18, v122
    v_mfma_f32_16x16x32_bf16 v[36:39], v[196:199], v[92:95], v[36:39]
    v_mul_f32 v19, v19, v123
    v_mfma_f32_16x16x32_bf16 v[36:39], v[172:175], v[88:91], v[36:39]
    v_mul_f32 v20, v20, v124
    v_mfma_f32_16x16x32_bf16 v[24:27], v[176:179], v[88:91], v[24:27]
    v_mul_f32 v21, v21, v125
    v_mfma_f32_16x16x32_bf16 v[24:27], v[200:203], v[92:95], v[24:27]
    v_mul_f32 v22, v22, v126
    v_mfma_f32_16x16x32_bf16 v[28:31], v[204:207], v[92:95], v[28:31]
    v_mul_f32 v23, v23, v127
    v_mfma_f32_16x16x32_bf16 v[28:31], v[180:183], v[88:91], v[28:31]
    ds_read_b128 v[88:91], v2 offset:0
    s_waitcnt lgkmcnt(2)
    v_mfma_f32_16x16x32_bf16 v[8:11], v[208:211], v[96:99], v[8:11]
    ds_read_b128 v[92:95], v2 offset:256
    s_waitcnt lgkmcnt(2)
    v_mfma_f32_16x16x32_bf16 v[8:11], v[232:235], v[100:103], v[8:11]
    v_cvt_pk_bf16_f32 v16, v16, v17
    v_mfma_f32_16x16x32_bf16 v[12:15], v[236:239], v[100:103], v[12:15]
    v_cvt_pk_bf16_f32 v17, v18, v19
    v_mfma_f32_16x16x32_bf16 v[12:15], v[212:215], v[96:99], v[12:15]
    v_cvt_pk_bf16_f32 v18, v20, v21
    v_mfma_f32_16x16x32_bf16 v[32:35], v[216:219], v[96:99], v[32:35]
    v_cvt_pk_bf16_f32 v19, v22, v23
    v_mfma_f32_16x16x32_bf16 v[32:35], v[240:243], v[100:103], v[32:35]
    v_mfma_f32_16x16x32_bf16 v[36:39], v[244:247], v[100:103], v[36:39]
    v_permlane16_swap_b32 v16, v18
    v_mfma_f32_16x16x32_bf16 v[36:39], v[220:223], v[96:99], v[36:39]
    v_permlane16_swap_b32 v17, v19
    s_mov_b32 s22, 9216
    v_mfma_f32_16x16x32_bf16 v[24:27], v[224:227], v[96:99], v[24:27]
    buffer_store_dwordx4 v[16:19], v3, s[16:19], s22 offen nt
    v_mfma_f32_16x16x32_bf16 v[24:27], v[248:251], v[100:103], v[24:27]
    v_mfma_f32_16x16x32_bf16 v[28:31], v[252:255], v[100:103], v[28:31]
    v_mfma_f32_16x16x32_bf16 v[28:31], v[228:231], v[96:99], v[28:31]
    ds_read_b128 v[96:99], v2 offset:512
    s_waitcnt lgkmcnt(2)
    v_mfma_f32_16x16x32_bf16 v[16:19], a[0:3], v[88:91], 0
    ds_read_b128 v[100:103], v2 offset:768
    s_waitcnt lgkmcnt(2)
    v_mfma_f32_16x16x32_bf16 v[16:19], a[24:27], v[92:95], v[16:19]
    s_waitcnt vmcnt(18)
    v_fma_f32 v56, v56, v104, v112
    v_mfma_f32_16x16x32_bf16 v[20:23], a[28:31], v[92:95], 0
    s_barrier
    s_add_u32 m0, s21, 32768
    s_mov_b32 s29, 18432
    v_mfma_f32_16x16x32_bf16 v[20:23], a[4:7], v[88:91], v[20:23]
    buffer_load_dwordx4 v4, s[8:11], s29 offen lds
    v_mfma_f32_16x16x32_bf16 v[8:11], a[8:11], v[88:91], v[8:11]
    v_fma_f32 v57, v57, v105, v113
    v_mfma_f32_16x16x32_bf16 v[8:11], a[32:35], v[92:95], v[8:11]
    v_fma_f32 v58, v58, v106, v114
    v_mfma_f32_16x16x32_bf16 v[12:15], a[36:39], v[92:95], v[12:15]
    v_fma_f32 v59, v59, v107, v115
    v_mfma_f32_16x16x32_bf16 v[12:15], a[12:15], v[88:91], v[12:15]
    v_exp_f32 v120, v56
    v_mfma_f32_16x16x32_bf16 v[32:35], a[16:19], v[88:91], v[32:35]
    v_exp_f32 v121, v57
    v_mfma_f32_16x16x32_bf16 v[32:35], a[40:43], v[92:95], v[32:35]
    v_exp_f32 v122, v58
    v_mfma_f32_16x16x32_bf16 v[36:39], a[44:47], v[92:95], v[36:39]
    v_exp_f32 v123, v59
    v_mfma_f32_16x16x32_bf16 v[36:39], a[20:23], v[88:91], v[36:39]
    ds_read_b128 v[88:91], v2 offset:4096
    s_waitcnt lgkmcnt(2)
    v_mfma_f32_16x16x32_bf16 v[16:19], a[48:51], v[96:99], v[16:19]
    ds_read_b128 v[92:95], v2 offset:4352
    s_waitcnt lgkmcnt(2)
    v_mfma_f32_16x16x32_bf16 v[16:19], a[72:75], v[100:103], v[16:19]
    v_fma_f32 v120, v120, s28, s28
    s_add_u32 m0, s21, 36864
    v_mfma_f32_16x16x32_bf16 v[20:23], a[76:79], v[100:103], v[20:23]
    buffer_load_dwordx4 v5, s[8:11], s29 offen lds
    v_mfma_f32_16x16x32_bf16 v[20:23], a[52:55], v[96:99], v[20:23]
    v_fma_f32 v121, v121, s28, s28
    v_mfma_f32_16x16x32_bf16 v[8:11], a[56:59], v[96:99], v[8:11]
    v_fma_f32 v122, v122, s28, s28
    v_mfma_f32_16x16x32_bf16 v[8:11], a[80:83], v[100:103], v[8:11]
    v_fma_f32 v123, v123, s28, s28
    v_mfma_f32_16x16x32_bf16 v[12:15], a[84:87], v[100:103], v[12:15]
    v_rcp_f32 v120, v120
    v_mfma_f32_16x16x32_bf16 v[12:15], a[60:63], v[96:99], v[12:15]
    v_rcp_f32 v121, v121
    v_mfma_f32_16x16x32_bf16 v[32:35], a[64:67], v[96:99], v[32:35]
    v_rcp_f32 v122, v122
    v_mfma_f32_16x16x32_bf16 v[32:35], a[88:91], v[100:103], v[32:35]
    v_rcp_f32 v123, v123
    v_mfma_f32_16x16x32_bf16 v[36:39], a[92:95], v[100:103], v[36:39]
    v_mul_f32 v56, v56, v120
    s_add_u32 m0, s21, 40960
    v_mfma_f32_16x16x32_bf16 v[36:39], a[68:71], v[96:99], v[36:39]
    ds_read_b128 v[96:99], v2 offset:4608
    s_waitcnt lgkmcnt(2)
    v_mfma_f32_16x16x32_bf16 v[16:19], a[96:99], v[88:91], v[16:19]
    ds_read_b128 v[100:103], v2 offset:4864
    s_waitcnt lgkmcnt(2)
    v_mfma_f32_16x16x32_bf16 v[16:19], a[120:123], v[92:95], v[16:19]
    buffer_load_dwordx4 v6, s[8:11], s29 offen lds
    v_mfma_f32_16x16x32_bf16 v[20:23], a[124:127], v[92:95], v[20:23]
    v_mul_f32 v57, v57, v121
    v_mfma_f32_16x16x32_bf16 v[20:23], a[100:103], v[88:91], v[20:23]
    v_mul_f32 v58, v58, v122
    v_mfma_f32_16x16x32_bf16 v[8:11], a[104:107], v[88:91], v[8:11]
    v_mul_f32 v59, v59, v123
    v_mfma_f32_16x16x32_bf16 v[8:11], a[128:131], v[92:95], v[8:11]
    v_cvt_pk_bf16_f32 v56, v56, v57
    v_mfma_f32_16x16x32_bf16 v[12:15], a[132:135], v[92:95], v[12:15]
    v_cvt_pk_bf16_f32 v57, v58, v59
    v_mfma_f32_16x16x32_bf16 v[12:15], a[108:111], v[88:91], v[12:15]
    v_fma_f32 v24, v24, v104, v112
    v_mfma_f32_16x16x32_bf16 v[32:35], a[112:115], v[88:91], v[32:35]
    v_fma_f32 v25, v25, v105, v113
    v_mfma_f32_16x16x32_bf16 v[32:35], a[136:139], v[92:95], v[32:35]
    v_fma_f32 v26, v26, v106, v114
    s_add_u32 m0, s21, 45056
    v_mfma_f32_16x16x32_bf16 v[36:39], a[140:143], v[92:95], v[36:39]
    buffer_load_dwordx4 v7, s[8:11], s29 offen lds
    v_mfma_f32_16x16x32_bf16 v[36:39], a[116:119], v[88:91], v[36:39]
    ds_read_b128 v[88:91], v2 offset:8192
    s_waitcnt lgkmcnt(2)
    v_mfma_f32_16x16x32_bf16 v[16:19], a[144:147], v[96:99], v[16:19]
    ds_read_b128 v[92:95], v2 offset:8448
    s_waitcnt lgkmcnt(2)
    v_mfma_f32_16x16x32_bf16 v[16:19], a[168:171], v[100:103], v[16:19]
    v_fma_f32 v27, v27, v107, v115
    v_mfma_f32_16x16x32_bf16 v[20:23], a[172:175], v[100:103], v[20:23]
    v_fma_f32 v28, v28, v108, v116
    v_mfma_f32_16x16x32_bf16 v[20:23], a[148:151], v[96:99], v[20:23]
    v_fma_f32 v29, v29, v109, v117
    v_mfma_f32_16x16x32_bf16 v[8:11], a[152:155], v[96:99], v[8:11]
    v_fma_f32 v30, v30, v110, v118
    v_mfma_f32_16x16x32_bf16 v[8:11], a[176:179], v[100:103], v[8:11]
    v_fma_f32 v31, v31, v111, v119
    v_mfma_f32_16x16x32_bf16 v[12:15], a[180:183], v[100:103], v[12:15]
    v_exp_f32 v120, v24
    s_add_u32 m0, s21, 49152
    s_mov_b32 s29, 19456
    v_mfma_f32_16x16x32_bf16 v[12:15], a[156:159], v[96:99], v[12:15]
    buffer_load_dwordx4 v4, s[8:11], s29 offen lds
    v_mfma_f32_16x16x32_bf16 v[32:35], a[160:163], v[96:99], v[32:35]
    v_exp_f32 v121, v25
    v_mfma_f32_16x16x32_bf16 v[32:35], a[184:187], v[100:103], v[32:35]
    v_exp_f32 v122, v26
    v_mfma_f32_16x16x32_bf16 v[36:39], a[188:191], v[100:103], v[36:39]
    v_exp_f32 v123, v27
    v_mfma_f32_16x16x32_bf16 v[36:39], a[164:167], v[96:99], v[36:39]
    ds_read_b128 v[96:99], v2 offset:8704
    s_waitcnt lgkmcnt(2)
    v_mfma_f32_16x16x32_bf16 v[16:19], a[192:195], v[88:91], v[16:19]
    ds_read_b128 v[100:103], v2 offset:8960
    s_waitcnt lgkmcnt(2)
    v_mfma_f32_16x16x32_bf16 v[16:19], a[216:219], v[92:95], v[16:19]
    v_exp_f32 v124, v28
    v_mfma_f32_16x16x32_bf16 v[20:23], a[220:223], v[92:95], v[20:23]
    v_exp_f32 v125, v29
    v_mfma_f32_16x16x32_bf16 v[20:23], a[196:199], v[88:91], v[20:23]
    v_exp_f32 v126, v30
    s_add_u32 m0, s21, 53248
    v_mfma_f32_16x16x32_bf16 v[8:11], a[200:203], v[88:91], v[8:11]
    buffer_load_dwordx4 v5, s[8:11], s29 offen lds
    v_mfma_f32_16x16x32_bf16 v[8:11], a[224:227], v[92:95], v[8:11]
    v_exp_f32 v127, v31
    v_mfma_f32_16x16x32_bf16 v[12:15], a[228:231], v[92:95], v[12:15]
    v_fma_f32 v120, v120, s28, s28
    v_mfma_f32_16x16x32_bf16 v[12:15], a[204:207], v[88:91], v[12:15]
    v_fma_f32 v121, v121, s28, s28
    v_mfma_f32_16x16x32_bf16 v[32:35], a[208:211], v[88:91], v[32:35]
    v_fma_f32 v122, v122, s28, s28
    v_mfma_f32_16x16x32_bf16 v[32:35], a[232:235], v[92:95], v[32:35]
    v_fma_f32 v123, v123, s28, s28
    v_mfma_f32_16x16x32_bf16 v[36:39], a[236:239], v[92:95], v[36:39]
    v_fma_f32 v124, v124, s28, s28
    v_mfma_f32_16x16x32_bf16 v[36:39], a[212:215], v[88:91], v[36:39]
    ds_read_b128 v[88:91], v2 offset:12288
    s_waitcnt lgkmcnt(2)
    v_mfma_f32_16x16x32_bf16 v[16:19], a[240:243], v[96:99], v[16:19]
    ds_read_b128 v[92:95], v2 offset:12544
    s_waitcnt lgkmcnt(2)
    v_mfma_f32_16x16x32_bf16 v[16:19], v[136:139], v[100:103], v[16:19]
    v_fma_f32 v125, v125, s28, s28
    v_mfma_f32_16x16x32_bf16 v[20:23], v[140:143], v[100:103], v[20:23]
    v_fma_f32 v126, v126, s28, s28
    v_mfma_f32_16x16x32_bf16 v[20:23], a[244:247], v[96:99], v[20:23]
    v_fma_f32 v127, v127, s28, s28
    v_mfma_f32_16x16x32_bf16 v[8:11], a[248:251], v[96:99], v[8:11]
    v_rcp_f32 v120, v120
    v_mfma_f32_16x16x32_bf16 v[8:11], v[144:147], v[100:103], v[8:11]
    v_rcp_f32 v121, v121
    v_mfma_f32_16x16x32_bf16 v[12:15], v[148:151], v[100:103], v[12:15]
    v_rcp_f32 v122, v122
    v_mfma_f32_16x16x32_bf16 v[12:15], a[252:255], v[96:99], v[12:15]
    v_rcp_f32 v123, v123
    v_mfma_f32_16x16x32_bf16 v[32:35], v[128:131], v[96:99], v[32:35]
    v_rcp_f32 v124, v124
    v_mfma_f32_16x16x32_bf16 v[32:35], v[152:155], v[100:103], v[32:35]
    v_rcp_f32 v125, v125
    v_mfma_f32_16x16x32_bf16 v[36:39], v[156:159], v[100:103], v[36:39]
    v_rcp_f32 v126, v126
    v_mfma_f32_16x16x32_bf16 v[36:39], v[132:135], v[96:99], v[36:39]
    ds_read_b128 v[96:99], v2 offset:12800
    s_waitcnt lgkmcnt(2)
    v_mfma_f32_16x16x32_bf16 v[16:19], v[160:163], v[88:91], v[16:19]
    ds_read_b128 v[100:103], v2 offset:13056
    s_waitcnt lgkmcnt(2)
    v_mfma_f32_16x16x32_bf16 v[16:19], v[184:187], v[92:95], v[16:19]
    v_rcp_f32 v127, v127
    v_mfma_f32_16x16x32_bf16 v[20:23], v[188:191], v[92:95], v[20:23]
    v_mul_f32 v24, v24, v120
    v_mfma_f32_16x16x32_bf16 v[20:23], v[164:167], v[88:91], v[20:23]
    v_mul_f32 v25, v25, v121
    v_mfma_f32_16x16x32_bf16 v[8:11], v[168:171], v[88:91], v[8:11]
    v_mul_f32 v26, v26, v122
    v_mfma_f32_16x16x32_bf16 v[8:11], v[192:195], v[92:95], v[8:11]
    v_mul_f32 v27, v27, v123
    v_mfma_f32_16x16x32_bf16 v[12:15], v[196:199], v[92:95], v[12:15]
    v_mul_f32 v28, v28, v124
    v_mfma_f32_16x16x32_bf16 v[12:15], v[172:175], v[88:91], v[12:15]
    v_mul_f32 v29, v29, v125
    v_mfma_f32_16x16x32_bf16 v[32:35], v[176:179], v[88:91], v[32:35]
    v_mul_f32 v30, v30, v126
    v_mfma_f32_16x16x32_bf16 v[32:35], v[200:203], v[92:95], v[32:35]
    v_mul_f32 v31, v31, v127
    v_mfma_f32_16x16x32_bf16 v[36:39], v[204:207], v[92:95], v[36:39]
    v_cvt_pk_bf16_f32 v24, v24, v25
    v_mfma_f32_16x16x32_bf16 v[36:39], v[180:183], v[88:91], v[36:39]
    ds_read_b128 v[88:91], v2 offset:16384
    s_waitcnt lgkmcnt(2)
    v_mfma_f32_16x16x32_bf16 v[16:19], v[208:211], v[96:99], v[16:19]
    ds_read_b128 v[92:95], v2 offset:16640
    s_waitcnt lgkmcnt(2)
    v_mfma_f32_16x16x32_bf16 v[16:19], v[232:235], v[100:103], v[16:19]
    v_cvt_pk_bf16_f32 v25, v26, v27
    v_mfma_f32_16x16x32_bf16 v[20:23], v[236:239], v[100:103], v[20:23]
    v_cvt_pk_bf16_f32 v26, v28, v29
    v_mfma_f32_16x16x32_bf16 v[20:23], v[212:215], v[96:99], v[20:23]
    v_cvt_pk_bf16_f32 v27, v30, v31
    v_mfma_f32_16x16x32_bf16 v[8:11], v[216:219], v[96:99], v[8:11]
    v_mfma_f32_16x16x32_bf16 v[8:11], v[240:243], v[100:103], v[8:11]
    v_permlane16_swap_b32 v24, v26
    v_mfma_f32_16x16x32_bf16 v[12:15], v[244:247], v[100:103], v[12:15]
    v_permlane16_swap_b32 v25, v27
    s_mov_b32 s22, 10240
    v_mfma_f32_16x16x32_bf16 v[12:15], v[220:223], v[96:99], v[12:15]
    buffer_store_dwordx4 v[24:27], v3, s[16:19], s22 offen nt
    v_mfma_f32_16x16x32_bf16 v[32:35], v[224:227], v[96:99], v[32:35]
    v_mfma_f32_16x16x32_bf16 v[32:35], v[248:251], v[100:103], v[32:35]
    v_mfma_f32_16x16x32_bf16 v[36:39], v[252:255], v[100:103], v[36:39]
    v_mfma_f32_16x16x32_bf16 v[36:39], v[228:231], v[96:99], v[36:39]
    ds_read_b128 v[96:99], v2 offset:16896
    s_waitcnt lgkmcnt(2)
    v_mfma_f32_16x16x32_bf16 v[24:27], a[0:3], v[88:91], 0
    ds_read_b128 v[100:103], v2 offset:17152
    s_waitcnt lgkmcnt(2)
    v_mfma_f32_16x16x32_bf16 v[24:27], a[24:27], v[92:95], v[24:27]
    v_fma_f32 v60, v60, v108, v116
    s_add_u32 m0, s21, 57344
    v_mfma_f32_16x16x32_bf16 v[28:31], a[28:31], v[92:95], 0
    buffer_load_dwordx4 v6, s[8:11], s29 offen lds
    v_mfma_f32_16x16x32_bf16 v[28:31], a[4:7], v[88:91], v[28:31]
    v_fma_f32 v61, v61, v109, v117
    v_mfma_f32_16x16x32_bf16 v[16:19], a[8:11], v[88:91], v[16:19]
    v_fma_f32 v62, v62, v110, v118
    v_mfma_f32_16x16x32_bf16 v[16:19], a[32:35], v[92:95], v[16:19]
    v_fma_f32 v63, v63, v111, v119
    v_mfma_f32_16x16x32_bf16 v[20:23], a[36:39], v[92:95], v[20:23]
    v_exp_f32 v124, v60
    v_mfma_f32_16x16x32_bf16 v[20:23], a[12:15], v[88:91], v[20:23]
    v_exp_f32 v125, v61
    v_mfma_f32_16x16x32_bf16 v[8:11], a[16:19], v[88:91], v[8:11]
    v_exp_f32 v126, v62
    v_mfma_f32_16x16x32_bf16 v[8:11], a[40:43], v[92:95], v[8:11]
    v_exp_f32 v127, v63
    v_mfma_f32_16x16x32_bf16 v[12:15], a[44:47], v[92:95], v[12:15]
    v_fma_f32 v124, v124, s28, s28
    s_add_u32 m0, s21, 61440
    v_mfma_f32_16x16x32_bf16 v[12:15], a[20:23], v[88:91], v[12:15]
    ds_read_b128 v[88:91], v2 offset:20480
    s_waitcnt lgkmcnt(2)
    v_mfma_f32_16x16x32_bf16 v[24:27], a[48:51], v[96:99], v[24:27]
    ds_read_b128 v[92:95], v2 offset:20736
    s_waitcnt lgkmcnt(2)
    v_mfma_f32_16x16x32_bf16 v[24:27], a[72:75], v[100:103], v[24:27]
    buffer_load_dwordx4 v7, s[8:11], s29 offen lds
    v_mfma_f32_16x16x32_bf16 v[28:31], a[76:79], v[100:103], v[28:31]
    v_fma_f32 v125, v125, s28, s28
    v_mfma_f32_16x16x32_bf16 v[28:31], a[52:55], v[96:99], v[28:31]
    v_fma_f32 v126, v126, s28, s28
    v_mfma_f32_16x16x32_bf16 v[16:19], a[56:59], v[96:99], v[16:19]
    v_fma_f32 v127, v127, s28, s28
    v_mfma_f32_16x16x32_bf16 v[16:19], a[80:83], v[100:103], v[16:19]
    v_rcp_f32 v124, v124
    v_mfma_f32_16x16x32_bf16 v[20:23], a[84:87], v[100:103], v[20:23]
    v_rcp_f32 v125, v125
    v_mfma_f32_16x16x32_bf16 v[20:23], a[60:63], v[96:99], v[20:23]
    v_rcp_f32 v126, v126
    v_mfma_f32_16x16x32_bf16 v[8:11], a[64:67], v[96:99], v[8:11]
    v_rcp_f32 v127, v127
    v_mfma_f32_16x16x32_bf16 v[8:11], a[88:91], v[100:103], v[8:11]
    v_mul_f32 v60, v60, v124
    v_mfma_f32_16x16x32_bf16 v[12:15], a[92:95], v[100:103], v[12:15]
    v_mul_f32 v61, v61, v125
    v_mfma_f32_16x16x32_bf16 v[12:15], a[68:71], v[96:99], v[12:15]
    ds_read_b128 v[96:99], v2 offset:20992
    s_waitcnt lgkmcnt(2)
    v_mfma_f32_16x16x32_bf16 v[24:27], a[96:99], v[88:91], v[24:27]
    ds_read_b128 v[100:103], v2 offset:21248
    s_waitcnt lgkmcnt(2)
    v_mfma_f32_16x16x32_bf16 v[24:27], a[120:123], v[92:95], v[24:27]
    v_mul_f32 v62, v62, v126
    v_mfma_f32_16x16x32_bf16 v[28:31], a[124:127], v[92:95], v[28:31]
    v_mul_f32 v63, v63, v127
    v_mfma_f32_16x16x32_bf16 v[28:31], a[100:103], v[88:91], v[28:31]
    v_cvt_pk_bf16_f32 v58, v60, v61
    v_mfma_f32_16x16x32_bf16 v[16:19], a[104:107], v[88:91], v[16:19]
    v_cvt_pk_bf16_f32 v59, v62, v63
    v_mfma_f32_16x16x32_bf16 v[16:19], a[128:131], v[92:95], v[16:19]
    v_mfma_f32_16x16x32_bf16 v[20:23], a[132:135], v[92:95], v[20:23]
    v_permlane16_swap_b32 v56, v58
    v_mfma_f32_16x16x32_bf16 v[20:23], a[108:111], v[88:91], v[20:23]
    v_permlane16_swap_b32 v57, v59
    s_mov_b32 s22, 2048
    v_mfma_f32_16x16x32_bf16 v[8:11], a[112:115], v[88:91], v[8:11]
    buffer_store_dwordx4 v[56:59], v3, s[16:19], s22 offen nt
    v_mfma_f32_16x16x32_bf16 v[8:11], a[136:139], v[92:95], v[8:11]
    v_fma_f32 v32, v32, v104, v112
    v_mfma_f32_16x16x32_bf16 v[12:15], a[140:143], v[92:95], v[12:15]
    v_fma_f32 v33, v33, v105, v113
    v_mfma_f32_16x16x32_bf16 v[12:15], a[116:119], v[88:91], v[12:15]
    ds_read_b128 v[88:91], v2 offset:24576
    s_waitcnt lgkmcnt(2)
    v_mfma_f32_16x16x32_bf16 v[24:27], a[144:147], v[96:99], v[24:27]
    ds_read_b128 v[92:95], v2 offset:24832
    s_waitcnt lgkmcnt(2)
    v_mfma_f32_16x16x32_bf16 v[24:27], a[168:171], v[100:103], v[24:27]
    v_fma_f32 v34, v34, v106, v114
    v_mfma_f32_16x16x32_bf16 v[28:31], a[172:175], v[100:103], v[28:31]
    v_fma_f32 v35, v35, v107, v115
    v_mfma_f32_16x16x32_bf16 v[28:31], a[148:151], v[96:99], v[28:31]
    v_fma_f32 v36, v36, v108, v116
    v_mfma_f32_16x16x32_bf16 v[16:19], a[152:155], v[96:99], v[16:19]
    v_fma_f32 v37, v37, v109, v117
    v_mfma_f32_16x16x32_bf16 v[16:19], a[176:179], v[100:103], v[16:19]
    v_fma_f32 v38, v38, v110, v118
    v_mfma_f32_16x16x32_bf16 v[20:23], a[180:183], v[100:103], v[20:23]
    v_fma_f32 v39, v39, v111, v119
    v_mfma_f32_16x16x32_bf16 v[20:23], a[156:159], v[96:99], v[20:23]
    v_exp_f32 v120, v32
    v_mfma_f32_16x16x32_bf16 v[8:11], a[160:163], v[96:99], v[8:11]
    v_exp_f32 v121, v33
    v_mfma_f32_16x16x32_bf16 v[8:11], a[184:187], v[100:103], v[8:11]
    v_exp_f32 v122, v34
    v_mfma_f32_16x16x32_bf16 v[12:15], a[188:191], v[100:103], v[12:15]
    v_exp_f32 v123, v35
    v_mfma_f32_16x16x32_bf16 v[12:15], a[164:167], v[96:99], v[12:15]
    ds_read_b128 v[96:99], v2 offset:25088
    s_waitcnt lgkmcnt(2)
    v_mfma_f32_16x16x32_bf16 v[24:27], a[192:195], v[88:91], v[24:27]
    ds_read_b128 v[100:103], v2 offset:25344
    s_waitcnt lgkmcnt(2)
    v_mfma_f32_16x16x32_bf16 v[24:27], a[216:219], v[92:95], v[24:27]
    v_exp_f32 v124, v36
    v_mfma_f32_16x16x32_bf16 v[28:31], a[220:223], v[92:95], v[28:31]
    v_exp_f32 v125, v37
    v_mfma_f32_16x16x32_bf16 v[28:31], a[196:199], v[88:91], v[28:31]
    v_exp_f32 v126, v38
    v_mfma_f32_16x16x32_bf16 v[16:19], a[200:203], v[88:91], v[16:19]
    v_exp_f32 v127, v39
    v_mfma_f32_16x16x32_bf16 v[16:19], a[224:227], v[92:95], v[16:19]
    v_fma_f32 v120, v120, s28, s28
    v_mfma_f32_16x16x32_bf16 v[20:23], a[228:231], v[92:95], v[20:23]
    v_fma_f32 v121, v121, s28, s28
    v_mfma_f32_16x16x32_bf16 v[20:23], a[204:207], v[88:91], v[20:23]
    v_fma_f32 v122, v122, s28, s28
    v_mfma_f32_16x16x32_bf16 v[8:11], a[208:211], v[88:91], v[8:11]
    v_fma_f32 v123, v123, s28, s28
    v_mfma_f32_16x16x32_bf16 v[8:11], a[232:235], v[92:95], v[8:11]
    v_fma_f32 v124, v124, s28, s28
    v_mfma_f32_16x16x32_bf16 v[12:15], a[236:239], v[92:95], v[12:15]
    v_fma_f32 v125, v125, s28, s28
    v_mfma_f32_16x16x32_bf16 v[12:15], a[212:215], v[88:91], v[12:15]
    ds_read_b128 v[88:91], v2 offset:28672
    s_waitcnt lgkmcnt(2)
    v_mfma_f32_16x16x32_bf16 v[24:27], a[240:243], v[96:99], v[24:27]
    ds_read_b128 v[92:95], v2 offset:28928
    s_waitcnt lgkmcnt(2)
    v_mfma_f32_16x16x32_bf16 v[24:27], v[136:139], v[100:103], v[24:27]
    v_fma_f32 v126, v126, s28, s28
    v_mfma_f32_16x16x32_bf16 v[28:31], v[140:143], v[100:103], v[28:31]
    v_fma_f32 v127, v127, s28, s28
    v_mfma_f32_16x16x32_bf16 v[28:31], a[244:247], v[96:99], v[28:31]
    v_rcp_f32 v120, v120
    v_mfma_f32_16x16x32_bf16 v[16:19], a[248:251], v[96:99], v[16:19]
    v_rcp_f32 v121, v121
    v_mfma_f32_16x16x32_bf16 v[16:19], v[144:147], v[100:103], v[16:19]
    v_rcp_f32 v122, v122
    v_mfma_f32_16x16x32_bf16 v[20:23], v[148:151], v[100:103], v[20:23]
    v_rcp_f32 v123, v123
    v_mfma_f32_16x16x32_bf16 v[20:23], a[252:255], v[96:99], v[20:23]
    v_rcp_f32 v124, v124
    v_mfma_f32_16x16x32_bf16 v[8:11], v[128:131], v[96:99], v[8:11]
    v_rcp_f32 v125, v125
    v_mfma_f32_16x16x32_bf16 v[8:11], v[152:155], v[100:103], v[8:11]
    v_rcp_f32 v126, v126
    v_mfma_f32_16x16x32_bf16 v[12:15], v[156:159], v[100:103], v[12:15]
    v_rcp_f32 v127, v127
    v_mfma_f32_16x16x32_bf16 v[12:15], v[132:135], v[96:99], v[12:15]
    ds_read_b128 v[96:99], v2 offset:29184
    s_waitcnt lgkmcnt(2)
    v_mfma_f32_16x16x32_bf16 v[24:27], v[160:163], v[88:91], v[24:27]
    ds_read_b128 v[100:103], v2 offset:29440
    s_waitcnt lgkmcnt(2)
    v_mfma_f32_16x16x32_bf16 v[24:27], v[184:187], v[92:95], v[24:27]
    v_mul_f32 v32, v32, v120
    v_mfma_f32_16x16x32_bf16 v[28:31], v[188:191], v[92:95], v[28:31]
    v_mul_f32 v33, v33, v121
    v_mfma_f32_16x16x32_bf16 v[28:31], v[164:167], v[88:91], v[28:31]
    v_mul_f32 v34, v34, v122
    v_mfma_f32_16x16x32_bf16 v[16:19], v[168:171], v[88:91], v[16:19]
    v_mul_f32 v35, v35, v123
    v_mfma_f32_16x16x32_bf16 v[16:19], v[192:195], v[92:95], v[16:19]
    v_mul_f32 v36, v36, v124
    v_mfma_f32_16x16x32_bf16 v[20:23], v[196:199], v[92:95], v[20:23]
    v_mul_f32 v37, v37, v125
    v_mfma_f32_16x16x32_bf16 v[20:23], v[172:175], v[88:91], v[20:23]
    v_mul_f32 v38, v38, v126
    v_mfma_f32_16x16x32_bf16 v[8:11], v[176:179], v[88:91], v[8:11]
    v_mul_f32 v39, v39, v127
    v_mfma_f32_16x16x32_bf16 v[8:11], v[200:203], v[92:95], v[8:11]
    v_cvt_pk_bf16_f32 v32, v32, v33
    v_mfma_f32_16x16x32_bf16 v[12:15], v[204:207], v[92:95], v[12:15]
    v_cvt_pk_bf16_f32 v33, v34, v35
    v_mfma_f32_16x16x32_bf16 v[12:15], v[180:183], v[88:91], v[12:15]
    ds_read_b128 v[88:91], v2 offset:32768
    s_waitcnt lgkmcnt(2)
    v_mfma_f32_16x16x32_bf16 v[24:27], v[208:211], v[96:99], v[24:27]
    ds_read_b128 v[92:95], v2 offset:33024
    s_waitcnt lgkmcnt(2)
    v_mfma_f32_16x16x32_bf16 v[24:27], v[232:235], v[100:103], v[24:27]
    v_cvt_pk_bf16_f32 v34, v36, v37
    v_mfma_f32_16x16x32_bf16 v[28:31], v[236:239], v[100:103], v[28:31]
    v_cvt_pk_bf16_f32 v35, v38, v39
    v_mfma_f32_16x16x32_bf16 v[28:31], v[212:215], v[96:99], v[28:31]
    v_mfma_f32_16x16x32_bf16 v[16:19], v[216:219], v[96:99], v[16:19]
    v_permlane16_swap_b32 v32, v34
    v_mfma_f32_16x16x32_bf16 v[16:19], v[240:243], v[100:103], v[16:19]
    v_permlane16_swap_b32 v33, v35
    s_mov_b32 s22, 11264
    v_mfma_f32_16x16x32_bf16 v[20:23], v[244:247], v[100:103], v[20:23]
    buffer_store_dwordx4 v[32:35], v3, s[16:19], s22 offen nt
    v_mfma_f32_16x16x32_bf16 v[20:23], v[220:223], v[96:99], v[20:23]
    v_mfma_f32_16x16x32_bf16 v[8:11], v[224:227], v[96:99], v[8:11]
    v_mfma_f32_16x16x32_bf16 v[8:11], v[248:251], v[100:103], v[8:11]
    v_mfma_f32_16x16x32_bf16 v[12:15], v[252:255], v[100:103], v[12:15]
    v_mfma_f32_16x16x32_bf16 v[12:15], v[228:231], v[96:99], v[12:15]
    ds_read_b128 v[96:99], v2 offset:33280
    s_waitcnt lgkmcnt(2)
    v_mfma_f32_16x16x32_bf16 v[32:35], a[0:3], v[88:91], 0
    ds_read_b128 v[100:103], v2 offset:33536
    s_waitcnt lgkmcnt(2)
    v_mfma_f32_16x16x32_bf16 v[32:35], a[24:27], v[92:95], v[32:35]
    s_waitcnt vmcnt(18)
    v_fma_f32 v64, v64, v104, v112
    v_mfma_f32_16x16x32_bf16 v[36:39], a[28:31], v[92:95], 0
    s_barrier
    s_add_u32 m0, s21, 65536
    s_mov_b32 s29, 20480
    v_mfma_f32_16x16x32_bf16 v[36:39], a[4:7], v[88:91], v[36:39]
    buffer_load_dwordx4 v4, s[8:11], s29 offen lds
    v_mfma_f32_16x16x32_bf16 v[24:27], a[8:11], v[88:91], v[24:27]
    v_fma_f32 v65, v65, v105, v113
    v_mfma_f32_16x16x32_bf16 v[24:27], a[32:35], v[92:95], v[24:27]
    v_fma_f32 v66, v66, v106, v114
    v_mfma_f32_16x16x32_bf16 v[28:31], a[36:39], v[92:95], v[28:31]
    v_fma_f32 v67, v67, v107, v115
    v_mfma_f32_16x16x32_bf16 v[28:31], a[12:15], v[88:91], v[28:31]
    v_exp_f32 v120, v64
    v_mfma_f32_16x16x32_bf16 v[16:19], a[16:19], v[88:91], v[16:19]
    v_exp_f32 v121, v65
    v_mfma_f32_16x16x32_bf16 v[16:19], a[40:43], v[92:95], v[16:19]
    v_exp_f32 v122, v66
    v_mfma_f32_16x16x32_bf16 v[20:23], a[44:47], v[92:95], v[20:23]
    v_exp_f32 v123, v67
    v_mfma_f32_16x16x32_bf16 v[20:23], a[20:23], v[88:91], v[20:23]
    ds_read_b128 v[88:91], v2 offset:36864
    s_waitcnt lgkmcnt(2)
    v_mfma_f32_16x16x32_bf16 v[32:35], a[48:51], v[96:99], v[32:35]
    ds_read_b128 v[92:95], v2 offset:37120
    s_waitcnt lgkmcnt(2)
    v_mfma_f32_16x16x32_bf16 v[32:35], a[72:75], v[100:103], v[32:35]
    v_fma_f32 v120, v120, s28, s28
    s_add_u32 m0, s21, 69632
    v_mfma_f32_16x16x32_bf16 v[36:39], a[76:79], v[100:103], v[36:39]
    buffer_load_dwordx4 v5, s[8:11], s29 offen lds
    v_mfma_f32_16x16x32_bf16 v[36:39], a[52:55], v[96:99], v[36:39]
    v_fma_f32 v121, v121, s28, s28
    v_mfma_f32_16x16x32_bf16 v[24:27], a[56:59], v[96:99], v[24:27]
    v_fma_f32 v122, v122, s28, s28
    v_mfma_f32_16x16x32_bf16 v[24:27], a[80:83], v[100:103], v[24:27]
    v_fma_f32 v123, v123, s28, s28
    v_mfma_f32_16x16x32_bf16 v[28:31], a[84:87], v[100:103], v[28:31]
    v_rcp_f32 v120, v120
    v_mfma_f32_16x16x32_bf16 v[28:31], a[60:63], v[96:99], v[28:31]
    v_rcp_f32 v121, v121
    v_mfma_f32_16x16x32_bf16 v[16:19], a[64:67], v[96:99], v[16:19]
    v_rcp_f32 v122, v122
    v_mfma_f32_16x16x32_bf16 v[16:19], a[88:91], v[100:103], v[16:19]
    v_rcp_f32 v123, v123
    v_mfma_f32_16x16x32_bf16 v[20:23], a[92:95], v[100:103], v[20:23]
    v_mul_f32 v64, v64, v120
    s_add_u32 m0, s21, 73728
    v_mfma_f32_16x16x32_bf16 v[20:23], a[68:71], v[96:99], v[20:23]
    ds_read_b128 v[96:99], v2 offset:37376
    s_waitcnt lgkmcnt(2)
    v_mfma_f32_16x16x32_bf16 v[32:35], a[96:99], v[88:91], v[32:35]
    ds_read_b128 v[100:103], v2 offset:37632
    s_waitcnt lgkmcnt(2)
    v_mfma_f32_16x16x32_bf16 v[32:35], a[120:123], v[92:95], v[32:35]
    buffer_load_dwordx4 v6, s[8:11], s29 offen lds
    v_mfma_f32_16x16x32_bf16 v[36:39], a[124:127], v[92:95], v[36:39]
    v_mul_f32 v65, v65, v121
    v_mfma_f32_16x16x32_bf16 v[36:39], a[100:103], v[88:91], v[36:39]
    v_mul_f32 v66, v66, v122
    v_mfma_f32_16x16x32_bf16 v[24:27], a[104:107], v[88:91], v[24:27]
    v_mul_f32 v67, v67, v123
    v_mfma_f32_16x16x32_bf16 v[24:27], a[128:131], v[92:95], v[24:27]
    v_cvt_pk_bf16_f32 v64, v64, v65
    v_mfma_f32_16x16x32_bf16 v[28:31], a[132:135], v[92:95], v[28:31]
    v_cvt_pk_bf16_f32 v65, v66, v67
    v_mfma_f32_16x16x32_bf16 v[28:31], a[108:111], v[88:91], v[28:31]
    v_fma_f32 v8, v8, v104, v112
    v_mfma_f32_16x16x32_bf16 v[16:19], a[112:115], v[88:91], v[16:19]
    v_fma_f32 v9, v9, v105, v113
    v_mfma_f32_16x16x32_bf16 v[16:19], a[136:139], v[92:95], v[16:19]
    v_fma_f32 v10, v10, v106, v114
    s_add_u32 m0, s21, 77824
    v_mfma_f32_16x16x32_bf16 v[20:23], a[140:143], v[92:95], v[20:23]
    buffer_load_dwordx4 v7, s[8:11], s29 offen lds
    v_mfma_f32_16x16x32_bf16 v[20:23], a[116:119], v[88:91], v[20:23]
    ds_read_b128 v[88:91], v2 offset:40960
    s_waitcnt lgkmcnt(2)
    v_mfma_f32_16x16x32_bf16 v[32:35], a[144:147], v[96:99], v[32:35]
    ds_read_b128 v[92:95], v2 offset:41216
    s_waitcnt lgkmcnt(2)
    v_mfma_f32_16x16x32_bf16 v[32:35], a[168:171], v[100:103], v[32:35]
    v_fma_f32 v11, v11, v107, v115
    v_mfma_f32_16x16x32_bf16 v[36:39], a[172:175], v[100:103], v[36:39]
    v_fma_f32 v12, v12, v108, v116
    v_mfma_f32_16x16x32_bf16 v[36:39], a[148:151], v[96:99], v[36:39]
    v_fma_f32 v13, v13, v109, v117
    v_mfma_f32_16x16x32_bf16 v[24:27], a[152:155], v[96:99], v[24:27]
    v_fma_f32 v14, v14, v110, v118
    v_mfma_f32_16x16x32_bf16 v[24:27], a[176:179], v[100:103], v[24:27]
    v_fma_f32 v15, v15, v111, v119
    v_mfma_f32_16x16x32_bf16 v[28:31], a[180:183], v[100:103], v[28:31]
    v_exp_f32 v120, v8
    s_add_u32 m0, s21, 81920
    s_mov_b32 s29, 21504
    v_mfma_f32_16x16x32_bf16 v[28:31], a[156:159], v[96:99], v[28:31]
    buffer_load_dwordx4 v4, s[8:11], s29 offen lds
    v_mfma_f32_16x16x32_bf16 v[16:19], a[160:163], v[96:99], v[16:19]
    v_exp_f32 v121, v9
    v_mfma_f32_16x16x32_bf16 v[16:19], a[184:187], v[100:103], v[16:19]
    v_exp_f32 v122, v10
    v_mfma_f32_16x16x32_bf16 v[20:23], a[188:191], v[100:103], v[20:23]
    v_exp_f32 v123, v11
    v_mfma_f32_16x16x32_bf16 v[20:23], a[164:167], v[96:99], v[20:23]
    ds_read_b128 v[96:99], v2 offset:41472
    s_waitcnt lgkmcnt(2)
    v_mfma_f32_16x16x32_bf16 v[32:35], a[192:195], v[88:91], v[32:35]
    ds_read_b128 v[100:103], v2 offset:41728
    s_waitcnt lgkmcnt(2)
    v_mfma_f32_16x16x32_bf16 v[32:35], a[216:219], v[92:95], v[32:35]
    v_exp_f32 v124, v12
    v_mfma_f32_16x16x32_bf16 v[36:39], a[220:223], v[92:95], v[36:39]
    v_exp_f32 v125, v13
    v_mfma_f32_16x16x32_bf16 v[36:39], a[196:199], v[88:91], v[36:39]
    v_exp_f32 v126, v14
    s_add_u32 m0, s21, 86016
    v_mfma_f32_16x16x32_bf16 v[24:27], a[200:203], v[88:91], v[24:27]
    buffer_load_dwordx4 v5, s[8:11], s29 offen lds
    v_mfma_f32_16x16x32_bf16 v[24:27], a[224:227], v[92:95], v[24:27]
    v_exp_f32 v127, v15
    v_mfma_f32_16x16x32_bf16 v[28:31], a[228:231], v[92:95], v[28:31]
    v_fma_f32 v120, v120, s28, s28
    v_mfma_f32_16x16x32_bf16 v[28:31], a[204:207], v[88:91], v[28:31]
    v_fma_f32 v121, v121, s28, s28
    v_mfma_f32_16x16x32_bf16 v[16:19], a[208:211], v[88:91], v[16:19]
    v_fma_f32 v122, v122, s28, s28
    v_mfma_f32_16x16x32_bf16 v[16:19], a[232:235], v[92:95], v[16:19]
    v_fma_f32 v123, v123, s28, s28
    v_mfma_f32_16x16x32_bf16 v[20:23], a[236:239], v[92:95], v[20:23]
    v_fma_f32 v124, v124, s28, s28
    v_mfma_f32_16x16x32_bf16 v[20:23], a[212:215], v[88:91], v[20:23]
    ds_read_b128 v[88:91], v2 offset:45056
    s_waitcnt lgkmcnt(2)
    v_mfma_f32_16x16x32_bf16 v[32:35], a[240:243], v[96:99], v[32:35]
    ds_read_b128 v[92:95], v2 offset:45312
    s_waitcnt lgkmcnt(2)
    v_mfma_f32_16x16x32_bf16 v[32:35], v[136:139], v[100:103], v[32:35]
    v_fma_f32 v125, v125, s28, s28
    v_mfma_f32_16x16x32_bf16 v[36:39], v[140:143], v[100:103], v[36:39]
    v_fma_f32 v126, v126, s28, s28
    v_mfma_f32_16x16x32_bf16 v[36:39], a[244:247], v[96:99], v[36:39]
    v_fma_f32 v127, v127, s28, s28
    v_mfma_f32_16x16x32_bf16 v[24:27], a[248:251], v[96:99], v[24:27]
    v_rcp_f32 v120, v120
    v_mfma_f32_16x16x32_bf16 v[24:27], v[144:147], v[100:103], v[24:27]
    v_rcp_f32 v121, v121
    v_mfma_f32_16x16x32_bf16 v[28:31], v[148:151], v[100:103], v[28:31]
    v_rcp_f32 v122, v122
    v_mfma_f32_16x16x32_bf16 v[28:31], a[252:255], v[96:99], v[28:31]
    v_rcp_f32 v123, v123
    v_mfma_f32_16x16x32_bf16 v[16:19], v[128:131], v[96:99], v[16:19]
    v_rcp_f32 v124, v124
    v_mfma_f32_16x16x32_bf16 v[16:19], v[152:155], v[100:103], v[16:19]
    v_rcp_f32 v125, v125
    v_mfma_f32_16x16x32_bf16 v[20:23], v[156:159], v[100:103], v[20:23]
    v_rcp_f32 v126, v126
    v_mfma_f32_16x16x32_bf16 v[20:23], v[132:135], v[96:99], v[20:23]
    ds_read_b128 v[96:99], v2 offset:45568
    s_waitcnt lgkmcnt(2)
    v_mfma_f32_16x16x32_bf16 v[32:35], v[160:163], v[88:91], v[32:35]
    ds_read_b128 v[100:103], v2 offset:45824
    s_waitcnt lgkmcnt(2)
    v_mfma_f32_16x16x32_bf16 v[32:35], v[184:187], v[92:95], v[32:35]
    v_rcp_f32 v127, v127
    v_mfma_f32_16x16x32_bf16 v[36:39], v[188:191], v[92:95], v[36:39]
    v_mul_f32 v8, v8, v120
    v_mfma_f32_16x16x32_bf16 v[36:39], v[164:167], v[88:91], v[36:39]
    v_mul_f32 v9, v9, v121
    v_mfma_f32_16x16x32_bf16 v[24:27], v[168:171], v[88:91], v[24:27]
    v_mul_f32 v10, v10, v122
    v_mfma_f32_16x16x32_bf16 v[24:27], v[192:195], v[92:95], v[24:27]
    v_mul_f32 v11, v11, v123
    v_mfma_f32_16x16x32_bf16 v[28:31], v[196:199], v[92:95], v[28:31]
    v_mul_f32 v12, v12, v124
    v_mfma_f32_16x16x32_bf16 v[28:31], v[172:175], v[88:91], v[28:31]
    v_mul_f32 v13, v13, v125
    v_mfma_f32_16x16x32_bf16 v[16:19], v[176:179], v[88:91], v[16:19]
    v_mul_f32 v14, v14, v126
    v_mfma_f32_16x16x32_bf16 v[16:19], v[200:203], v[92:95], v[16:19]
    v_mul_f32 v15, v15, v127
    v_mfma_f32_16x16x32_bf16 v[20:23], v[204:207], v[92:95], v[20:23]
    v_cvt_pk_bf16_f32 v8, v8, v9
    v_mfma_f32_16x16x32_bf16 v[20:23], v[180:183], v[88:91], v[20:23]
    ds_read_b128 v[88:91], v2 offset:49152
    s_waitcnt lgkmcnt(2)
    v_mfma_f32_16x16x32_bf16 v[32:35], v[208:211], v[96:99], v[32:35]
    ds_read_b128 v[92:95], v2 offset:49408
    s_waitcnt lgkmcnt(2)
    v_mfma_f32_16x16x32_bf16 v[32:35], v[232:235], v[100:103], v[32:35]
    v_cvt_pk_bf16_f32 v9, v10, v11
    v_mfma_f32_16x16x32_bf16 v[36:39], v[236:239], v[100:103], v[36:39]
    v_cvt_pk_bf16_f32 v10, v12, v13
    v_mfma_f32_16x16x32_bf16 v[36:39], v[212:215], v[96:99], v[36:39]
    v_cvt_pk_bf16_f32 v11, v14, v15
    v_mfma_f32_16x16x32_bf16 v[24:27], v[216:219], v[96:99], v[24:27]
    v_mfma_f32_16x16x32_bf16 v[24:27], v[240:243], v[100:103], v[24:27]
    v_permlane16_swap_b32 v8, v10
    v_mfma_f32_16x16x32_bf16 v[28:31], v[244:247], v[100:103], v[28:31]
    v_permlane16_swap_b32 v9, v11
    s_mov_b32 s22, 12288
    v_mfma_f32_16x16x32_bf16 v[28:31], v[220:223], v[96:99], v[28:31]
    buffer_store_dwordx4 v[8:11], v3, s[16:19], s22 offen nt
    v_mfma_f32_16x16x32_bf16 v[16:19], v[224:227], v[96:99], v[16:19]
    v_mfma_f32_16x16x32_bf16 v[16:19], v[248:251], v[100:103], v[16:19]
    v_mfma_f32_16x16x32_bf16 v[20:23], v[252:255], v[100:103], v[20:23]
    v_mfma_f32_16x16x32_bf16 v[20:23], v[228:231], v[96:99], v[20:23]
    ds_read_b128 v[96:99], v2 offset:49664
    s_waitcnt lgkmcnt(2)
    v_mfma_f32_16x16x32_bf16 v[8:11], a[0:3], v[88:91], 0
    ds_read_b128 v[100:103], v2 offset:49920
    s_waitcnt lgkmcnt(2)
    v_mfma_f32_16x16x32_bf16 v[8:11], a[24:27], v[92:95], v[8:11]
    v_fma_f32 v68, v68, v108, v116
    s_add_u32 m0, s21, 90112
    v_mfma_f32_16x16x32_bf16 v[12:15], a[28:31], v[92:95], 0
    buffer_load_dwordx4 v6, s[8:11], s29 offen lds
    v_mfma_f32_16x16x32_bf16 v[12:15], a[4:7], v[88:91], v[12:15]
    v_fma_f32 v69, v69, v109, v117
    v_mfma_f32_16x16x32_bf16 v[32:35], a[8:11], v[88:91], v[32:35]
    v_fma_f32 v70, v70, v110, v118
    v_mfma_f32_16x16x32_bf16 v[32:35], a[32:35], v[92:95], v[32:35]
    v_fma_f32 v71, v71, v111, v119
    v_mfma_f32_16x16x32_bf16 v[36:39], a[36:39], v[92:95], v[36:39]
    v_exp_f32 v124, v68
    v_mfma_f32_16x16x32_bf16 v[36:39], a[12:15], v[88:91], v[36:39]
    v_exp_f32 v125, v69
    v_mfma_f32_16x16x32_bf16 v[24:27], a[16:19], v[88:91], v[24:27]
    v_exp_f32 v126, v70
    v_mfma_f32_16x16x32_bf16 v[24:27], a[40:43], v[92:95], v[24:27]
    v_exp_f32 v127, v71
    v_mfma_f32_16x16x32_bf16 v[28:31], a[44:47], v[92:95], v[28:31]
    v_fma_f32 v124, v124, s28, s28
    s_add_u32 m0, s21, 94208
    v_mfma_f32_16x16x32_bf16 v[28:31], a[20:23], v[88:91], v[28:31]
    ds_read_b128 v[88:91], v2 offset:53248
    s_waitcnt lgkmcnt(2)
    v_mfma_f32_16x16x32_bf16 v[8:11], a[48:51], v[96:99], v[8:11]
    ds_read_b128 v[92:95], v2 offset:53504
    s_waitcnt lgkmcnt(2)
    v_mfma_f32_16x16x32_bf16 v[8:11], a[72:75], v[100:103], v[8:11]
    buffer_load_dwordx4 v7, s[8:11], s29 offen lds
    v_mfma_f32_16x16x32_bf16 v[12:15], a[76:79], v[100:103], v[12:15]
    v_fma_f32 v125, v125, s28, s28
    v_mfma_f32_16x16x32_bf16 v[12:15], a[52:55], v[96:99], v[12:15]
    v_fma_f32 v126, v126, s28, s28
    v_mfma_f32_16x16x32_bf16 v[32:35], a[56:59], v[96:99], v[32:35]
    v_fma_f32 v127, v127, s28, s28
    v_mfma_f32_16x16x32_bf16 v[32:35], a[80:83], v[100:103], v[32:35]
    v_rcp_f32 v124, v124
    v_mfma_f32_16x16x32_bf16 v[36:39], a[84:87], v[100:103], v[36:39]
    v_rcp_f32 v125, v125
    v_mfma_f32_16x16x32_bf16 v[36:39], a[60:63], v[96:99], v[36:39]
    v_rcp_f32 v126, v126
    v_mfma_f32_16x16x32_bf16 v[24:27], a[64:67], v[96:99], v[24:27]
    v_rcp_f32 v127, v127
    v_mfma_f32_16x16x32_bf16 v[24:27], a[88:91], v[100:103], v[24:27]
    v_mul_f32 v68, v68, v124
    s_add_u32 m0, s21, 131072
    s_mov_b32 s29, L_loop-L_pc
    v_mfma_f32_16x16x32_bf16 v[28:31], a[92:95], v[100:103], v[28:31]
    buffer_load_dword v0, s[64:67], s29 offen lds
    v_mfma_f32_16x16x32_bf16 v[28:31], a[68:71], v[96:99], v[28:31]
    ds_read_b128 v[96:99], v2 offset:53760
    s_waitcnt lgkmcnt(2)
    v_mfma_f32_16x16x32_bf16 v[8:11], a[96:99], v[88:91], v[8:11]
    ds_read_b128 v[100:103], v2 offset:54016
    s_waitcnt lgkmcnt(2)
    v_mfma_f32_16x16x32_bf16 v[8:11], a[120:123], v[92:95], v[8:11]
    v_mul_f32 v69, v69, v125
    v_mfma_f32_16x16x32_bf16 v[12:15], a[124:127], v[92:95], v[12:15]
    v_mul_f32 v70, v70, v126
    v_mfma_f32_16x16x32_bf16 v[12:15], a[100:103], v[88:91], v[12:15]
    v_mul_f32 v71, v71, v127
    v_mfma_f32_16x16x32_bf16 v[32:35], a[104:107], v[88:91], v[32:35]
    v_cvt_pk_bf16_f32 v66, v68, v69
    v_mfma_f32_16x16x32_bf16 v[32:35], a[128:131], v[92:95], v[32:35]
    v_cvt_pk_bf16_f32 v67, v70, v71
    v_mfma_f32_16x16x32_bf16 v[36:39], a[132:135], v[92:95], v[36:39]
    v_mfma_f32_16x16x32_bf16 v[36:39], a[108:111], v[88:91], v[36:39]
    v_permlane16_swap_b32 v64, v66
    v_mfma_f32_16x16x32_bf16 v[24:27], a[112:115], v[88:91], v[24:27]
    v_permlane16_swap_b32 v65, v67
    s_mov_b32 s22, 3072
    v_mfma_f32_16x16x32_bf16 v[24:27], a[136:139], v[92:95], v[24:27]
    buffer_store_dwordx4 v[64:67], v3, s[16:19], s22 offen nt
    v_mfma_f32_16x16x32_bf16 v[28:31], a[140:143], v[92:95], v[28:31]
    v_fma_f32 v16, v16, v104, v112
    v_mfma_f32_16x16x32_bf16 v[28:31], a[116:119], v[88:91], v[28:31]
    ds_read_b128 v[88:91], v2 offset:57344
    s_waitcnt lgkmcnt(2)
    v_mfma_f32_16x16x32_bf16 v[8:11], a[144:147], v[96:99], v[8:11]
    ds_read_b128 v[92:95], v2 offset:57600
    s_waitcnt lgkmcnt(2)
    v_mfma_f32_16x16x32_bf16 v[8:11], a[168:171], v[100:103], v[8:11]
    v_fma_f32 v17, v17, v105, v113
    v_mfma_f32_16x16x32_bf16 v[12:15], a[172:175], v[100:103], v[12:15]
    v_fma_f32 v18, v18, v106, v114
    v_mfma_f32_16x16x32_bf16 v[12:15], a[148:151], v[96:99], v[12:15]
    v_fma_f32 v19, v19, v107, v115
    v_mfma_f32_16x16x32_bf16 v[32:35], a[152:155], v[96:99], v[32:35]
    v_fma_f32 v20, v20, v108, v116
    v_mfma_f32_16x16x32_bf16 v[32:35], a[176:179], v[100:103], v[32:35]
    v_fma_f32 v21, v21, v109, v117
    v_mfma_f32_16x16x32_bf16 v[36:39], a[180:183], v[100:103], v[36:39]
    v_fma_f32 v22, v22, v110, v118
    v_mfma_f32_16x16x32_bf16 v[36:39], a[156:159], v[96:99], v[36:39]
    v_fma_f32 v23, v23, v111, v119
    v_mfma_f32_16x16x32_bf16 v[24:27], a[160:163], v[96:99], v[24:27]
    v_exp_f32 v120, v16
    v_mfma_f32_16x16x32_bf16 v[24:27], a[184:187], v[100:103], v[24:27]
    v_exp_f32 v121, v17
    v_mfma_f32_16x16x32_bf16 v[28:31], a[188:191], v[100:103], v[28:31]
    v_exp_f32 v122, v18
    v_mfma_f32_16x16x32_bf16 v[28:31], a[164:167], v[96:99], v[28:31]
    ds_read_b128 v[96:99], v2 offset:57856
    s_waitcnt lgkmcnt(2)
    v_mfma_f32_16x16x32_bf16 v[8:11], a[192:195], v[88:91], v[8:11]
    ds_read_b128 v[100:103], v2 offset:58112
    s_waitcnt lgkmcnt(2)
    v_mfma_f32_16x16x32_bf16 v[8:11], a[216:219], v[92:95], v[8:11]
    v_exp_f32 v123, v19
    v_mfma_f32_16x16x32_bf16 v[12:15], a[220:223], v[92:95], v[12:15]
    v_exp_f32 v124, v20
    v_mfma_f32_16x16x32_bf16 v[12:15], a[196:199], v[88:91], v[12:15]
    v_exp_f32 v125, v21
    v_mfma_f32_16x16x32_bf16 v[32:35], a[200:203], v[88:91], v[32:35]
    v_exp_f32 v126, v22
    v_mfma_f32_16x16x32_bf16 v[32:35], a[224:227], v[92:95], v[32:35]
    v_exp_f32 v127, v23
    v_mfma_f32_16x16x32_bf16 v[36:39], a[228:231], v[92:95], v[36:39]
    v_fma_f32 v120, v120, s28, s28
    v_mfma_f32_16x16x32_bf16 v[36:39], a[204:207], v[88:91], v[36:39]
    v_fma_f32 v121, v121, s28, s28
    v_mfma_f32_16x16x32_bf16 v[24:27], a[208:211], v[88:91], v[24:27]
    v_fma_f32 v122, v122, s28, s28
    v_mfma_f32_16x16x32_bf16 v[24:27], a[232:235], v[92:95], v[24:27]
    v_fma_f32 v123, v123, s28, s28
    v_mfma_f32_16x16x32_bf16 v[28:31], a[236:239], v[92:95], v[28:31]
    v_fma_f32 v124, v124, s28, s28
    v_mfma_f32_16x16x32_bf16 v[28:31], a[212:215], v[88:91], v[28:31]
    ds_read_b128 v[88:91], v2 offset:61440
    s_waitcnt lgkmcnt(2)
    v_mfma_f32_16x16x32_bf16 v[8:11], a[240:243], v[96:99], v[8:11]
    ds_read_b128 v[92:95], v2 offset:61696
    s_waitcnt lgkmcnt(2)
    v_mfma_f32_16x16x32_bf16 v[8:11], v[136:139], v[100:103], v[8:11]
    v_fma_f32 v125, v125, s28, s28
    v_mfma_f32_16x16x32_bf16 v[12:15], v[140:143], v[100:103], v[12:15]
    v_fma_f32 v126, v126, s28, s28
    v_mfma_f32_16x16x32_bf16 v[12:15], a[244:247], v[96:99], v[12:15]
    v_fma_f32 v127, v127, s28, s28
    v_mfma_f32_16x16x32_bf16 v[32:35], a[248:251], v[96:99], v[32:35]
    v_rcp_f32 v120, v120
    v_mfma_f32_16x16x32_bf16 v[32:35], v[144:147], v[100:103], v[32:35]
    v_rcp_f32 v121, v121
    v_mfma_f32_16x16x32_bf16 v[36:39], v[148:151], v[100:103], v[36:39]
    v_rcp_f32 v122, v122
    v_mfma_f32_16x16x32_bf16 v[36:39], a[252:255], v[96:99], v[36:39]
    v_rcp_f32 v123, v123
    v_mfma_f32_16x16x32_bf16 v[24:27], v[128:131], v[96:99], v[24:27]
    v_rcp_f32 v124, v124
    v_mfma_f32_16x16x32_bf16 v[24:27], v[152:155], v[100:103], v[24:27]
    v_rcp_f32 v125, v125
    v_mfma_f32_16x16x32_bf16 v[28:31], v[156:159], v[100:103], v[28:31]
    v_rcp_f32 v126, v126
    v_mfma_f32_16x16x32_bf16 v[28:31], v[132:135], v[96:99], v[28:31]
    ds_read_b128 v[96:99], v2 offset:61952
    s_waitcnt lgkmcnt(2)
    v_mfma_f32_16x16x32_bf16 v[8:11], v[160:163], v[88:91], v[8:11]
    ds_read_b128 v[100:103], v2 offset:62208
    s_waitcnt lgkmcnt(2)
    v_mfma_f32_16x16x32_bf16 v[8:11], v[184:187], v[92:95], v[8:11]
    v_rcp_f32 v127, v127
    v_mfma_f32_16x16x32_bf16 v[12:15], v[188:191], v[92:95], v[12:15]
    v_mul_f32 v16, v16, v120
    v_mfma_f32_16x16x32_bf16 v[12:15], v[164:167], v[88:91], v[12:15]
    v_mul_f32 v17, v17, v121
    v_mfma_f32_16x16x32_bf16 v[32:35], v[168:171], v[88:91], v[32:35]
    v_mul_f32 v18, v18, v122
    v_mfma_f32_16x16x32_bf16 v[32:35], v[192:195], v[92:95], v[32:35]
    v_mul_f32 v19, v19, v123
    v_mfma_f32_16x16x32_bf16 v[36:39], v[196:199], v[92:95], v[36:39]
    v_mul_f32 v20, v20, v124
    v_mfma_f32_16x16x32_bf16 v[36:39], v[172:175], v[88:91], v[36:39]
    v_mul_f32 v21, v21, v125
    v_mfma_f32_16x16x32_bf16 v[24:27], v[176:179], v[88:91], v[24:27]
    v_mul_f32 v22, v22, v126
    v_mfma_f32_16x16x32_bf16 v[24:27], v[200:203], v[92:95], v[24:27]
    v_mul_f32 v23, v23, v127
    v_mfma_f32_16x16x32_bf16 v[28:31], v[204:207], v[92:95], v[28:31]
    v_cvt_pk_bf16_f32 v16, v16, v17
    v_mfma_f32_16x16x32_bf16 v[28:31], v[180:183], v[88:91], v[28:31]
    ds_read_b128 v[88:91], v1 offset:0
    s_waitcnt lgkmcnt(2)
    v_mfma_f32_16x16x32_bf16 v[8:11], v[208:211], v[96:99], v[8:11]
    ds_read_b128 v[92:95], v1 offset:256
    s_waitcnt lgkmcnt(2)
    v_mfma_f32_16x16x32_bf16 v[8:11], v[232:235], v[100:103], v[8:11]
    v_cvt_pk_bf16_f32 v17, v18, v19
    v_mfma_f32_16x16x32_bf16 v[12:15], v[236:239], v[100:103], v[12:15]
    v_cvt_pk_bf16_f32 v18, v20, v21
    v_mfma_f32_16x16x32_bf16 v[12:15], v[212:215], v[96:99], v[12:15]
    v_cvt_pk_bf16_f32 v19, v22, v23
    v_mfma_f32_16x16x32_bf16 v[32:35], v[216:219], v[96:99], v[32:35]
    v_mfma_f32_16x16x32_bf16 v[32:35], v[240:243], v[100:103], v[32:35]
    v_permlane16_swap_b32 v16, v18
    v_mfma_f32_16x16x32_bf16 v[36:39], v[244:247], v[100:103], v[36:39]
    v_permlane16_swap_b32 v17, v19
    s_mov_b32 s22, 13312
    v_mfma_f32_16x16x32_bf16 v[36:39], v[220:223], v[96:99], v[36:39]
    buffer_store_dwordx4 v[16:19], v3, s[16:19], s22 offen nt
    v_mfma_f32_16x16x32_bf16 v[24:27], v[224:227], v[96:99], v[24:27]
    v_mfma_f32_16x16x32_bf16 v[24:27], v[248:251], v[100:103], v[24:27]
    v_mfma_f32_16x16x32_bf16 v[28:31], v[252:255], v[100:103], v[28:31]
    v_mfma_f32_16x16x32_bf16 v[28:31], v[228:231], v[96:99], v[28:31]
    ds_read_b128 v[96:99], v1 offset:512
    s_waitcnt lgkmcnt(2)
    v_mfma_f32_16x16x32_bf16 v[16:19], a[0:3], v[88:91], 0
    ds_read_b128 v[100:103], v1 offset:768
    s_waitcnt lgkmcnt(2)
    v_mfma_f32_16x16x32_bf16 v[16:19], a[24:27], v[92:95], v[16:19]
    s_waitcnt vmcnt(19)
    v_fma_f32 v72, v72, v104, v112
    v_mfma_f32_16x16x32_bf16 v[20:23], a[28:31], v[92:95], 0
    s_barrier
    s_add_u32 m0, s21, 98304
    s_mov_b32 s29, 22528
    v_mfma_f32_16x16x32_bf16 v[20:23], a[4:7], v[88:91], v[20:23]
    buffer_load_dwordx4 v4, s[8:11], s29 offen lds
    v_mfma_f32_16x16x32_bf16 v[8:11], a[8:11], v[88:91], v[8:11]
    v_fma_f32 v73, v73, v105, v113
    v_mfma_f32_16x16x32_bf16 v[8:11], a[32:35], v[92:95], v[8:11]
    v_fma_f32 v74, v74, v106, v114
    v_mfma_f32_16x16x32_bf16 v[12:15], a[36:39], v[92:95], v[12:15]
    v_fma_f32 v75, v75, v107, v115
    v_mfma_f32_16x16x32_bf16 v[12:15], a[12:15], v[88:91], v[12:15]
    v_exp_f32 v120, v72
    v_mfma_f32_16x16x32_bf16 v[32:35], a[16:19], v[88:91], v[32:35]
    v_exp_f32 v121, v73
    v_mfma_f32_16x16x32_bf16 v[32:35], a[40:43], v[92:95], v[32:35]
    v_exp_f32 v122, v74
    v_mfma_f32_16x16x32_bf16 v[36:39], a[44:47], v[92:95], v[36:39]
    v_exp_f32 v123, v75
    v_mfma_f32_16x16x32_bf16 v[36:39], a[20:23], v[88:91], v[36:39]
    ds_read_b128 v[88:91], v1 offset:4096
    s_waitcnt lgkmcnt(2)
    v_mfma_f32_16x16x32_bf16 v[16:19], a[48:51], v[96:99], v[16:19]
    ds_read_b128 v[92:95], v1 offset:4352
    s_waitcnt lgkmcnt(2)
    v_mfma_f32_16x16x32_bf16 v[16:19], a[72:75], v[100:103], v[16:19]
    v_fma_f32 v120, v120, s28, s28
    s_add_u32 m0, s21, 102400
    v_mfma_f32_16x16x32_bf16 v[20:23], a[76:79], v[100:103], v[20:23]
    buffer_load_dwordx4 v5, s[8:11], s29 offen lds
    v_mfma_f32_16x16x32_bf16 v[20:23], a[52:55], v[96:99], v[20:23]
    v_fma_f32 v121, v121, s28, s28
    v_mfma_f32_16x16x32_bf16 v[8:11], a[56:59], v[96:99], v[8:11]
    v_fma_f32 v122, v122, s28, s28
    v_mfma_f32_16x16x32_bf16 v[8:11], a[80:83], v[100:103], v[8:11]
    v_fma_f32 v123, v123, s28, s28
    v_mfma_f32_16x16x32_bf16 v[12:15], a[84:87], v[100:103], v[12:15]
    v_rcp_f32 v120, v120
    v_mfma_f32_16x16x32_bf16 v[12:15], a[60:63], v[96:99], v[12:15]
    v_rcp_f32 v121, v121
    v_mfma_f32_16x16x32_bf16 v[32:35], a[64:67], v[96:99], v[32:35]
    v_rcp_f32 v122, v122
    v_mfma_f32_16x16x32_bf16 v[32:35], a[88:91], v[100:103], v[32:35]
    v_rcp_f32 v123, v123
    v_mfma_f32_16x16x32_bf16 v[36:39], a[92:95], v[100:103], v[36:39]
    v_mul_f32 v72, v72, v120
    s_add_u32 m0, s21, 106496
    v_mfma_f32_16x16x32_bf16 v[36:39], a[68:71], v[96:99], v[36:39]
    ds_read_b128 v[96:99], v1 offset:4608
    s_waitcnt lgkmcnt(2)
    v_mfma_f32_16x16x32_bf16 v[16:19], a[96:99], v[88:91], v[16:19]
    ds_read_b128 v[100:103], v1 offset:4864
    s_waitcnt lgkmcnt(2)
    v_mfma_f32_16x16x32_bf16 v[16:19], a[120:123], v[92:95], v[16:19]
    buffer_load_dwordx4 v6, s[8:11], s29 offen lds
    v_mfma_f32_16x16x32_bf16 v[20:23], a[124:127], v[92:95], v[20:23]
    v_mul_f32 v73, v73, v121
    v_mfma_f32_16x16x32_bf16 v[20:23], a[100:103], v[88:91], v[20:23]
    v_mul_f32 v74, v74, v122
    v_mfma_f32_16x16x32_bf16 v[8:11], a[104:107], v[88:91], v[8:11]
    v_mul_f32 v75, v75, v123
    v_mfma_f32_16x16x32_bf16 v[8:11], a[128:131], v[92:95], v[8:11]
    v_cvt_pk_bf16_f32 v72, v72, v73
    v_mfma_f32_16x16x32_bf16 v[12:15], a[132:135], v[92:95], v[12:15]
    v_cvt_pk_bf16_f32 v73, v74, v75
    v_mfma_f32_16x16x32_bf16 v[12:15], a[108:111], v[88:91], v[12:15]
    v_fma_f32 v24, v24, v104, v112
    v_mfma_f32_16x16x32_bf16 v[32:35], a[112:115], v[88:91], v[32:35]
    v_fma_f32 v25, v25, v105, v113
    v_mfma_f32_16x16x32_bf16 v[32:35], a[136:139], v[92:95], v[32:35]
    v_fma_f32 v26, v26, v106, v114
    s_add_u32 m0, s21, 110592
    v_mfma_f32_16x16x32_bf16 v[36:39], a[140:143], v[92:95], v[36:39]
    buffer_load_dwordx4 v7, s[8:11], s29 offen lds
    v_mfma_f32_16x16x32_bf16 v[36:39], a[116:119], v[88:91], v[36:39]
    ds_read_b128 v[88:91], v1 offset:8192
    s_waitcnt lgkmcnt(2)
    v_mfma_f32_16x16x32_bf16 v[16:19], a[144:147], v[96:99], v[16:19]
    ds_read_b128 v[92:95], v1 offset:8448
    s_waitcnt lgkmcnt(2)
    v_mfma_f32_16x16x32_bf16 v[16:19], a[168:171], v[100:103], v[16:19]
    v_fma_f32 v27, v27, v107, v115
    v_mfma_f32_16x16x32_bf16 v[20:23], a[172:175], v[100:103], v[20:23]
    v_fma_f32 v28, v28, v108, v116
    v_mfma_f32_16x16x32_bf16 v[20:23], a[148:151], v[96:99], v[20:23]
    v_fma_f32 v29, v29, v109, v117
    v_mfma_f32_16x16x32_bf16 v[8:11], a[152:155], v[96:99], v[8:11]
    v_fma_f32 v30, v30, v110, v118
    v_mfma_f32_16x16x32_bf16 v[8:11], a[176:179], v[100:103], v[8:11]
    v_fma_f32 v31, v31, v111, v119
    v_mfma_f32_16x16x32_bf16 v[12:15], a[180:183], v[100:103], v[12:15]
    v_exp_f32 v120, v24
    s_add_u32 m0, s21, 114688
    s_mov_b32 s29, 23552
    v_mfma_f32_16x16x32_bf16 v[12:15], a[156:159], v[96:99], v[12:15]
    buffer_load_dwordx4 v4, s[8:11], s29 offen lds
    v_mfma_f32_16x16x32_bf16 v[32:35], a[160:163], v[96:99], v[32:35]
    v_exp_f32 v121, v25
    v_mfma_f32_16x16x32_bf16 v[32:35], a[184:187], v[100:103], v[32:35]
    v_exp_f32 v122, v26
    v_mfma_f32_16x16x32_bf16 v[36:39], a[188:191], v[100:103], v[36:39]
    v_exp_f32 v123, v27
    v_mfma_f32_16x16x32_bf16 v[36:39], a[164:167], v[96:99], v[36:39]
    ds_read_b128 v[96:99], v1 offset:8704
    s_waitcnt lgkmcnt(2)
    v_mfma_f32_16x16x32_bf16 v[16:19], a[192:195], v[88:91], v[16:19]
    ds_read_b128 v[100:103], v1 offset:8960
    s_waitcnt lgkmcnt(2)
    v_mfma_f32_16x16x32_bf16 v[16:19], a[216:219], v[92:95], v[16:19]
    v_exp_f32 v124, v28
    v_mfma_f32_16x16x32_bf16 v[20:23], a[220:223], v[92:95], v[20:23]
    v_exp_f32 v125, v29
    v_mfma_f32_16x16x32_bf16 v[20:23], a[196:199], v[88:91], v[20:23]
    v_exp_f32 v126, v30
    s_add_u32 m0, s21, 118784
    v_mfma_f32_16x16x32_bf16 v[8:11], a[200:203], v[88:91], v[8:11]
    buffer_load_dwordx4 v5, s[8:11], s29 offen lds
    v_mfma_f32_16x16x32_bf16 v[8:11], a[224:227], v[92:95], v[8:11]
    v_exp_f32 v127, v31
    v_mfma_f32_16x16x32_bf16 v[12:15], a[228:231], v[92:95], v[12:15]
    v_fma_f32 v120, v120, s28, s28
    v_mfma_f32_16x16x32_bf16 v[12:15], a[204:207], v[88:91], v[12:15]
    v_fma_f32 v121, v121, s28, s28
    v_mfma_f32_16x16x32_bf16 v[32:35], a[208:211], v[88:91], v[32:35]
    v_fma_f32 v122, v122, s28, s28
    v_mfma_f32_16x16x32_bf16 v[32:35], a[232:235], v[92:95], v[32:35]
    v_fma_f32 v123, v123, s28, s28
    v_mfma_f32_16x16x32_bf16 v[36:39], a[236:239], v[92:95], v[36:39]
    v_fma_f32 v124, v124, s28, s28
    v_mfma_f32_16x16x32_bf16 v[36:39], a[212:215], v[88:91], v[36:39]
    ds_read_b128 v[88:91], v1 offset:12288
    s_waitcnt lgkmcnt(2)
    v_mfma_f32_16x16x32_bf16 v[16:19], a[240:243], v[96:99], v[16:19]
    ds_read_b128 v[92:95], v1 offset:12544
    s_waitcnt lgkmcnt(2)
    v_mfma_f32_16x16x32_bf16 v[16:19], v[136:139], v[100:103], v[16:19]
    v_fma_f32 v125, v125, s28, s28
    v_mfma_f32_16x16x32_bf16 v[20:23], v[140:143], v[100:103], v[20:23]
    v_fma_f32 v126, v126, s28, s28
    v_mfma_f32_16x16x32_bf16 v[20:23], a[244:247], v[96:99], v[20:23]
    v_fma_f32 v127, v127, s28, s28
    v_mfma_f32_16x16x32_bf16 v[8:11], a[248:251], v[96:99], v[8:11]
    v_rcp_f32 v120, v120
    v_mfma_f32_16x16x32_bf16 v[8:11], v[144:147], v[100:103], v[8:11]
    v_rcp_f32 v121, v121
    v_mfma_f32_16x16x32_bf16 v[12:15], v[148:151], v[100:103], v[12:15]
    v_rcp_f32 v122, v122
    v_mfma_f32_16x16x32_bf16 v[12:15], a[252:255], v[96:99], v[12:15]
    v_rcp_f32 v123, v123
    v_mfma_f32_16x16x32_bf16 v[32:35], v[128:131], v[96:99], v[32:35]
    v_rcp_f32 v124, v124
    v_mfma_f32_16x16x32_bf16 v[32:35], v[152:155], v[100:103], v[32:35]
    v_rcp_f32 v125, v125
    v_mfma_f32_16x16x32_bf16 v[36:39], v[156:159], v[100:103], v[36:39]
    v_rcp_f32 v126, v126
    v_mfma_f32_16x16x32_bf16 v[36:39], v[132:135], v[96:99], v[36:39]
    ds_read_b128 v[96:99], v1 offset:12800
    s_waitcnt lgkmcnt(2)
    v_mfma_f32_16x16x32_bf16 v[16:19], v[160:163], v[88:91], v[16:19]
    ds_read_b128 v[100:103], v1 offset:13056
    s_waitcnt lgkmcnt(2)
    v_mfma_f32_16x16x32_bf16 v[16:19], v[184:187], v[92:95], v[16:19]
    v_rcp_f32 v127, v127
    v_mfma_f32_16x16x32_bf16 v[20:23], v[188:191], v[92:95], v[20:23]
    v_mul_f32 v24, v24, v120
    v_mfma_f32_16x16x32_bf16 v[20:23], v[164:167], v[88:91], v[20:23]
    v_mul_f32 v25, v25, v121
    v_mfma_f32_16x16x32_bf16 v[8:11], v[168:171], v[88:91], v[8:11]
    v_mul_f32 v26, v26, v122
    v_mfma_f32_16x16x32_bf16 v[8:11], v[192:195], v[92:95], v[8:11]
    v_mul_f32 v27, v27, v123
    v_mfma_f32_16x16x32_bf16 v[12:15], v[196:199], v[92:95], v[12:15]
    v_mul_f32 v28, v28, v124
    v_mfma_f32_16x16x32_bf16 v[12:15], v[172:175], v[88:91], v[12:15]
    v_mul_f32 v29, v29, v125
    v_mfma_f32_16x16x32_bf16 v[32:35], v[176:179], v[88:91], v[32:35]
    v_mul_f32 v30, v30, v126
    v_mfma_f32_16x16x32_bf16 v[32:35], v[200:203], v[92:95], v[32:35]
    v_mul_f32 v31, v31, v127
    v_mfma_f32_16x16x32_bf16 v[36:39], v[204:207], v[92:95], v[36:39]
    v_cvt_pk_bf16_f32 v24, v24, v25
    v_mfma_f32_16x16x32_bf16 v[36:39], v[180:183], v[88:91], v[36:39]
    ds_read_b128 v[88:91], v1 offset:16384
    s_waitcnt lgkmcnt(2)
    v_mfma_f32_16x16x32_bf16 v[16:19], v[208:211], v[96:99], v[16:19]
    ds_read_b128 v[92:95], v1 offset:16640
    s_waitcnt lgkmcnt(2)
    v_mfma_f32_16x16x32_bf16 v[16:19], v[232:235], v[100:103], v[16:19]
    v_cvt_pk_bf16_f32 v25, v26, v27
    v_mfma_f32_16x16x32_bf16 v[20:23], v[236:239], v[100:103], v[20:23]
    v_cvt_pk_bf16_f32 v26, v28, v29
    v_mfma_f32_16x16x32_bf16 v[20:23], v[212:215], v[96:99], v[20:23]
    v_cvt_pk_bf16_f32 v27, v30, v31
    v_mfma_f32_16x16x32_bf16 v[8:11], v[216:219], v[96:99], v[8:11]
    v_mfma_f32_16x16x32_bf16 v[8:11], v[240:243], v[100:103], v[8:11]
    v_permlane16_swap_b32 v24, v26
    v_mfma_f32_16x16x32_bf16 v[12:15], v[244:247], v[100:103], v[12:15]
    v_permlane16_swap_b32 v25, v27
    s_mov_b32 s22, 14336
    v_mfma_f32_16x16x32_bf16 v[12:15], v[220:223], v[96:99], v[12:15]
    buffer_store_dwordx4 v[24:27], v3, s[16:19], s22 offen nt
    v_mfma_f32_16x16x32_bf16 v[32:35], v[224:227], v[96:99], v[32:35]
    v_mfma_f32_16x16x32_bf16 v[32:35], v[248:251], v[100:103], v[32:35]
    v_mfma_f32_16x16x32_bf16 v[36:39], v[252:255], v[100:103], v[36:39]
    v_mfma_f32_16x16x32_bf16 v[36:39], v[228:231], v[96:99], v[36:39]
    ds_read_b128 v[96:99], v1 offset:16896
    s_waitcnt lgkmcnt(2)
    v_mfma_f32_16x16x32_bf16 v[24:27], a[0:3], v[88:91], 0
    ds_read_b128 v[100:103], v1 offset:17152
    s_waitcnt lgkmcnt(2)
    v_mfma_f32_16x16x32_bf16 v[24:27], a[24:27], v[92:95], v[24:27]
    v_fma_f32 v76, v76, v108, v116
    s_add_u32 m0, s21, 122880
    v_mfma_f32_16x16x32_bf16 v[28:31], a[28:31], v[92:95], 0
    buffer_load_dwordx4 v6, s[8:11], s29 offen lds
    v_mfma_f32_16x16x32_bf16 v[28:31], a[4:7], v[88:91], v[28:31]
    v_fma_f32 v77, v77, v109, v117
    v_mfma_f32_16x16x32_bf16 v[16:19], a[8:11], v[88:91], v[16:19]
    v_fma_f32 v78, v78, v110, v118
    v_mfma_f32_16x16x32_bf16 v[16:19], a[32:35], v[92:95], v[16:19]
    v_fma_f32 v79, v79, v111, v119
    v_mfma_f32_16x16x32_bf16 v[20:23], a[36:39], v[92:95], v[20:23]
    v_exp_f32 v124, v76
    v_mfma_f32_16x16x32_bf16 v[20:23], a[12:15], v[88:91], v[20:23]
    v_exp_f32 v125, v77
    v_mfma_f32_16x16x32_bf16 v[8:11], a[16:19], v[88:91], v[8:11]
    v_exp_f32 v126, v78
    v_mfma_f32_16x16x32_bf16 v[8:11], a[40:43], v[92:95], v[8:11]
    v_exp_f32 v127, v79
    v_mfma_f32_16x16x32_bf16 v[12:15], a[44:47], v[92:95], v[12:15]
    v_fma_f32 v124, v124, s28, s28
    s_add_u32 m0, s21, 126976
    v_mfma_f32_16x16x32_bf16 v[12:15], a[20:23], v[88:91], v[12:15]
    ds_read_b128 v[88:91], v1 offset:20480
    s_waitcnt lgkmcnt(2)
    v_mfma_f32_16x16x32_bf16 v[24:27], a[48:51], v[96:99], v[24:27]
    ds_read_b128 v[92:95], v1 offset:20736
    s_waitcnt lgkmcnt(2)
    v_mfma_f32_16x16x32_bf16 v[24:27], a[72:75], v[100:103], v[24:27]
    buffer_load_dwordx4 v7, s[8:11], s29 offen lds
    v_mfma_f32_16x16x32_bf16 v[28:31], a[76:79], v[100:103], v[28:31]
    v_fma_f32 v125, v125, s28, s28
    v_mfma_f32_16x16x32_bf16 v[28:31], a[52:55], v[96:99], v[28:31]
    v_fma_f32 v126, v126, s28, s28
    v_mfma_f32_16x16x32_bf16 v[16:19], a[56:59], v[96:99], v[16:19]
    v_fma_f32 v127, v127, s28, s28
    v_mfma_f32_16x16x32_bf16 v[16:19], a[80:83], v[100:103], v[16:19]
    v_rcp_f32 v124, v124
    v_mfma_f32_16x16x32_bf16 v[20:23], a[84:87], v[100:103], v[20:23]
    v_rcp_f32 v125, v125
    v_mfma_f32_16x16x32_bf16 v[20:23], a[60:63], v[96:99], v[20:23]
    v_rcp_f32 v126, v126
    v_mfma_f32_16x16x32_bf16 v[8:11], a[64:67], v[96:99], v[8:11]
    v_rcp_f32 v127, v127
    v_mfma_f32_16x16x32_bf16 v[8:11], a[88:91], v[100:103], v[8:11]
    v_mul_f32 v76, v76, v124
    v_mfma_f32_16x16x32_bf16 v[12:15], a[92:95], v[100:103], v[12:15]
    v_mul_f32 v77, v77, v125
    v_mfma_f32_16x16x32_bf16 v[12:15], a[68:71], v[96:99], v[12:15]
    ds_read_b128 v[96:99], v1 offset:20992
    s_waitcnt lgkmcnt(2)
    v_mfma_f32_16x16x32_bf16 v[24:27], a[96:99], v[88:91], v[24:27]
    ds_read_b128 v[100:103], v1 offset:21248
    s_waitcnt lgkmcnt(2)
    v_mfma_f32_16x16x32_bf16 v[24:27], a[120:123], v[92:95], v[24:27]
    v_mul_f32 v78, v78, v126
    v_mfma_f32_16x16x32_bf16 v[28:31], a[124:127], v[92:95], v[28:31]
    v_mul_f32 v79, v79, v127
    v_mfma_f32_16x16x32_bf16 v[28:31], a[100:103], v[88:91], v[28:31]
    v_cvt_pk_bf16_f32 v74, v76, v77
    v_mfma_f32_16x16x32_bf16 v[16:19], a[104:107], v[88:91], v[16:19]
    v_cvt_pk_bf16_f32 v75, v78, v79
    v_mfma_f32_16x16x32_bf16 v[16:19], a[128:131], v[92:95], v[16:19]
    v_mfma_f32_16x16x32_bf16 v[20:23], a[132:135], v[92:95], v[20:23]
    v_permlane16_swap_b32 v72, v74
    v_mfma_f32_16x16x32_bf16 v[20:23], a[108:111], v[88:91], v[20:23]
    v_permlane16_swap_b32 v73, v75
    s_mov_b32 s22, 4096
    v_mfma_f32_16x16x32_bf16 v[8:11], a[112:115], v[88:91], v[8:11]
    buffer_store_dwordx4 v[72:75], v3, s[16:19], s22 offen nt
    v_mfma_f32_16x16x32_bf16 v[8:11], a[136:139], v[92:95], v[8:11]
    v_fma_f32 v32, v32, v104, v112
    v_mfma_f32_16x16x32_bf16 v[12:15], a[140:143], v[92:95], v[12:15]
    v_fma_f32 v33, v33, v105, v113
    v_mfma_f32_16x16x32_bf16 v[12:15], a[116:119], v[88:91], v[12:15]
    ds_read_b128 v[88:91], v1 offset:24576
    s_waitcnt lgkmcnt(2)
    v_mfma_f32_16x16x32_bf16 v[24:27], a[144:147], v[96:99], v[24:27]
    ds_read_b128 v[92:95], v1 offset:24832
    s_waitcnt lgkmcnt(2)
    v_mfma_f32_16x16x32_bf16 v[24:27], a[168:171], v[100:103], v[24:27]
    v_fma_f32 v34, v34, v106, v114
    v_mfma_f32_16x16x32_bf16 v[28:31], a[172:175], v[100:103], v[28:31]
    v_fma_f32 v35, v35, v107, v115
    v_mfma_f32_16x16x32_bf16 v[28:31], a[148:151], v[96:99], v[28:31]
    v_fma_f32 v36, v36, v108, v116
    v_mfma_f32_16x16x32_bf16 v[16:19], a[152:155], v[96:99], v[16:19]
    v_fma_f32 v37, v37, v109, v117
    v_mfma_f32_16x16x32_bf16 v[16:19], a[176:179], v[100:103], v[16:19]
    v_fma_f32 v38, v38, v110, v118
    v_mfma_f32_16x16x32_bf16 v[20:23], a[180:183], v[100:103], v[20:23]
    v_fma_f32 v39, v39, v111, v119
    v_mfma_f32_16x16x32_bf16 v[20:23], a[156:159], v[96:99], v[20:23]
    v_exp_f32 v120, v32
    v_mfma_f32_16x16x32_bf16 v[8:11], a[160:163], v[96:99], v[8:11]
    v_exp_f32 v121, v33
    v_mfma_f32_16x16x32_bf16 v[8:11], a[184:187], v[100:103], v[8:11]
    v_exp_f32 v122, v34
    v_mfma_f32_16x16x32_bf16 v[12:15], a[188:191], v[100:103], v[12:15]
    v_exp_f32 v123, v35
    v_mfma_f32_16x16x32_bf16 v[12:15], a[164:167], v[96:99], v[12:15]
    ds_read_b128 v[96:99], v1 offset:25088
    s_waitcnt lgkmcnt(2)
    v_mfma_f32_16x16x32_bf16 v[24:27], a[192:195], v[88:91], v[24:27]
    ds_read_b128 v[100:103], v1 offset:25344
    s_waitcnt lgkmcnt(2)
    v_mfma_f32_16x16x32_bf16 v[24:27], a[216:219], v[92:95], v[24:27]
    v_exp_f32 v124, v36
    v_mfma_f32_16x16x32_bf16 v[28:31], a[220:223], v[92:95], v[28:31]
    v_exp_f32 v125, v37
    v_mfma_f32_16x16x32_bf16 v[28:31], a[196:199], v[88:91], v[28:31]
    v_exp_f32 v126, v38
    v_mfma_f32_16x16x32_bf16 v[16:19], a[200:203], v[88:91], v[16:19]
    v_exp_f32 v127, v39
    v_mfma_f32_16x16x32_bf16 v[16:19], a[224:227], v[92:95], v[16:19]
    v_fma_f32 v120, v120, s28, s28
    v_mfma_f32_16x16x32_bf16 v[20:23], a[228:231], v[92:95], v[20:23]
    v_fma_f32 v121, v121, s28, s28
    v_mfma_f32_16x16x32_bf16 v[20:23], a[204:207], v[88:91], v[20:23]
    v_fma_f32 v122, v122, s28, s28
    v_mfma_f32_16x16x32_bf16 v[8:11], a[208:211], v[88:91], v[8:11]
    v_fma_f32 v123, v123, s28, s28
    v_mfma_f32_16x16x32_bf16 v[8:11], a[232:235], v[92:95], v[8:11]
    v_fma_f32 v124, v124, s28, s28
    v_mfma_f32_16x16x32_bf16 v[12:15], a[236:239], v[92:95], v[12:15]
    v_fma_f32 v125, v125, s28, s28
    v_mfma_f32_16x16x32_bf16 v[12:15], a[212:215], v[88:91], v[12:15]
    ds_read_b128 v[88:91], v1 offset:28672
    s_waitcnt lgkmcnt(2)
    v_mfma_f32_16x16x32_bf16 v[24:27], a[240:243], v[96:99], v[24:27]
    ds_read_b128 v[92:95], v1 offset:28928
    s_waitcnt lgkmcnt(2)
    v_mfma_f32_16x16x32_bf16 v[24:27], v[136:139], v[100:103], v[24:27]
    v_fma_f32 v126, v126, s28, s28
    v_mfma_f32_16x16x32_bf16 v[28:31], v[140:143], v[100:103], v[28:31]
    v_fma_f32 v127, v127, s28, s28
    v_mfma_f32_16x16x32_bf16 v[28:31], a[244:247], v[96:99], v[28:31]
    v_rcp_f32 v120, v120
    v_mfma_f32_16x16x32_bf16 v[16:19], a[248:251], v[96:99], v[16:19]
    v_rcp_f32 v121, v121
    v_mfma_f32_16x16x32_bf16 v[16:19], v[144:147], v[100:103], v[16:19]
    v_rcp_f32 v122, v122
    v_mfma_f32_16x16x32_bf16 v[20:23], v[148:151], v[100:103], v[20:23]
    v_rcp_f32 v123, v123
    v_mfma_f32_16x16x32_bf16 v[20:23], a[252:255], v[96:99], v[20:23]
    v_rcp_f32 v124, v124
    v_mfma_f32_16x16x32_bf16 v[8:11], v[128:131], v[96:99], v[8:11]
    v_rcp_f32 v125, v125
    v_mfma_f32_16x16x32_bf16 v[8:11], v[152:155], v[100:103], v[8:11]
    v_rcp_f32 v126, v126
    v_mfma_f32_16x16x32_bf16 v[12:15], v[156:159], v[100:103], v[12:15]
    v_rcp_f32 v127, v127
    v_mfma_f32_16x16x32_bf16 v[12:15], v[132:135], v[96:99], v[12:15]
    ds_read_b128 v[96:99], v1 offset:29184
    s_waitcnt lgkmcnt(2)
    v_mfma_f32_16x16x32_bf16 v[24:27], v[160:163], v[88:91], v[24:27]
    ds_read_b128 v[100:103], v1 offset:29440
    s_waitcnt lgkmcnt(2)
    v_mfma_f32_16x16x32_bf16 v[24:27], v[184:187], v[92:95], v[24:27]
    v_mul_f32 v32, v32, v120
    v_mfma_f32_16x16x32_bf16 v[28:31], v[188:191], v[92:95], v[28:31]
    v_mul_f32 v33, v33, v121
    v_mfma_f32_16x16x32_bf16 v[28:31], v[164:167], v[88:91], v[28:31]
    v_mul_f32 v34, v34, v122
    v_mfma_f32_16x16x32_bf16 v[16:19], v[168:171], v[88:91], v[16:19]
    v_mul_f32 v35, v35, v123
    v_mfma_f32_16x16x32_bf16 v[16:19], v[192:195], v[92:95], v[16:19]
    v_mul_f32 v36, v36, v124
    v_mfma_f32_16x16x32_bf16 v[20:23], v[196:199], v[92:95], v[20:23]
    v_mul_f32 v37, v37, v125
    v_mfma_f32_16x16x32_bf16 v[20:23], v[172:175], v[88:91], v[20:23]
    v_mul_f32 v38, v38, v126
    v_mfma_f32_16x16x32_bf16 v[8:11], v[176:179], v[88:91], v[8:11]
    v_mul_f32 v39, v39, v127
    v_mfma_f32_16x16x32_bf16 v[8:11], v[200:203], v[92:95], v[8:11]
    v_cvt_pk_bf16_f32 v32, v32, v33
    v_mfma_f32_16x16x32_bf16 v[12:15], v[204:207], v[92:95], v[12:15]
    v_cvt_pk_bf16_f32 v33, v34, v35
    v_mfma_f32_16x16x32_bf16 v[12:15], v[180:183], v[88:91], v[12:15]
    ds_read_b128 v[88:91], v1 offset:32768
    s_waitcnt lgkmcnt(2)
    v_mfma_f32_16x16x32_bf16 v[24:27], v[208:211], v[96:99], v[24:27]
    ds_read_b128 v[92:95], v1 offset:33024
    s_waitcnt lgkmcnt(2)
    v_mfma_f32_16x16x32_bf16 v[24:27], v[232:235], v[100:103], v[24:27]
    v_cvt_pk_bf16_f32 v34, v36, v37
    v_mfma_f32_16x16x32_bf16 v[28:31], v[236:239], v[100:103], v[28:31]
    v_cvt_pk_bf16_f32 v35, v38, v39
    v_mfma_f32_16x16x32_bf16 v[28:31], v[212:215], v[96:99], v[28:31]
    v_mfma_f32_16x16x32_bf16 v[16:19], v[216:219], v[96:99], v[16:19]
    v_permlane16_swap_b32 v32, v34
    v_mfma_f32_16x16x32_bf16 v[16:19], v[240:243], v[100:103], v[16:19]
    v_permlane16_swap_b32 v33, v35
    s_mov_b32 s22, 15360
    v_mfma_f32_16x16x32_bf16 v[20:23], v[244:247], v[100:103], v[20:23]
    buffer_store_dwordx4 v[32:35], v3, s[16:19], s22 offen nt
    v_mfma_f32_16x16x32_bf16 v[20:23], v[220:223], v[96:99], v[20:23]
    v_mfma_f32_16x16x32_bf16 v[8:11], v[224:227], v[96:99], v[8:11]
    v_mfma_f32_16x16x32_bf16 v[8:11], v[248:251], v[100:103], v[8:11]
    v_mfma_f32_16x16x32_bf16 v[12:15], v[252:255], v[100:103], v[12:15]
    v_mfma_f32_16x16x32_bf16 v[12:15], v[228:231], v[96:99], v[12:15]
    ds_read_b128 v[96:99], v1 offset:33280
    s_waitcnt lgkmcnt(2)
    v_mfma_f32_16x16x32_bf16 v[32:35], a[0:3], v[88:91], 0
    ds_read_b128 v[100:103], v1 offset:33536
    s_waitcnt lgkmcnt(2)
    v_mfma_f32_16x16x32_bf16 v[32:35], a[24:27], v[92:95], v[32:35]
    s_waitcnt vmcnt(19)
    v_fma_f32 v80, v80, v104, v112
    v_mfma_f32_16x16x32_bf16 v[36:39], a[28:31], v[92:95], 0
    s_barrier
    s_add_u32 m0, s21, 0
    s_mov_b32 s29, 24576
    v_mfma_f32_16x16x32_bf16 v[36:39], a[4:7], v[88:91], v[36:39]
    buffer_load_dwordx4 v4, s[8:11], s29 offen lds
    v_mfma_f32_16x16x32_bf16 v[24:27], a[8:11], v[88:91], v[24:27]
    v_fma_f32 v81, v81, v105, v113
    v_mfma_f32_16x16x32_bf16 v[24:27], a[32:35], v[92:95], v[24:27]
    v_fma_f32 v82, v82, v106, v114
    v_mfma_f32_16x16x32_bf16 v[28:31], a[36:39], v[92:95], v[28:31]
    v_fma_f32 v83, v83, v107, v115
    v_mfma_f32_16x16x32_bf16 v[28:31], a[12:15], v[88:91], v[28:31]
    v_exp_f32 v120, v80
    v_mfma_f32_16x16x32_bf16 v[16:19], a[16:19], v[88:91], v[16:19]
    v_exp_f32 v121, v81
    v_mfma_f32_16x16x32_bf16 v[16:19], a[40:43], v[92:95], v[16:19]
    v_exp_f32 v122, v82
    v_mfma_f32_16x16x32_bf16 v[20:23], a[44:47], v[92:95], v[20:23]
    v_exp_f32 v123, v83
    v_mfma_f32_16x16x32_bf16 v[20:23], a[20:23], v[88:91], v[20:23]
    ds_read_b128 v[88:91], v1 offset:36864
    s_waitcnt lgkmcnt(2)
    v_mfma_f32_16x16x32_bf16 v[32:35], a[48:51], v[96:99], v[32:35]
    ds_read_b128 v[92:95], v1 offset:37120
    s_waitcnt lgkmcnt(2)
    v_mfma_f32_16x16x32_bf16 v[32:35], a[72:75], v[100:103], v[32:35]
    v_fma_f32 v120, v120, s28, s28
    s_add_u32 m0, s21, 4096
    v_mfma_f32_16x16x32_bf16 v[36:39], a[76:79], v[100:103], v[36:39]
    buffer_load_dwordx4 v5, s[8:11], s29 offen lds
    v_mfma_f32_16x16x32_bf16 v[36:39], a[52:55], v[96:99], v[36:39]
    v_fma_f32 v121, v121, s28, s28
    v_mfma_f32_16x16x32_bf16 v[24:27], a[56:59], v[96:99], v[24:27]
    v_fma_f32 v122, v122, s28, s28
    v_mfma_f32_16x16x32_bf16 v[24:27], a[80:83], v[100:103], v[24:27]
    v_fma_f32 v123, v123, s28, s28
    v_mfma_f32_16x16x32_bf16 v[28:31], a[84:87], v[100:103], v[28:31]
    v_rcp_f32 v120, v120
    v_mfma_f32_16x16x32_bf16 v[28:31], a[60:63], v[96:99], v[28:31]
    v_rcp_f32 v121, v121
    v_mfma_f32_16x16x32_bf16 v[16:19], a[64:67], v[96:99], v[16:19]
    v_rcp_f32 v122, v122
    v_mfma_f32_16x16x32_bf16 v[16:19], a[88:91], v[100:103], v[16:19]
    v_rcp_f32 v123, v123
    v_mfma_f32_16x16x32_bf16 v[20:23], a[92:95], v[100:103], v[20:23]
    v_mul_f32 v80, v80, v120
    s_add_u32 m0, s21, 8192
    v_mfma_f32_16x16x32_bf16 v[20:23], a[68:71], v[96:99], v[20:23]
    ds_read_b128 v[96:99], v1 offset:37376
    s_waitcnt lgkmcnt(2)
    v_mfma_f32_16x16x32_bf16 v[32:35], a[96:99], v[88:91], v[32:35]
    ds_read_b128 v[100:103], v1 offset:37632
    s_waitcnt lgkmcnt(2)
    v_mfma_f32_16x16x32_bf16 v[32:35], a[120:123], v[92:95], v[32:35]
    buffer_load_dwordx4 v6, s[8:11], s29 offen lds
    v_mfma_f32_16x16x32_bf16 v[36:39], a[124:127], v[92:95], v[36:39]
    v_mul_f32 v81, v81, v121
    v_mfma_f32_16x16x32_bf16 v[36:39], a[100:103], v[88:91], v[36:39]
    v_mul_f32 v82, v82, v122
    v_mfma_f32_16x16x32_bf16 v[24:27], a[104:107], v[88:91], v[24:27]
    v_mul_f32 v83, v83, v123
    v_mfma_f32_16x16x32_bf16 v[24:27], a[128:131], v[92:95], v[24:27]
    v_cvt_pk_bf16_f32 v80, v80, v81
    v_mfma_f32_16x16x32_bf16 v[28:31], a[132:135], v[92:95], v[28:31]
    v_cvt_pk_bf16_f32 v81, v82, v83
    v_mfma_f32_16x16x32_bf16 v[28:31], a[108:111], v[88:91], v[28:31]
    v_fma_f32 v8, v8, v104, v112
    v_mfma_f32_16x16x32_bf16 v[16:19], a[112:115], v[88:91], v[16:19]
    v_fma_f32 v9, v9, v105, v113
    v_mfma_f32_16x16x32_bf16 v[16:19], a[136:139], v[92:95], v[16:19]
    v_fma_f32 v10, v10, v106, v114
    s_add_u32 m0, s21, 12288
    v_mfma_f32_16x16x32_bf16 v[20:23], a[140:143], v[92:95], v[20:23]
    buffer_load_dwordx4 v7, s[8:11], s29 offen lds
    v_mfma_f32_16x16x32_bf16 v[20:23], a[116:119], v[88:91], v[20:23]
    ds_read_b128 v[88:91], v1 offset:40960
    s_waitcnt lgkmcnt(2)
    v_mfma_f32_16x16x32_bf16 v[32:35], a[144:147], v[96:99], v[32:35]
    ds_read_b128 v[92:95], v1 offset:41216
    s_waitcnt lgkmcnt(2)
    v_mfma_f32_16x16x32_bf16 v[32:35], a[168:171], v[100:103], v[32:35]
    v_fma_f32 v11, v11, v107, v115
    v_mfma_f32_16x16x32_bf16 v[36:39], a[172:175], v[100:103], v[36:39]
    v_fma_f32 v12, v12, v108, v116
    v_mfma_f32_16x16x32_bf16 v[36:39], a[148:151], v[96:99], v[36:39]
    v_fma_f32 v13, v13, v109, v117
    v_mfma_f32_16x16x32_bf16 v[24:27], a[152:155], v[96:99], v[24:27]
    v_fma_f32 v14, v14, v110, v118
    v_mfma_f32_16x16x32_bf16 v[24:27], a[176:179], v[100:103], v[24:27]
    v_fma_f32 v15, v15, v111, v119
    v_mfma_f32_16x16x32_bf16 v[28:31], a[180:183], v[100:103], v[28:31]
    v_exp_f32 v120, v8
    s_add_u32 m0, s21, 16384
    s_mov_b32 s29, 25600
    v_mfma_f32_16x16x32_bf16 v[28:31], a[156:159], v[96:99], v[28:31]
    buffer_load_dwordx4 v4, s[8:11], s29 offen lds
    v_mfma_f32_16x16x32_bf16 v[16:19], a[160:163], v[96:99], v[16:19]
    v_exp_f32 v121, v9
    v_mfma_f32_16x16x32_bf16 v[16:19], a[184:187], v[100:103], v[16:19]
    v_exp_f32 v122, v10
    v_mfma_f32_16x16x32_bf16 v[20:23], a[188:191], v[100:103], v[20:23]
    v_exp_f32 v123, v11
    v_mfma_f32_16x16x32_bf16 v[20:23], a[164:167], v[96:99], v[20:23]
    ds_read_b128 v[96:99], v1 offset:41472
    s_waitcnt lgkmcnt(2)
    v_mfma_f32_16x16x32_bf16 v[32:35], a[192:195], v[88:91], v[32:35]
    ds_read_b128 v[100:103], v1 offset:41728
    s_waitcnt lgkmcnt(2)
    v_mfma_f32_16x16x32_bf16 v[32:35], a[216:219], v[92:95], v[32:35]
    v_exp_f32 v124, v12
    v_mfma_f32_16x16x32_bf16 v[36:39], a[220:223], v[92:95], v[36:39]
    v_exp_f32 v125, v13
    v_mfma_f32_16x16x32_bf16 v[36:39], a[196:199], v[88:91], v[36:39]
    v_exp_f32 v126, v14
    s_add_u32 m0, s21, 20480
    v_mfma_f32_16x16x32_bf16 v[24:27], a[200:203], v[88:91], v[24:27]
    buffer_load_dwordx4 v5, s[8:11], s29 offen lds
    v_mfma_f32_16x16x32_bf16 v[24:27], a[224:227], v[92:95], v[24:27]
    v_exp_f32 v127, v15
    v_mfma_f32_16x16x32_bf16 v[28:31], a[228:231], v[92:95], v[28:31]
    v_fma_f32 v120, v120, s28, s28
    v_mfma_f32_16x16x32_bf16 v[28:31], a[204:207], v[88:91], v[28:31]
    v_fma_f32 v121, v121, s28, s28
    v_mfma_f32_16x16x32_bf16 v[16:19], a[208:211], v[88:91], v[16:19]
    v_fma_f32 v122, v122, s28, s28
    v_mfma_f32_16x16x32_bf16 v[16:19], a[232:235], v[92:95], v[16:19]
    v_fma_f32 v123, v123, s28, s28
    v_mfma_f32_16x16x32_bf16 v[20:23], a[236:239], v[92:95], v[20:23]
    v_fma_f32 v124, v124, s28, s28
    v_mfma_f32_16x16x32_bf16 v[20:23], a[212:215], v[88:91], v[20:23]
    ds_read_b128 v[88:91], v1 offset:45056
    s_waitcnt lgkmcnt(2)
    v_mfma_f32_16x16x32_bf16 v[32:35], a[240:243], v[96:99], v[32:35]
    ds_read_b128 v[92:95], v1 offset:45312
    s_waitcnt lgkmcnt(2)
    v_mfma_f32_16x16x32_bf16 v[32:35], v[136:139], v[100:103], v[32:35]
    v_fma_f32 v125, v125, s28, s28
    v_mfma_f32_16x16x32_bf16 v[36:39], v[140:143], v[100:103], v[36:39]
    v_fma_f32 v126, v126, s28, s28
    v_mfma_f32_16x16x32_bf16 v[36:39], a[244:247], v[96:99], v[36:39]
    v_fma_f32 v127, v127, s28, s28
    v_mfma_f32_16x16x32_bf16 v[24:27], a[248:251], v[96:99], v[24:27]
    v_rcp_f32 v120, v120
    v_mfma_f32_16x16x32_bf16 v[24:27], v[144:147], v[100:103], v[24:27]
    v_rcp_f32 v121, v121
    v_mfma_f32_16x16x32_bf16 v[28:31], v[148:151], v[100:103], v[28:31]
    v_rcp_f32 v122, v122
    v_mfma_f32_16x16x32_bf16 v[28:31], a[252:255], v[96:99], v[28:31]
    v_rcp_f32 v123, v123
    v_mfma_f32_16x16x32_bf16 v[16:19], v[128:131], v[96:99], v[16:19]
    v_rcp_f32 v124, v124
    v_mfma_f32_16x16x32_bf16 v[16:19], v[152:155], v[100:103], v[16:19]
    v_rcp_f32 v125, v125
    v_mfma_f32_16x16x32_bf16 v[20:23], v[156:159], v[100:103], v[20:23]
    v_rcp_f32 v126, v126
    v_mfma_f32_16x16x32_bf16 v[20:23], v[132:135], v[96:99], v[20:23]
    ds_read_b128 v[96:99], v1 offset:45568
    s_waitcnt lgkmcnt(2)
    v_mfma_f32_16x16x32_bf16 v[32:35], v[160:163], v[88:91], v[32:35]
    ds_read_b128 v[100:103], v1 offset:45824
    s_waitcnt lgkmcnt(2)
    v_mfma_f32_16x16x32_bf16 v[32:35], v[184:187], v[92:95], v[32:35]
    v_rcp_f32 v127, v127
    v_mfma_f32_16x16x32_bf16 v[36:39], v[188:191], v[92:95], v[36:39]
    v_mul_f32 v8, v8, v120
    v_mfma_f32_16x16x32_bf16 v[36:39], v[164:167], v[88:91], v[36:39]
    v_mul_f32 v9, v9, v121
    v_mfma_f32_16x16x32_bf16 v[24:27], v[168:171], v[88:91], v[24:27]
    v_mul_f32 v10, v10, v122
    v_mfma_f32_16x16x32_bf16 v[24:27], v[192:195], v[92:95], v[24:27]
    v_mul_f32 v11, v11, v123
    v_mfma_f32_16x16x32_bf16 v[28:31], v[196:199], v[92:95], v[28:31]
    v_mul_f32 v12, v12, v124
    v_mfma_f32_16x16x32_bf16 v[28:31], v[172:175], v[88:91], v[28:31]
    v_mul_f32 v13, v13, v125
    v_mfma_f32_16x16x32_bf16 v[16:19], v[176:179], v[88:91], v[16:19]
    v_mul_f32 v14, v14, v126
    v_mfma_f32_16x16x32_bf16 v[16:19], v[200:203], v[92:95], v[16:19]
    v_mul_f32 v15, v15, v127
    v_mfma_f32_16x16x32_bf16 v[20:23], v[204:207], v[92:95], v[20:23]
    v_cvt_pk_bf16_f32 v8, v8, v9
    v_mfma_f32_16x16x32_bf16 v[20:23], v[180:183], v[88:91], v[20:23]
    ds_read_b128 v[88:91], v1 offset:49152
    s_waitcnt lgkmcnt(2)
    v_mfma_f32_16x16x32_bf16 v[32:35], v[208:211], v[96:99], v[32:35]
    ds_read_b128 v[92:95], v1 offset:49408
    s_waitcnt lgkmcnt(2)
    v_mfma_f32_16x16x32_bf16 v[32:35], v[232:235], v[100:103], v[32:35]
    v_cvt_pk_bf16_f32 v9, v10, v11
    v_mfma_f32_16x16x32_bf16 v[36:39], v[236:239], v[100:103], v[36:39]
    v_cvt_pk_bf16_f32 v10, v12, v13
    v_mfma_f32_16x16x32_bf16 v[36:39], v[212:215], v[96:99], v[36:39]
    v_cvt_pk_bf16_f32 v11, v14, v15
    v_mfma_f32_16x16x32_bf16 v[24:27], v[216:219], v[96:99], v[24:27]
    v_mfma_f32_16x16x32_bf16 v[24:27], v[240:243], v[100:103], v[24:27]
    v_permlane16_swap_b32 v8, v10
    v_mfma_f32_16x16x32_bf16 v[28:31], v[244:247], v[100:103], v[28:31]
    v_permlane16_swap_b32 v9, v11
    s_mov_b32 s22, 16384
    v_mfma_f32_16x16x32_bf16 v[28:31], v[220:223], v[96:99], v[28:31]
    buffer_store_dwordx4 v[8:11], v3, s[16:19], s22 offen nt
    v_mfma_f32_16x16x32_bf16 v[16:19], v[224:227], v[96:99], v[16:19]
    v_mfma_f32_16x16x32_bf16 v[16:19], v[248:251], v[100:103], v[16:19]
    v_mfma_f32_16x16x32_bf16 v[20:23], v[252:255], v[100:103], v[20:23]
    v_mfma_f32_16x16x32_bf16 v[20:23], v[228:231], v[96:99], v[20:23]
    ds_read_b128 v[96:99], v1 offset:49664
    s_waitcnt lgkmcnt(2)
    v_mfma_f32_16x16x32_bf16 v[8:11], a[0:3], v[88:91], 0
    ds_read_b128 v[100:103], v1 offset:49920
    s_waitcnt lgkmcnt(2)
    v_mfma_f32_16x16x32_bf16 v[8:11], a[24:27], v[92:95], v[8:11]
    v_fma_f32 v84, v84, v108, v116
    s_add_u32 m0, s21, 24576
    v_mfma_f32_16x16x32_bf16 v[12:15], a[28:31], v[92:95], 0
    buffer_load_dwordx4 v6, s[8:11], s29 offen lds
    v_mfma_f32_16x16x32_bf16 v[12:15], a[4:7], v[88:91], v[12:15]
    v_fma_f32 v85, v85, v109, v117
    v_mfma_f32_16x16x32_bf16 v[32:35], a[8:11], v[88:91], v[32:35]
    v_fma_f32 v86, v86, v110, v118
    v_mfma_f32_16x16x32_bf16 v[32:35], a[32:35], v[92:95], v[32:35]
    v_fma_f32 v87, v87, v111, v119
    v_mfma_f32_16x16x32_bf16 v[36:39], a[36:39], v[92:95], v[36:39]
    v_exp_f32 v124, v84
    v_mfma_f32_16x16x32_bf16 v[36:39], a[12:15], v[88:91], v[36:39]
    v_exp_f32 v125, v85
    v_mfma_f32_16x16x32_bf16 v[24:27], a[16:19], v[88:91], v[24:27]
    v_exp_f32 v126, v86
    v_mfma_f32_16x16x32_bf16 v[24:27], a[40:43], v[92:95], v[24:27]
    v_exp_f32 v127, v87
    v_mfma_f32_16x16x32_bf16 v[28:31], a[44:47], v[92:95], v[28:31]
    v_fma_f32 v124, v124, s28, s28
    s_add_u32 m0, s21, 28672
    v_mfma_f32_16x16x32_bf16 v[28:31], a[20:23], v[88:91], v[28:31]
    ds_read_b128 v[88:91], v1 offset:53248
    s_waitcnt lgkmcnt(2)
    v_mfma_f32_16x16x32_bf16 v[8:11], a[48:51], v[96:99], v[8:11]
    ds_read_b128 v[92:95], v1 offset:53504
    s_waitcnt lgkmcnt(2)
    v_mfma_f32_16x16x32_bf16 v[8:11], a[72:75], v[100:103], v[8:11]
    buffer_load_dwordx4 v7, s[8:11], s29 offen lds
    v_mfma_f32_16x16x32_bf16 v[12:15], a[76:79], v[100:103], v[12:15]
    v_fma_f32 v125, v125, s28, s28
    v_mfma_f32_16x16x32_bf16 v[12:15], a[52:55], v[96:99], v[12:15]
    v_fma_f32 v126, v126, s28, s28
    v_mfma_f32_16x16x32_bf16 v[32:35], a[56:59], v[96:99], v[32:35]
    v_fma_f32 v127, v127, s28, s28
    v_mfma_f32_16x16x32_bf16 v[32:35], a[80:83], v[100:103], v[32:35]
    v_rcp_f32 v124, v124
    v_mfma_f32_16x16x32_bf16 v[36:39], a[84:87], v[100:103], v[36:39]
    v_rcp_f32 v125, v125
    v_mfma_f32_16x16x32_bf16 v[36:39], a[60:63], v[96:99], v[36:39]
    v_rcp_f32 v126, v126
    v_mfma_f32_16x16x32_bf16 v[24:27], a[64:67], v[96:99], v[24:27]
    v_rcp_f32 v127, v127
    v_mfma_f32_16x16x32_bf16 v[24:27], a[88:91], v[100:103], v[24:27]
    v_mul_f32 v84, v84, v124
    v_mfma_f32_16x16x32_bf16 v[28:31], a[92:95], v[100:103], v[28:31]
    v_mul_f32 v85, v85, v125
    v_mfma_f32_16x16x32_bf16 v[28:31], a[68:71], v[96:99], v[28:31]
    ds_read_b128 v[96:99], v1 offset:53760
    s_waitcnt lgkmcnt(2)
    v_mfma_f32_16x16x32_bf16 v[8:11], a[96:99], v[88:91], v[8:11]
    ds_read_b128 v[100:103], v1 offset:54016
    s_waitcnt lgkmcnt(2)
    v_mfma_f32_16x16x32_bf16 v[8:11], a[120:123], v[92:95], v[8:11]
    v_mul_f32 v86, v86, v126
    v_mfma_f32_16x16x32_bf16 v[12:15], a[124:127], v[92:95], v[12:15]
    v_mul_f32 v87, v87, v127
    v_mfma_f32_16x16x32_bf16 v[12:15], a[100:103], v[88:91], v[12:15]
    v_cvt_pk_bf16_f32 v82, v84, v85
    v_mfma_f32_16x16x32_bf16 v[32:35], a[104:107], v[88:91], v[32:35]
    v_cvt_pk_bf16_f32 v83, v86, v87
    v_mfma_f32_16x16x32_bf16 v[32:35], a[128:131], v[92:95], v[32:35]
    v_mfma_f32_16x16x32_bf16 v[36:39], a[132:135], v[92:95], v[36:39]
    v_permlane16_swap_b32 v80, v82
    v_mfma_f32_16x16x32_bf16 v[36:39], a[108:111], v[88:91], v[36:39]
    v_permlane16_swap_b32 v81, v83
    s_mov_b32 s22, 5120
    v_mfma_f32_16x16x32_bf16 v[24:27], a[112:115], v[88:91], v[24:27]
    buffer_store_dwordx4 v[80:83], v3, s[16:19], s22 offen nt
    v_mfma_f32_16x16x32_bf16 v[24:27], a[136:139], v[92:95], v[24:27]
    v_fma_f32 v16, v16, v104, v112
    v_mfma_f32_16x16x32_bf16 v[28:31], a[140:143], v[92:95], v[28:31]
    v_fma_f32 v17, v17, v105, v113
    v_mfma_f32_16x16x32_bf16 v[28:31], a[116:119], v[88:91], v[28:31]
    ds_read_b128 v[88:91], v1 offset:57344
    s_waitcnt lgkmcnt(2)
    v_mfma_f32_16x16x32_bf16 v[8:11], a[144:147], v[96:99], v[8:11]
    ds_read_b128 v[92:95], v1 offset:57600
    s_waitcnt lgkmcnt(2)
    v_mfma_f32_16x16x32_bf16 v[8:11], a[168:171], v[100:103], v[8:11]
    v_fma_f32 v18, v18, v106, v114
    v_mfma_f32_16x16x32_bf16 v[12:15], a[172:175], v[100:103], v[12:15]
    v_fma_f32 v19, v19, v107, v115
    v_mfma_f32_16x16x32_bf16 v[12:15], a[148:151], v[96:99], v[12:15]
    v_fma_f32 v20, v20, v108, v116
    v_mfma_f32_16x16x32_bf16 v[32:35], a[152:155], v[96:99], v[32:35]
    v_fma_f32 v21, v21, v109, v117
    v_mfma_f32_16x16x32_bf16 v[32:35], a[176:179], v[100:103], v[32:35]
    v_fma_f32 v22, v22, v110, v118
    v_mfma_f32_16x16x32_bf16 v[36:39], a[180:183], v[100:103], v[36:39]
    v_fma_f32 v23, v23, v111, v119
    v_mfma_f32_16x16x32_bf16 v[36:39], a[156:159], v[96:99], v[36:39]
    v_exp_f32 v120, v16
    v_mfma_f32_16x16x32_bf16 v[24:27], a[160:163], v[96:99], v[24:27]
    v_exp_f32 v121, v17
    v_mfma_f32_16x16x32_bf16 v[24:27], a[184:187], v[100:103], v[24:27]
    v_exp_f32 v122, v18
    v_mfma_f32_16x16x32_bf16 v[28:31], a[188:191], v[100:103], v[28:31]
    v_exp_f32 v123, v19
    v_mfma_f32_16x16x32_bf16 v[28:31], a[164:167], v[96:99], v[28:31]
    ds_read_b128 v[96:99], v1 offset:57856
    s_waitcnt lgkmcnt(2)
    v_mfma_f32_16x16x32_bf16 v[8:11], a[192:195], v[88:91], v[8:11]
    ds_read_b128 v[100:103], v1 offset:58112
    s_waitcnt lgkmcnt(2)
    v_mfma_f32_16x16x32_bf16 v[8:11], a[216:219], v[92:95], v[8:11]
    v_exp_f32 v124, v20
    v_mfma_f32_16x16x32_bf16 v[12:15], a[220:223], v[92:95], v[12:15]
    v_exp_f32 v125, v21
    v_mfma_f32_16x16x32_bf16 v[12:15], a[196:199], v[88:91], v[12:15]
    v_exp_f32 v126, v22
    v_mfma_f32_16x16x32_bf16 v[32:35], a[200:203], v[88:91], v[32:35]
    v_exp_f32 v127, v23
    v_mfma_f32_16x16x32_bf16 v[32:35], a[224:227], v[92:95], v[32:35]
    v_fma_f32 v120, v120, s28, s28
    v_mfma_f32_16x16x32_bf16 v[36:39], a[228:231], v[92:95], v[36:39]
    v_fma_f32 v121, v121, s28, s28
    v_mfma_f32_16x16x32_bf16 v[36:39], a[204:207], v[88:91], v[36:39]
    v_fma_f32 v122, v122, s28, s28
    v_mfma_f32_16x16x32_bf16 v[24:27], a[208:211], v[88:91], v[24:27]
    v_fma_f32 v123, v123, s28, s28
    v_mfma_f32_16x16x32_bf16 v[24:27], a[232:235], v[92:95], v[24:27]
    v_fma_f32 v124, v124, s28, s28
    v_mfma_f32_16x16x32_bf16 v[28:31], a[236:239], v[92:95], v[28:31]
    v_fma_f32 v125, v125, s28, s28
    v_mfma_f32_16x16x32_bf16 v[28:31], a[212:215], v[88:91], v[28:31]
    ds_read_b128 v[88:91], v1 offset:61440
    s_waitcnt lgkmcnt(2)
    v_mfma_f32_16x16x32_bf16 v[8:11], a[240:243], v[96:99], v[8:11]
    ds_read_b128 v[92:95], v1 offset:61696
    s_waitcnt lgkmcnt(2)
    v_mfma_f32_16x16x32_bf16 v[8:11], v[136:139], v[100:103], v[8:11]
    v_fma_f32 v126, v126, s28, s28
    v_mfma_f32_16x16x32_bf16 v[12:15], v[140:143], v[100:103], v[12:15]
    v_fma_f32 v127, v127, s28, s28
    v_mfma_f32_16x16x32_bf16 v[12:15], a[244:247], v[96:99], v[12:15]
    v_rcp_f32 v120, v120
    v_mfma_f32_16x16x32_bf16 v[32:35], a[248:251], v[96:99], v[32:35]
    v_rcp_f32 v121, v121
    v_mfma_f32_16x16x32_bf16 v[32:35], v[144:147], v[100:103], v[32:35]
    v_rcp_f32 v122, v122
    v_mfma_f32_16x16x32_bf16 v[36:39], v[148:151], v[100:103], v[36:39]
    v_rcp_f32 v123, v123
    v_mfma_f32_16x16x32_bf16 v[36:39], a[252:255], v[96:99], v[36:39]
    v_rcp_f32 v124, v124
    v_mfma_f32_16x16x32_bf16 v[24:27], v[128:131], v[96:99], v[24:27]
    v_rcp_f32 v125, v125
    v_mfma_f32_16x16x32_bf16 v[24:27], v[152:155], v[100:103], v[24:27]
    v_rcp_f32 v126, v126
    v_mfma_f32_16x16x32_bf16 v[28:31], v[156:159], v[100:103], v[28:31]
    v_rcp_f32 v127, v127
    v_mfma_f32_16x16x32_bf16 v[28:31], v[132:135], v[96:99], v[28:31]
    ds_read_b128 v[96:99], v1 offset:61952
    s_waitcnt lgkmcnt(2)
    v_mfma_f32_16x16x32_bf16 v[8:11], v[160:163], v[88:91], v[8:11]
    ds_read_b128 v[100:103], v1 offset:62208
    s_waitcnt lgkmcnt(2)
    v_mfma_f32_16x16x32_bf16 v[8:11], v[184:187], v[92:95], v[8:11]
    v_mul_f32 v16, v16, v120
    v_mfma_f32_16x16x32_bf16 v[12:15], v[188:191], v[92:95], v[12:15]
    v_mul_f32 v17, v17, v121
    v_mfma_f32_16x16x32_bf16 v[12:15], v[164:167], v[88:91], v[12:15]
    v_mul_f32 v18, v18, v122
    v_mfma_f32_16x16x32_bf16 v[32:35], v[168:171], v[88:91], v[32:35]
    v_mul_f32 v19, v19, v123
    v_mfma_f32_16x16x32_bf16 v[32:35], v[192:195], v[92:95], v[32:35]
    v_mul_f32 v20, v20, v124
    v_mfma_f32_16x16x32_bf16 v[36:39], v[196:199], v[92:95], v[36:39]
    v_mul_f32 v21, v21, v125
    v_mfma_f32_16x16x32_bf16 v[36:39], v[172:175], v[88:91], v[36:39]
    v_mul_f32 v22, v22, v126
    v_mfma_f32_16x16x32_bf16 v[24:27], v[176:179], v[88:91], v[24:27]
    v_mul_f32 v23, v23, v127
    v_mfma_f32_16x16x32_bf16 v[24:27], v[200:203], v[92:95], v[24:27]
    v_cvt_pk_bf16_f32 v16, v16, v17
    v_mfma_f32_16x16x32_bf16 v[28:31], v[204:207], v[92:95], v[28:31]
    v_cvt_pk_bf16_f32 v17, v18, v19
    v_mfma_f32_16x16x32_bf16 v[28:31], v[180:183], v[88:91], v[28:31]
    ds_read_b128 v[88:91], v2 offset:0
    s_waitcnt lgkmcnt(2)
    v_mfma_f32_16x16x32_bf16 v[8:11], v[208:211], v[96:99], v[8:11]
    ds_read_b128 v[92:95], v2 offset:256
    s_waitcnt lgkmcnt(2)
    v_mfma_f32_16x16x32_bf16 v[8:11], v[232:235], v[100:103], v[8:11]
    v_cvt_pk_bf16_f32 v18, v20, v21
    v_mfma_f32_16x16x32_bf16 v[12:15], v[236:239], v[100:103], v[12:15]
    v_cvt_pk_bf16_f32 v19, v22, v23
    v_mfma_f32_16x16x32_bf16 v[12:15], v[212:215], v[96:99], v[12:15]
    v_mfma_f32_16x16x32_bf16 v[32:35], v[216:219], v[96:99], v[32:35]
    v_permlane16_swap_b32 v16, v18
    v_mfma_f32_16x16x32_bf16 v[32:35], v[240:243], v[100:103], v[32:35]
    v_permlane16_swap_b32 v17, v19
    s_mov_b32 s22, 17408
    v_mfma_f32_16x16x32_bf16 v[36:39], v[244:247], v[100:103], v[36:39]
    buffer_store_dwordx4 v[16:19], v3, s[16:19], s22 offen nt
    v_mfma_f32_16x16x32_bf16 v[36:39], v[220:223], v[96:99], v[36:39]
    v_mfma_f32_16x16x32_bf16 v[24:27], v[224:227], v[96:99], v[24:27]
    v_mfma_f32_16x16x32_bf16 v[24:27], v[248:251], v[100:103], v[24:27]
    v_mfma_f32_16x16x32_bf16 v[28:31], v[252:255], v[100:103], v[28:31]
    v_mfma_f32_16x16x32_bf16 v[28:31], v[228:231], v[96:99], v[28:31]
    ds_read_b128 v[96:99], v2 offset:512
    s_mov_b32 s37, s21
    s_add_u32 s36, s21, 0x10000
    v_swap_b32 v1, v2
    s_mov_b32 s38, 25600
    s_mov_b32 s39, 17408
    s_mov_b32 s40, 0
L_loop:
    s_waitcnt lgkmcnt(2)
    v_mfma_f32_16x16x32_bf16 v[16:19], a[0:3], v[88:91], 0
    ds_read_b128 v[100:103], v1 offset:768
    s_waitcnt lgkmcnt(2)
    v_mfma_f32_16x16x32_bf16 v[16:19], a[24:27], v[92:95], v[16:19]
    s_waitcnt vmcnt(16)
    s_barrier
    v_mfma_f32_16x16x32_bf16 v[20:23], a[28:31], v[92:95], 0
    s_add_u32 s38, s38, 1024
    s_cmp_lt_u32 s38, 32768
    s_cselect_b32 s29, s38, 0x100000
    s_add_u32 m0, s37, 32768
    v_mfma_f32_16x16x32_bf16 v[20:23], a[4:7], v[88:91], v[20:23]
    buffer_load_dwordx4 v4, s[8:11], s29 offen lds
    v_mfma_f32_16x16x32_bf16 v[8:11], a[8:11], v[88:91], v[8:11]
    v_mfma_f32_16x16x32_bf16 v[8:11], a[32:35], v[92:95], v[8:11]
    s_add_u32 m0, s37, 36864
    v_mfma_f32_16x16x32_bf16 v[12:15], a[36:39], v[92:95], v[12:15]
    buffer_load_dwordx4 v5, s[8:11], s29 offen lds
    v_mfma_f32_16x16x32_bf16 v[12:15], a[12:15], v[88:91], v[12:15]
    v_mfma_f32_16x16x32_bf16 v[32:35], a[16:19], v[88:91], v[32:35]
    v_fma_f32 v24, v24, v104, v112
    s_add_u32 m0, s37, 40960
    v_mfma_f32_16x16x32_bf16 v[32:35], a[40:43], v[92:95], v[32:35]
    buffer_load_dwordx4 v6, s[8:11], s29 offen lds
    v_mfma_f32_16x16x32_bf16 v[36:39], a[44:47], v[92:95], v[36:39]
    v_fma_f32 v25, v25, v105, v113
    v_mfma_f32_16x16x32_bf16 v[36:39], a[20:23], v[88:91], v[36:39]
    ds_read_b128 v[88:91], v1 offset:4096
    s_waitcnt lgkmcnt(2)
    v_mfma_f32_16x16x32_bf16 v[16:19], a[48:51], v[96:99], v[16:19]
    ds_read_b128 v[92:95], v1 offset:4352
    s_waitcnt lgkmcnt(2)
    v_mfma_f32_16x16x32_bf16 v[16:19], a[72:75], v[100:103], v[16:19]
    v_fma_f32 v26, v26, v106, v114
    s_add_u32 m0, s37, 45056
    v_mfma_f32_16x16x32_bf16 v[20:23], a[76:79], v[100:103], v[20:23]
    buffer_load_dwordx4 v7, s[8:11], s29 offen lds
    v_mfma_f32_16x16x32_bf16 v[20:23], a[52:55], v[96:99], v[20:23]
    v_fma_f32 v27, v27, v107, v115
    v_mfma_f32_16x16x32_bf16 v[8:11], a[56:59], v[96:99], v[8:11]
    v_fma_f32 v28, v28, v108, v116
    v_mfma_f32_16x16x32_bf16 v[8:11], a[80:83], v[100:103], v[8:11]
    v_fma_f32 v29, v29, v109, v117
    v_mfma_f32_16x16x32_bf16 v[12:15], a[84:87], v[100:103], v[12:15]
    v_fma_f32 v30, v30, v110, v118
    v_mfma_f32_16x16x32_bf16 v[12:15], a[60:63], v[96:99], v[12:15]
    v_fma_f32 v31, v31, v111, v119
    v_mfma_f32_16x16x32_bf16 v[32:35], a[64:67], v[96:99], v[32:35]
    v_exp_f32 v120, v24
    v_mfma_f32_16x16x32_bf16 v[32:35], a[88:91], v[100:103], v[32:35]
    v_exp_f32 v121, v25
    v_mfma_f32_16x16x32_bf16 v[36:39], a[92:95], v[100:103], v[36:39]
    v_exp_f32 v122, v26
    v_mfma_f32_16x16x32_bf16 v[36:39], a[68:71], v[96:99], v[36:39]
    ds_read_b128 v[96:99], v1 offset:4608
    s_waitcnt lgkmcnt(2)
    v_mfma_f32_16x16x32_bf16 v[16:19], a[96:99], v[88:91], v[16:19]
    ds_read_b128 v[100:103], v1 offset:4864
    s_waitcnt lgkmcnt(2)
    v_mfma_f32_16x16x32_bf16 v[16:19], a[120:123], v[92:95], v[16:19]
    v_exp_f32 v123, v27
    v_mfma_f32_16x16x32_bf16 v[20:23], a[124:127], v[92:95], v[20:23]
    v_exp_f32 v124, v28
    v_mfma_f32_16x16x32_bf16 v[20:23], a[100:103], v[88:91], v[20:23]
    v_exp_f32 v125, v29
    v_mfma_f32_16x16x32_bf16 v[8:11], a[104:107], v[88:91], v[8:11]
    v_exp_f32 v126, v30
    v_mfma_f32_16x16x32_bf16 v[8:11], a[128:131], v[92:95], v[8:11]
    v_exp_f32 v127, v31
    v_mfma_f32_16x16x32_bf16 v[12:15], a[132:135], v[92:95], v[12:15]
    v_fma_f32 v120, v120, s28, s28
    v_mfma_f32_16x16x32_bf16 v[12:15], a[108:111], v[88:91], v[12:15]
    v_fma_f32 v121, v121, s28, s28
    v_mfma_f32_16x16x32_bf16 v[32:35], a[112:115], v[88:91], v[32:35]
    v_fma_f32 v122, v122, s28, s28
    v_mfma_f32_16x16x32_bf16 v[32:35], a[136:139], v[92:95], v[32:35]
    v_fma_f32 v123, v123, s28, s28
    v_mfma_f32_16x16x32_bf16 v[36:39], a[140:143], v[92:95], v[36:39]
    v_fma_f32 v124, v124, s28, s28
    v_mfma_f32_16x16x32_bf16 v[36:39], a[116:119], v[88:91], v[36:39]
    ds_read_b128 v[88:91], v1 offset:8192
    s_waitcnt lgkmcnt(2)
    v_mfma_f32_16x16x32_bf16 v[16:19], a[144:147], v[96:99], v[16:19]
    ds_read_b128 v[92:95], v1 offset:8448
    s_waitcnt lgkmcnt(2)
    v_mfma_f32_16x16x32_bf16 v[16:19], a[168:171], v[100:103], v[16:19]
    v_fma_f32 v125, v125, s28, s28
    v_mfma_f32_16x16x32_bf16 v[20:23], a[172:175], v[100:103], v[20:23]
    v_fma_f32 v126, v126, s28, s28
    v_mfma_f32_16x16x32_bf16 v[20:23], a[148:151], v[96:99], v[20:23]
    v_fma_f32 v127, v127, s28, s28
    v_mfma_f32_16x16x32_bf16 v[8:11], a[152:155], v[96:99], v[8:11]
    v_rcp_f32 v120, v120
    v_mfma_f32_16x16x32_bf16 v[8:11], a[176:179], v[100:103], v[8:11]
    v_rcp_f32 v121, v121
    v_mfma_f32_16x16x32_bf16 v[12:15], a[180:183], v[100:103], v[12:15]
    v_rcp_f32 v122, v122
    v_mfma_f32_16x16x32_bf16 v[12:15], a[156:159], v[96:99], v[12:15]
    v_rcp_f32 v123, v123
    v_mfma_f32_16x16x32_bf16 v[32:35], a[160:163], v[96:99], v[32:35]
    v_rcp_f32 v124, v124
    v_mfma_f32_16x16x32_bf16 v[32:35], a[184:187], v[100:103], v[32:35]
    v_rcp_f32 v125, v125
    v_mfma_f32_16x16x32_bf16 v[36:39], a[188:191], v[100:103], v[36:39]
    v_rcp_f32 v126, v126
    v_mfma_f32_16x16x32_bf16 v[36:39], a[164:167], v[96:99], v[36:39]
    ds_read_b128 v[96:99], v1 offset:8704
    s_waitcnt lgkmcnt(2)
    v_mfma_f32_16x16x32_bf16 v[16:19], a[192:195], v[88:91], v[16:19]
    ds_read_b128 v[100:103], v1 offset:8960
    s_waitcnt lgkmcnt(2)
    v_mfma_f32_16x16x32_bf16 v[16:19], a[216:219], v[92:95], v[16:19]
    v_rcp_f32 v127, v127
    v_mfma_f32_16x16x32_bf16 v[20:23], a[220:223], v[92:95], v[20:23]
    v_mul_f32 v24, v24, v120
    v_mfma_f32_16x16x32_bf16 v[20:23], a[196:199], v[88:91], v[20:23]
    v_mul_f32 v25, v25, v121
    v_mfma_f32_16x16x32_bf16 v[8:11], a[200:203], v[88:91], v[8:11]
    v_mul_f32 v26, v26, v122
    v_mfma_f32_16x16x32_bf16 v[8:11], a[224:227], v[92:95], v[8:11]
    v_mul_f32 v27, v27, v123
    v_mfma_f32_16x16x32_bf16 v[12:15], a[228:231], v[92:95], v[12:15]
    v_mul_f32 v28, v28, v124
    v_mfma_f32_16x16x32_bf16 v[12:15], a[204:207], v[88:91], v[12:15]
    v_mul_f32 v29, v29, v125
    v_mfma_f32_16x16x32_bf16 v[32:35], a[208:211], v[88:91], v[32:35]
    v_mul_f32 v30, v30, v126
    v_mfma_f32_16x16x32_bf16 v[32:35], a[232:235], v[92:95], v[32:35]
    v_mul_f32 v31, v31, v127
    v_mfma_f32_16x16x32_bf16 v[36:39], a[236:239], v[92:95], v[36:39]
    v_cvt_pk_bf16_f32 v24, v24, v25
    v_mfma_f32_16x16x32_bf16 v[36:39], a[212:215], v[88:91], v[36:39]
    ds_read_b128 v[88:91], v1 offset:12288
    s_waitcnt lgkmcnt(2)
    v_mfma_f32_16x16x32_bf16 v[16:19], a[240:243], v[96:99], v[16:19]
    ds_read_b128 v[92:95], v1 offset:12544
    s_waitcnt lgkmcnt(2)
    v_mfma_f32_16x16x32_bf16 v[16:19], v[136:139], v[100:103], v[16:19]
    v_cvt_pk_bf16_f32 v25, v26, v27
    v_mfma_f32_16x16x32_bf16 v[20:23], v[140:143], v[100:103], v[20:23]
    v_cvt_pk_bf16_f32 v26, v28, v29
    v_mfma_f32_16x16x32_bf16 v[20:23], a[244:247], v[96:99], v[20:23]
    v_cvt_pk_bf16_f32 v27, v30, v31
    v_mfma_f32_16x16x32_bf16 v[8:11], a[248:251], v[96:99], v[8:11]
    v_mfma_f32_16x16x32_bf16 v[8:11], v[144:147], v[100:103], v[8:11]
    v_permlane16_swap_b32 v24, v26
    v_mfma_f32_16x16x32_bf16 v[12:15], v[148:151], v[100:103], v[12:15]
    v_permlane16_swap_b32 v25, v27
    s_add_u32 s39, s39, 1024
    v_mfma_f32_16x16x32_bf16 v[12:15], a[252:255], v[96:99], v[12:15]
    buffer_store_dwordx4 v[24:27], v3, s[16:19], s39 offen nt
    v_mfma_f32_16x16x32_bf16 v[32:35], v[128:131], v[96:99], v[32:35]
    v_mfma_f32_16x16x32_bf16 v[32:35], v[152:155], v[100:103], v[32:35]
    v_mfma_f32_16x16x32_bf16 v[36:39], v[156:159], v[100:103], v[36:39]
    v_mfma_f32_16x16x32_bf16 v[36:39], v[132:135], v[96:99], v[36:39]
    ds_read_b128 v[96:99], v1 offset:12800
    s_waitcnt lgkmcnt(2)
    v_mfma_f32_16x16x32_bf16 v[16:19], v[160:163], v[88:91], v[16:19]
    ds_read_b128 v[100:103], v1 offset:13056
    s_waitcnt lgkmcnt(2)
    v_mfma_f32_16x16x32_bf16 v[16:19], v[184:187], v[92:95], v[16:19]
    v_mfma_f32_16x16x32_bf16 v[20:23], v[188:191], v[92:95], v[20:23]
    v_mfma_f32_16x16x32_bf16 v[20:23], v[164:167], v[88:91], v[20:23]
    v_mfma_f32_16x16x32_bf16 v[8:11], v[168:171], v[88:91], v[8:11]
    v_mfma_f32_16x16x32_bf16 v[8:11], v[192:195], v[92:95], v[8:11]
    v_mfma_f32_16x16x32_bf16 v[12:15], v[196:199], v[92:95], v[12:15]
    v_mfma_f32_16x16x32_bf16 v[12:15], v[172:175], v[88:91], v[12:15]
    v_mfma_f32_16x16x32_bf16 v[32:35], v[176:179], v[88:91], v[32:35]
    v_mfma_f32_16x16x32_bf16 v[32:35], v[200:203], v[92:95], v[32:35]
    v_mfma_f32_16x16x32_bf16 v[36:39], v[204:207], v[92:95], v[36:39]
    v_mfma_f32_16x16x32_bf16 v[36:39], v[180:183], v[88:91], v[36:39]
    ds_read_b128 v[88:91], v1 offset:16384
    s_waitcnt lgkmcnt(2)
    v_mfma_f32_16x16x32_bf16 v[16:19], v[208:211], v[96:99], v[16:19]
    ds_read_b128 v[92:95], v1 offset:16640
    s_waitcnt lgkmcnt(2)
    v_mfma_f32_16x16x32_bf16 v[16:19], v[232:235], v[100:103], v[16:19]
    v_mfma_f32_16x16x32_bf16 v[20:23], v[236:239], v[100:103], v[20:23]
    v_mfma_f32_16x16x32_bf16 v[20:23], v[212:215], v[96:99], v[20:23]
    v_mfma_f32_16x16x32_bf16 v[8:11], v[216:219], v[96:99], v[8:11]
    v_mfma_f32_16x16x32_bf16 v[8:11], v[240:243], v[100:103], v[8:11]
    v_mfma_f32_16x16x32_bf16 v[12:15], v[244:247], v[100:103], v[12:15]
    v_mfma_f32_16x16x32_bf16 v[12:15], v[220:223], v[96:99], v[12:15]
    v_mfma_f32_16x16x32_bf16 v[32:35], v[224:227], v[96:99], v[32:35]
    v_mfma_f32_16x16x32_bf16 v[32:35], v[248:251], v[100:103], v[32:35]
    v_mfma_f32_16x16x32_bf16 v[36:39], v[252:255], v[100:103], v[36:39]
    v_mfma_f32_16x16x32_bf16 v[36:39], v[228:231], v[96:99], v[36:39]
    ds_read_b128 v[96:99], v1 offset:16896
    s_waitcnt lgkmcnt(2)
    v_mfma_f32_16x16x32_bf16 v[24:27], a[0:3], v[88:91], 0
    ds_read_b128 v[100:103], v1 offset:17152
    s_waitcnt lgkmcnt(2)
    v_mfma_f32_16x16x32_bf16 v[24:27], a[24:27], v[92:95], v[24:27]
    s_add_u32 s38, s38, 1024
    s_cmp_lt_u32 s38, 32768
    s_cselect_b32 s29, s38, 0x100000
    s_add_u32 m0, s37, 49152
    v_mfma_f32_16x16x32_bf16 v[28:31], a[28:31], v[92:95], 0
    buffer_load_dwordx4 v4, s[8:11], s29 offen lds
    v_mfma_f32_16x16x32_bf16 v[28:31], a[4:7], v[88:91], v[28:31]
    v_mfma_f32_16x16x32_bf16 v[16:19], a[8:11], v[88:91], v[16:19]
    s_add_u32 m0, s37, 53248
    v_mfma_f32_16x16x32_bf16 v[16:19], a[32:35], v[92:95], v[16:19]
    buffer_load_dwordx4 v5, s[8:11], s29 offen lds
    v_mfma_f32_16x16x32_bf16 v[20:23], a[36:39], v[92:95], v[20:23]
    v_mfma_f32_16x16x32_bf16 v[20:23], a[12:15], v[88:91], v[20:23]
    s_add_u32 m0, s37, 57344
    v_mfma_f32_16x16x32_bf16 v[8:11], a[16:19], v[88:91], v[8:11]
    buffer_load_dwordx4 v6, s[8:11], s29 offen lds
    v_mfma_f32_16x16x32_bf16 v[8:11], a[40:43], v[92:95], v[8:11]
    v_fma_f32 v32, v32, v104, v112
    v_mfma_f32_16x16x32_bf16 v[12:15], a[44:47], v[92:95], v[12:15]
    v_fma_f32 v33, v33, v105, v113
    s_add_u32 m0, s37, 61440
    v_mfma_f32_16x16x32_bf16 v[12:15], a[20:23], v[88:91], v[12:15]
    ds_read_b128 v[88:91], v1 offset:20480
    s_waitcnt lgkmcnt(2)
    v_mfma_f32_16x16x32_bf16 v[24:27], a[48:51], v[96:99], v[24:27]
    ds_read_b128 v[92:95], v1 offset:20736
    s_waitcnt lgkmcnt(2)
    v_mfma_f32_16x16x32_bf16 v[24:27], a[72:75], v[100:103], v[24:27]
    buffer_load_dwordx4 v7, s[8:11], s29 offen lds
    v_mfma_f32_16x16x32_bf16 v[28:31], a[76:79], v[100:103], v[28:31]
    v_fma_f32 v34, v34, v106, v114
    v_mfma_f32_16x16x32_bf16 v[28:31], a[52:55], v[96:99], v[28:31]
    v_fma_f32 v35, v35, v107, v115
    v_mfma_f32_16x16x32_bf16 v[16:19], a[56:59], v[96:99], v[16:19]
    v_fma_f32 v36, v36, v108, v116
    v_mfma_f32_16x16x32_bf16 v[16:19], a[80:83], v[100:103], v[16:19]
    v_fma_f32 v37, v37, v109, v117
    v_mfma_f32_16x16x32_bf16 v[20:23], a[84:87], v[100:103], v[20:23]
    v_fma_f32 v38, v38, v110, v118
    v_mfma_f32_16x16x32_bf16 v[20:23], a[60:63], v[96:99], v[20:23]
    v_fma_f32 v39, v39, v111, v119
    v_mfma_f32_16x16x32_bf16 v[8:11], a[64:67], v[96:99], v[8:11]
    v_exp_f32 v120, v32
    v_mfma_f32_16x16x32_bf16 v[8:11], a[88:91], v[100:103], v[8:11]
    v_exp_f32 v121, v33
    v_mfma_f32_16x16x32_bf16 v[12:15], a[92:95], v[100:103], v[12:15]
    v_exp_f32 v122, v34
    v_mfma_f32_16x16x32_bf16 v[12:15], a[68:71], v[96:99], v[12:15]
    ds_read_b128 v[96:99], v1 offset:20992
    s_waitcnt lgkmcnt(2)
    v_mfma_f32_16x16x32_bf16 v[24:27], a[96:99], v[88:91], v[24:27]
    ds_read_b128 v[100:103], v1 offset:21248
    s_waitcnt lgkmcnt(2)
    v_mfma_f32_16x16x32_bf16 v[24:27], a[120:123], v[92:95], v[24:27]
    v_exp_f32 v123, v35
    v_mfma_f32_16x16x32_bf16 v[28:31], a[124:127], v[92:95], v[28:31]
    v_exp_f32 v124, v36
    v_mfma_f32_16x16x32_bf16 v[28:31], a[100:103], v[88:91], v[28:31]
    v_exp_f32 v125, v37
    v_mfma_f32_16x16x32_bf16 v[16:19], a[104:107], v[88:91], v[16:19]
    v_exp_f32 v126, v38
    v_mfma_f32_16x16x32_bf16 v[16:19], a[128:131], v[92:95], v[16:19]
    v_exp_f32 v127, v39
    v_mfma_f32_16x16x32_bf16 v[20:23], a[132:135], v[92:95], v[20:23]
    v_fma_f32 v120, v120, s28, s28
    v_mfma_f32_16x16x32_bf16 v[20:23], a[108:111], v[88:91], v[20:23]
    v_fma_f32 v121, v121, s28, s28
    v_mfma_f32_16x16x32_bf16 v[8:11], a[112:115], v[88:91], v[8:11]
    v_fma_f32 v122, v122, s28, s28
    v_mfma_f32_16x16x32_bf16 v[8:11], a[136:139], v[92:95], v[8:11]
    v_fma_f32 v123, v123, s28, s28
    v_mfma_f32_16x16x32_bf16 v[12:15], a[140:143], v[92:95], v[12:15]
    v_fma_f32 v124, v124, s28, s28
    v_mfma_f32_16x16x32_bf16 v[12:15], a[116:119], v[88:91], v[12:15]
    ds_read_b128 v[88:91], v1 offset:24576
    s_waitcnt lgkmcnt(2)
    v_mfma_f32_16x16x32_bf16 v[24:27], a[144:147], v[96:99], v[24:27]
    ds_read_b128 v[92:95], v1 offset:24832
    s_waitcnt lgkmcnt(2)
    v_mfma_f32_16x16x32_bf16 v[24:27], a[168:171], v[100:103], v[24:27]
    v_fma_f32 v125, v125, s28, s28
    v_mfma_f32_16x16x32_bf16 v[28:31], a[172:175], v[100:103], v[28:31]
    v_fma_f32 v126, v126, s28, s28
    v_mfma_f32_16x16x32_bf16 v[28:31], a[148:151], v[96:99], v[28:31]
    v_fma_f32 v127, v127, s28, s28
    v_mfma_f32_16x16x32_bf16 v[16:19], a[152:155], v[96:99], v[16:19]
    v_rcp_f32 v120, v120
    v_mfma_f32_16x16x32_bf16 v[16:19], a[176:179], v[100:103], v[16:19]
    v_rcp_f32 v121, v121
    v_mfma_f32_16x16x32_bf16 v[20:23], a[180:183], v[100:103], v[20:23]
    v_rcp_f32 v122, v122
    v_mfma_f32_16x16x32_bf16 v[20:23], a[156:159], v[96:99], v[20:23]
    v_rcp_f32 v123, v123
    v_mfma_f32_16x16x32_bf16 v[8:11], a[160:163], v[96:99], v[8:11]
    v_rcp_f32 v124, v124
    v_mfma_f32_16x16x32_bf16 v[8:11], a[184:187], v[100:103], v[8:11]
    v_rcp_f32 v125, v125
    v_mfma_f32_16x16x32_bf16 v[12:15], a[188:191], v[100:103], v[12:15]
    v_rcp_f32 v126, v126
    v_mfma_f32_16x16x32_bf16 v[12:15], a[164:167], v[96:99], v[12:15]
    ds_read_b128 v[96:99], v1 offset:25088
    s_waitcnt lgkmcnt(2)
    v_mfma_f32_16x16x32_bf16 v[24:27], a[192:195], v[88:91], v[24:27]
    ds_read_b128 v[100:103], v1 offset:25344
    s_waitcnt lgkmcnt(2)
    v_mfma_f32_16x16x32_bf16 v[24:27], a[216:219], v[92:95], v[24:27]
    v_rcp_f32 v127, v127
    v_mfma_f32_16x16x32_bf16 v[28:31], a[220:223], v[92:95], v[28:31]
    v_mul_f32 v32, v32, v120
    v_mfma_f32_16x16x32_bf16 v[28:31], a[196:199], v[88:91], v[28:31]
    v_mul_f32 v33, v33, v121
    v_mfma_f32_16x16x32_bf16 v[16:19], a[200:203], v[88:91], v[16:19]
    v_mul_f32 v34, v34, v122
    v_mfma_f32_16x16x32_bf16 v[16:19], a[224:227], v[92:95], v[16:19]
    v_mul_f32 v35, v35, v123
    v_mfma_f32_16x16x32_bf16 v[20:23], a[228:231], v[92:95], v[20:23]
    v_mul_f32 v36, v36, v124
    v_mfma_f32_16x16x32_bf16 v[20:23], a[204:207], v[88:91], v[20:23]
    v_mul_f32 v37, v37, v125
    v_mfma_f32_16x16x32_bf16 v[8:11], a[208:211], v[88:91], v[8:11]
    v_mul_f32 v38, v38, v126
    v_mfma_f32_16x16x32_bf16 v[8:11], a[232:235], v[92:95], v[8:11]
    v_mul_f32 v39, v39, v127
    v_mfma_f32_16x16x32_bf16 v[12:15], a[236:239], v[92:95], v[12:15]
    v_cvt_pk_bf16_f32 v32, v32, v33
    v_mfma_f32_16x16x32_bf16 v[12:15], a[212:215], v[88:91], v[12:15]
    ds_read_b128 v[88:91], v1 offset:28672
    s_waitcnt lgkmcnt(2)
    v_mfma_f32_16x16x32_bf16 v[24:27], a[240:243], v[96:99], v[24:27]
    ds_read_b128 v[92:95], v1 offset:28928
    s_waitcnt lgkmcnt(2)
    v_mfma_f32_16x16x32_bf16 v[24:27], v[136:139], v[100:103], v[24:27]
    v_cvt_pk_bf16_f32 v33, v34, v35
    v_mfma_f32_16x16x32_bf16 v[28:31], v[140:143], v[100:103], v[28:31]
    v_cvt_pk_bf16_f32 v34, v36, v37
    v_mfma_f32_16x16x32_bf16 v[28:31], a[244:247], v[96:99], v[28:31]
    v_cvt_pk_bf16_f32 v35, v38, v39
    v_mfma_f32_16x16x32_bf16 v[16:19], a[248:251], v[96:99], v[16:19]
    v_mfma_f32_16x16x32_bf16 v[16:19], v[144:147], v[100:103], v[16:19]
    v_permlane16_swap_b32 v32, v34
    v_mfma_f32_16x16x32_bf16 v[20:23], v[148:151], v[100:103], v[20:23]
    v_permlane16_swap_b32 v33, v35
    s_add_u32 s39, s39, 1024
    v_mfma_f32_16x16x32_bf16 v[20:23], a[252:255], v[96:99], v[20:23]
    buffer_store_dwordx4 v[32:35], v3, s[16:19], s39 offen nt
    v_mfma_f32_16x16x32_bf16 v[8:11], v[128:131], v[96:99], v[8:11]
    v_mfma_f32_16x16x32_bf16 v[8:11], v[152:155], v[100:103], v[8:11]
    v_mfma_f32_16x16x32_bf16 v[12:15], v[156:159], v[100:103], v[12:15]
    v_mfma_f32_16x16x32_bf16 v[12:15], v[132:135], v[96:99], v[12:15]
    ds_read_b128 v[96:99], v1 offset:29184
    s_waitcnt lgkmcnt(2)
    v_mfma_f32_16x16x32_bf16 v[24:27], v[160:163], v[88:91], v[24:27]
    ds_read_b128 v[100:103], v1 offset:29440
    s_waitcnt lgkmcnt(2)
    v_mfma_f32_16x16x32_bf16 v[24:27], v[184:187], v[92:95], v[24:27]
    v_mfma_f32_16x16x32_bf16 v[28:31], v[188:191], v[92:95], v[28:31]
    v_mfma_f32_16x16x32_bf16 v[28:31], v[164:167], v[88:91], v[28:31]
    v_mfma_f32_16x16x32_bf16 v[16:19], v[168:171], v[88:91], v[16:19]
    v_mfma_f32_16x16x32_bf16 v[16:19], v[192:195], v[92:95], v[16:19]
    v_mfma_f32_16x16x32_bf16 v[20:23], v[196:199], v[92:95], v[20:23]
    v_mfma_f32_16x16x32_bf16 v[20:23], v[172:175], v[88:91], v[20:23]
    v_mfma_f32_16x16x32_bf16 v[8:11], v[176:179], v[88:91], v[8:11]
    v_mfma_f32_16x16x32_bf16 v[8:11], v[200:203], v[92:95], v[8:11]
    v_mfma_f32_16x16x32_bf16 v[12:15], v[204:207], v[92:95], v[12:15]
    v_mfma_f32_16x16x32_bf16 v[12:15], v[180:183], v[88:91], v[12:15]
    ds_read_b128 v[88:91], v1 offset:32768
    s_waitcnt lgkmcnt(2)
    v_mfma_f32_16x16x32_bf16 v[24:27], v[208:211], v[96:99], v[24:27]
    ds_read_b128 v[92:95], v1 offset:33024
    s_waitcnt lgkmcnt(2)
    v_mfma_f32_16x16x32_bf16 v[24:27], v[232:235], v[100:103], v[24:27]
    v_mfma_f32_16x16x32_bf16 v[28:31], v[236:239], v[100:103], v[28:31]
    v_mfma_f32_16x16x32_bf16 v[28:31], v[212:215], v[96:99], v[28:31]
    v_mfma_f32_16x16x32_bf16 v[16:19], v[216:219], v[96:99], v[16:19]
    v_mfma_f32_16x16x32_bf16 v[16:19], v[240:243], v[100:103], v[16:19]
    v_mfma_f32_16x16x32_bf16 v[20:23], v[244:247], v[100:103], v[20:23]
    v_mfma_f32_16x16x32_bf16 v[20:23], v[220:223], v[96:99], v[20:23]
    v_mfma_f32_16x16x32_bf16 v[8:11], v[224:227], v[96:99], v[8:11]
    v_mfma_f32_16x16x32_bf16 v[8:11], v[248:251], v[100:103], v[8:11]
    v_mfma_f32_16x16x32_bf16 v[12:15], v[252:255], v[100:103], v[12:15]
    v_mfma_f32_16x16x32_bf16 v[12:15], v[228:231], v[96:99], v[12:15]
    ds_read_b128 v[96:99], v1 offset:33280
    s_waitcnt lgkmcnt(2)
    v_mfma_f32_16x16x32_bf16 v[32:35], a[0:3], v[88:91], 0
    ds_read_b128 v[100:103], v1 offset:33536
    s_waitcnt lgkmcnt(2)
    v_mfma_f32_16x16x32_bf16 v[32:35], a[24:27], v[92:95], v[32:35]
    s_waitcnt vmcnt(16)
    s_barrier
    v_mfma_f32_16x16x32_bf16 v[36:39], a[28:31], v[92:95], 0
    s_add_u32 s38, s38, 1024
    s_cmp_lt_u32 s38, 32768
    s_cselect_b32 s29, s38, 0x100000
    s_add_u32 m0, s36, 0
    v_mfma_f32_16x16x32_bf16 v[36:39], a[4:7], v[88:91], v[36:39]
    buffer_load_dwordx4 v4, s[8:11], s29 offen lds
    v_mfma_f32_16x16x32_bf16 v[24:27], a[8:11], v[88:91], v[24:27]
    v_mfma_f32_16x16x32_bf16 v[24:27], a[32:35], v[92:95], v[24:27]
    s_add_u32 m0, s36, 4096
    v_mfma_f32_16x16x32_bf16 v[28:31], a[36:39], v[92:95], v[28:31]
    buffer_load_dwordx4 v5, s[8:11], s29 offen lds
    v_mfma_f32_16x16x32_bf16 v[28:31], a[12:15], v[88:91], v[28:31]
    v_mfma_f32_16x16x32_bf16 v[16:19], a[16:19], v[88:91], v[16:19]
    v_fma_f32 v8, v8, v104, v112
    s_add_u32 m0, s36, 8192
    v_mfma_f32_16x16x32_bf16 v[16:19], a[40:43], v[92:95], v[16:19]
    buffer_load_dwordx4 v6, s[8:11], s29 offen lds
    v_mfma_f32_16x16x32_bf16 v[20:23], a[44:47], v[92:95], v[20:23]
    v_fma_f32 v9, v9, v105, v113
    v_mfma_f32_16x16x32_bf16 v[20:23], a[20:23], v[88:91], v[20:23]
    ds_read_b128 v[88:91], v1 offset:36864
    s_waitcnt lgkmcnt(2)
    v_mfma_f32_16x16x32_bf16 v[32:35], a[48:51], v[96:99], v[32:35]
    ds_read_b128 v[92:95], v1 offset:37120
    s_waitcnt lgkmcnt(2)
    v_mfma_f32_16x16x32_bf16 v[32:35], a[72:75], v[100:103], v[32:35]
    v_fma_f32 v10, v10, v106, v114
    s_add_u32 m0, s36, 12288
    v_mfma_f32_16x16x32_bf16 v[36:39], a[76:79], v[100:103], v[36:39]
    buffer_load_dwordx4 v7, s[8:11], s29 offen lds
    v_mfma_f32_16x16x32_bf16 v[36:39], a[52:55], v[96:99], v[36:39]
    v_fma_f32 v11, v11, v107, v115
    v_mfma_f32_16x16x32_bf16 v[24:27], a[56:59], v[96:99], v[24:27]
    v_fma_f32 v12, v12, v108, v116
    v_mfma_f32_16x16x32_bf16 v[24:27], a[80:83], v[100:103], v[24:27]
    v_fma_f32 v13, v13, v109, v117
    v_mfma_f32_16x16x32_bf16 v[28:31], a[84:87], v[100:103], v[28:31]
    v_fma_f32 v14, v14, v110, v118
    v_mfma_f32_16x16x32_bf16 v[28:31], a[60:63], v[96:99], v[28:31]
    v_fma_f32 v15, v15, v111, v119
    v_mfma_f32_16x16x32_bf16 v[16:19], a[64:67], v[96:99], v[16:19]
    v_exp_f32 v120, v8
    v_mfma_f32_16x16x32_bf16 v[16:19], a[88:91], v[100:103], v[16:19]
    v_exp_f32 v121, v9
    v_mfma_f32_16x16x32_bf16 v[20:23], a[92:95], v[100:103], v[20:23]
    v_exp_f32 v122, v10
    v_mfma_f32_16x16x32_bf16 v[20:23], a[68:71], v[96:99], v[20:23]
    ds_read_b128 v[96:99], v1 offset:37376
    s_waitcnt lgkmcnt(2)
    v_mfma_f32_16x16x32_bf16 v[32:35], a[96:99], v[88:91], v[32:35]
    ds_read_b128 v[100:103], v1 offset:37632
    s_waitcnt lgkmcnt(2)
    v_mfma_f32_16x16x32_bf16 v[32:35], a[120:123], v[92:95], v[32:35]
    v_exp_f32 v123, v11
    v_mfma_f32_16x16x32_bf16 v[36:39], a[124:127], v[92:95], v[36:39]
    v_exp_f32 v124, v12
    v_mfma_f32_16x16x32_bf16 v[36:39], a[100:103], v[88:91], v[36:39]
    v_exp_f32 v125, v13
    v_mfma_f32_16x16x32_bf16 v[24:27], a[104:107], v[88:91], v[24:27]
    v_exp_f32 v126, v14
    v_mfma_f32_16x16x32_bf16 v[24:27], a[128:131], v[92:95], v[24:27]
    v_exp_f32 v127, v15
    v_mfma_f32_16x16x32_bf16 v[28:31], a[132:135], v[92:95], v[28:31]
    v_fma_f32 v120, v120, s28, s28
    v_mfma_f32_16x16x32_bf16 v[28:31], a[108:111], v[88:91], v[28:31]
    v_fma_f32 v121, v121, s28, s28
    v_mfma_f32_16x16x32_bf16 v[16:19], a[112:115], v[88:91], v[16:19]
    v_fma_f32 v122, v122, s28, s28
    v_mfma_f32_16x16x32_bf16 v[16:19], a[136:139], v[92:95], v[16:19]
    v_fma_f32 v123, v123, s28, s28
    v_mfma_f32_16x16x32_bf16 v[20:23], a[140:143], v[92:95], v[20:23]
    v_fma_f32 v124, v124, s28, s28
    v_mfma_f32_16x16x32_bf16 v[20:23], a[116:119], v[88:91], v[20:23]
    ds_read_b128 v[88:91], v1 offset:40960
    s_waitcnt lgkmcnt(2)
    v_mfma_f32_16x16x32_bf16 v[32:35], a[144:147], v[96:99], v[32:35]
    ds_read_b128 v[92:95], v1 offset:41216
    s_waitcnt lgkmcnt(2)
    v_mfma_f32_16x16x32_bf16 v[32:35], a[168:171], v[100:103], v[32:35]
    v_fma_f32 v125, v125, s28, s28
    v_mfma_f32_16x16x32_bf16 v[36:39], a[172:175], v[100:103], v[36:39]
    v_fma_f32 v126, v126, s28, s28
    v_mfma_f32_16x16x32_bf16 v[36:39], a[148:151], v[96:99], v[36:39]
    v_fma_f32 v127, v127, s28, s28
    v_mfma_f32_16x16x32_bf16 v[24:27], a[152:155], v[96:99], v[24:27]
    v_rcp_f32 v120, v120
    v_mfma_f32_16x16x32_bf16 v[24:27], a[176:179], v[100:103], v[24:27]
    v_rcp_f32 v121, v121
    v_mfma_f32_16x16x32_bf16 v[28:31], a[180:183], v[100:103], v[28:31]
    v_rcp_f32 v122, v122
    v_mfma_f32_16x16x32_bf16 v[28:31], a[156:159], v[96:99], v[28:31]
    v_rcp_f32 v123, v123
    v_mfma_f32_16x16x32_bf16 v[16:19], a[160:163], v[96:99], v[16:19]
    v_rcp_f32 v124, v124
    v_mfma_f32_16x16x32_bf16 v[16:19], a[184:187], v[100:103], v[16:19]
    v_rcp_f32 v125, v125
    v_mfma_f32_16x16x32_bf16 v[20:23], a[188:191], v[100:103], v[20:23]
    v_rcp_f32 v126, v126
    v_mfma_f32_16x16x32_bf16 v[20:23], a[164:167], v[96:99], v[20:23]
    ds_read_b128 v[96:99], v1 offset:41472
    s_waitcnt lgkmcnt(2)
    v_mfma_f32_16x16x32_bf16 v[32:35], a[192:195], v[88:91], v[32:35]
    ds_read_b128 v[100:103], v1 offset:41728
    s_waitcnt lgkmcnt(2)
    v_mfma_f32_16x16x32_bf16 v[32:35], a[216:219], v[92:95], v[32:35]
    v_rcp_f32 v127, v127
    v_mfma_f32_16x16x32_bf16 v[36:39], a[220:223], v[92:95], v[36:39]
    v_mul_f32 v8, v8, v120
    v_mfma_f32_16x16x32_bf16 v[36:39], a[196:199], v[88:91], v[36:39]
    v_mul_f32 v9, v9, v121
    v_mfma_f32_16x16x32_bf16 v[24:27], a[200:203], v[88:91], v[24:27]
    v_mul_f32 v10, v10, v122
    v_mfma_f32_16x16x32_bf16 v[24:27], a[224:227], v[92:95], v[24:27]
    v_mul_f32 v11, v11, v123
    v_mfma_f32_16x16x32_bf16 v[28:31], a[228:231], v[92:95], v[28:31]
    v_mul_f32 v12, v12, v124
    v_mfma_f32_16x16x32_bf16 v[28:31], a[204:207], v[88:91], v[28:31]
    v_mul_f32 v13, v13, v125
    v_mfma_f32_16x16x32_bf16 v[16:19], a[208:211], v[88:91], v[16:19]
    v_mul_f32 v14, v14, v126
    v_mfma_f32_16x16x32_bf16 v[16:19], a[232:235], v[92:95], v[16:19]
    v_mul_f32 v15, v15, v127
    v_mfma_f32_16x16x32_bf16 v[20:23], a[236:239], v[92:95], v[20:23]
    v_cvt_pk_bf16_f32 v8, v8, v9
    v_mfma_f32_16x16x32_bf16 v[20:23], a[212:215], v[88:91], v[20:23]
    ds_read_b128 v[88:91], v1 offset:45056
    s_waitcnt lgkmcnt(2)
    v_mfma_f32_16x16x32_bf16 v[32:35], a[240:243], v[96:99], v[32:35]
    ds_read_b128 v[92:95], v1 offset:45312
    s_waitcnt lgkmcnt(2)
    v_mfma_f32_16x16x32_bf16 v[32:35], v[136:139], v[100:103], v[32:35]
    v_cvt_pk_bf16_f32 v9, v10, v11
    v_mfma_f32_16x16x32_bf16 v[36:39], v[140:143], v[100:103], v[36:39]
    v_cvt_pk_bf16_f32 v10, v12, v13
    v_mfma_f32_16x16x32_bf16 v[36:39], a[244:247], v[96:99], v[36:39]
    v_cvt_pk_bf16_f32 v11, v14, v15
    v_mfma_f32_16x16x32_bf16 v[24:27], a[248:251], v[96:99], v[24:27]
    v_mfma_f32_16x16x32_bf16 v[24:27], v[144:147], v[100:103], v[24:27]
    v_permlane16_swap_b32 v8, v10
    v_mfma_f32_16x16x32_bf16 v[28:31], v[148:151], v[100:103], v[28:31]
    v_permlane16_swap_b32 v9, v11
    s_add_u32 s39, s39, 1024
    v_mfma_f32_16x16x32_bf16 v[28:31], a[252:255], v[96:99], v[28:31]
    buffer_store_dwordx4 v[8:11], v3, s[16:19], s39 offen nt
    v_mfma_f32_16x16x32_bf16 v[16:19], v[128:131], v[96:99], v[16:19]
    v_mfma_f32_16x16x32_bf16 v[16:19], v[152:155], v[100:103], v[16:19]
    v_mfma_f32_16x16x32_bf16 v[20:23], v[156:159], v[100:103], v[20:23]
    v_mfma_f32_16x16x32_bf16 v[20:23], v[132:135], v[96:99], v[20:23]
    ds_read_b128 v[96:99], v1 offset:45568
    s_waitcnt lgkmcnt(2)
    v_mfma_f32_16x16x32_bf16 v[32:35], v[160:163], v[88:91], v[32:35]
    ds_read_b128 v[100:103], v1 offset:45824
    s_waitcnt lgkmcnt(2)
    v_mfma_f32_16x16x32_bf16 v[32:35], v[184:187], v[92:95], v[32:35]
    v_mfma_f32_16x16x32_bf16 v[36:39], v[188:191], v[92:95], v[36:39]
    v_mfma_f32_16x16x32_bf16 v[36:39], v[164:167], v[88:91], v[36:39]
    v_mfma_f32_16x16x32_bf16 v[24:27], v[168:171], v[88:91], v[24:27]
    v_mfma_f32_16x16x32_bf16 v[24:27], v[192:195], v[92:95], v[24:27]
    v_mfma_f32_16x16x32_bf16 v[28:31], v[196:199], v[92:95], v[28:31]
    v_mfma_f32_16x16x32_bf16 v[28:31], v[172:175], v[88:91], v[28:31]
    v_mfma_f32_16x16x32_bf16 v[16:19], v[176:179], v[88:91], v[16:19]
    v_mfma_f32_16x16x32_bf16 v[16:19], v[200:203], v[92:95], v[16:19]
    v_mfma_f32_16x16x32_bf16 v[20:23], v[204:207], v[92:95], v[20:23]
    v_mfma_f32_16x16x32_bf16 v[20:23], v[180:183], v[88:91], v[20:23]
    ds_read_b128 v[88:91], v1 offset:49152
    s_waitcnt lgkmcnt(2)
    v_mfma_f32_16x16x32_bf16 v[32:35], v[208:211], v[96:99], v[32:35]
    ds_read_b128 v[92:95], v1 offset:49408
    s_waitcnt lgkmcnt(2)
    v_mfma_f32_16x16x32_bf16 v[32:35], v[232:235], v[100:103], v[32:35]
    v_mfma_f32_16x16x32_bf16 v[36:39], v[236:239], v[100:103], v[36:39]
    v_mfma_f32_16x16x32_bf16 v[36:39], v[212:215], v[96:99], v[36:39]
    v_mfma_f32_16x16x32_bf16 v[24:27], v[216:219], v[96:99], v[24:27]
    v_mfma_f32_16x16x32_bf16 v[24:27], v[240:243], v[100:103], v[24:27]
    v_mfma_f32_16x16x32_bf16 v[28:31], v[244:247], v[100:103], v[28:31]
    v_mfma_f32_16x16x32_bf16 v[28:31], v[220:223], v[96:99], v[28:31]
    v_mfma_f32_16x16x32_bf16 v[16:19], v[224:227], v[96:99], v[16:19]
    v_mfma_f32_16x16x32_bf16 v[16:19], v[248:251], v[100:103], v[16:19]
    v_mfma_f32_16x16x32_bf16 v[20:23], v[252:255], v[100:103], v[20:23]
    v_mfma_f32_16x16x32_bf16 v[20:23], v[228:231], v[96:99], v[20:23]
    ds_read_b128 v[96:99], v1 offset:49664
    s_cmp_eq_u32 s40, 2
    s_cbranch_scc1 L_tail
    s_waitcnt lgkmcnt(2)
    v_mfma_f32_16x16x32_bf16 v[8:11], a[0:3], v[88:91], 0
    ds_read_b128 v[100:103], v1 offset:49920
    s_waitcnt lgkmcnt(2)
    v_mfma_f32_16x16x32_bf16 v[8:11], a[24:27], v[92:95], v[8:11]
    s_add_u32 s38, s38, 1024
    s_cmp_lt_u32 s38, 32768
    s_cselect_b32 s29, s38, 0x100000
    s_add_u32 m0, s36, 16384
    v_mfma_f32_16x16x32_bf16 v[12:15], a[28:31], v[92:95], 0
    buffer_load_dwordx4 v4, s[8:11], s29 offen lds
    v_mfma_f32_16x16x32_bf16 v[12:15], a[4:7], v[88:91], v[12:15]
    v_mfma_f32_16x16x32_bf16 v[32:35], a[8:11], v[88:91], v[32:35]
    s_add_u32 m0, s36, 20480
    v_mfma_f32_16x16x32_bf16 v[32:35], a[32:35], v[92:95], v[32:35]
    buffer_load_dwordx4 v5, s[8:11], s29 offen lds
    v_mfma_f32_16x16x32_bf16 v[36:39], a[36:39], v[92:95], v[36:39]
    v_mfma_f32_16x16x32_bf16 v[36:39], a[12:15], v[88:91], v[36:39]
    s_add_u32 m0, s36, 24576
    v_mfma_f32_16x16x32_bf16 v[24:27], a[16:19], v[88:91], v[24:27]
    buffer_load_dwordx4 v6, s[8:11], s29 offen lds
    v_mfma_f32_16x16x32_bf16 v[24:27], a[40:43], v[92:95], v[24:27]
    v_fma_f32 v16, v16, v104, v112
    v_mfma_f32_16x16x32_bf16 v[28:31], a[44:47], v[92:95], v[28:31]
    v_fma_f32 v17, v17, v105, v113
    s_add_u32 m0, s36, 28672
    v_mfma_f32_16x16x32_bf16 v[28:31], a[20:23], v[88:91], v[28:31]
    ds_read_b128 v[88:91], v1 offset:53248
    s_waitcnt lgkmcnt(2)
    v_mfma_f32_16x16x32_bf16 v[8:11], a[48:51], v[96:99], v[8:11]
    ds_read_b128 v[92:95], v1 offset:53504
    s_waitcnt lgkmcnt(2)
    v_mfma_f32_16x16x32_bf16 v[8:11], a[72:75], v[100:103], v[8:11]
    buffer_load_dwordx4 v7, s[8:11], s29 offen lds
    v_mfma_f32_16x16x32_bf16 v[12:15], a[76:79], v[100:103], v[12:15]
    v_fma_f32 v18, v18, v106, v114
    v_mfma_f32_16x16x32_bf16 v[12:15], a[52:55], v[96:99], v[12:15]
    v_fma_f32 v19, v19, v107, v115
    v_mfma_f32_16x16x32_bf16 v[32:35], a[56:59], v[96:99], v[32:35]
    v_fma_f32 v20, v20, v108, v116
    v_mfma_f32_16x16x32_bf16 v[32:35], a[80:83], v[100:103], v[32:35]
    v_fma_f32 v21, v21, v109, v117
    v_mfma_f32_16x16x32_bf16 v[36:39], a[84:87], v[100:103], v[36:39]
    v_fma_f32 v22, v22, v110, v118
    v_mfma_f32_16x16x32_bf16 v[36:39], a[60:63], v[96:99], v[36:39]
    v_fma_f32 v23, v23, v111, v119
    v_mfma_f32_16x16x32_bf16 v[24:27], a[64:67], v[96:99], v[24:27]
    v_exp_f32 v120, v16
    v_mfma_f32_16x16x32_bf16 v[24:27], a[88:91], v[100:103], v[24:27]
    v_exp_f32 v121, v17
    v_mfma_f32_16x16x32_bf16 v[28:31], a[92:95], v[100:103], v[28:31]
    v_exp_f32 v122, v18
    v_mfma_f32_16x16x32_bf16 v[28:31], a[68:71], v[96:99], v[28:31]
    ds_read_b128 v[96:99], v1 offset:53760
    s_waitcnt lgkmcnt(2)
    v_mfma_f32_16x16x32_bf16 v[8:11], a[96:99], v[88:91], v[8:11]
    ds_read_b128 v[100:103], v1 offset:54016
    s_waitcnt lgkmcnt(2)
    v_mfma_f32_16x16x32_bf16 v[8:11], a[120:123], v[92:95], v[8:11]
    v_exp_f32 v123, v19
    v_mfma_f32_16x16x32_bf16 v[12:15], a[124:127], v[92:95], v[12:15]
    v_exp_f32 v124, v20
    v_mfma_f32_16x16x32_bf16 v[12:15], a[100:103], v[88:91], v[12:15]
    v_exp_f32 v125, v21
    v_mfma_f32_16x16x32_bf16 v[32:35], a[104:107], v[88:91], v[32:35]
    v_exp_f32 v126, v22
    v_mfma_f32_16x16x32_bf16 v[32:35], a[128:131], v[92:95], v[32:35]
    v_exp_f32 v127, v23
    v_mfma_f32_16x16x32_bf16 v[36:39], a[132:135], v[92:95], v[36:39]
    v_fma_f32 v120, v120, s28, s28
    v_mfma_f32_16x16x32_bf16 v[36:39], a[108:111], v[88:91], v[36:39]
    v_fma_f32 v121, v121, s28, s28
    v_mfma_f32_16x16x32_bf16 v[24:27], a[112:115], v[88:91], v[24:27]
    v_fma_f32 v122, v122, s28, s28
    v_mfma_f32_16x16x32_bf16 v[24:27], a[136:139], v[92:95], v[24:27]
    v_fma_f32 v123, v123, s28, s28
    v_mfma_f32_16x16x32_bf16 v[28:31], a[140:143], v[92:95], v[28:31]
    v_fma_f32 v124, v124, s28, s28
    v_mfma_f32_16x16x32_bf16 v[28:31], a[116:119], v[88:91], v[28:31]
    ds_read_b128 v[88:91], v1 offset:57344
    s_waitcnt lgkmcnt(2)
    v_mfma_f32_16x16x32_bf16 v[8:11], a[144:147], v[96:99], v[8:11]
    ds_read_b128 v[92:95], v1 offset:57600
    s_waitcnt lgkmcnt(2)
    v_mfma_f32_16x16x32_bf16 v[8:11], a[168:171], v[100:103], v[8:11]
    v_fma_f32 v125, v125, s28, s28
    v_mfma_f32_16x16x32_bf16 v[12:15], a[172:175], v[100:103], v[12:15]
    v_fma_f32 v126, v126, s28, s28
    v_mfma_f32_16x16x32_bf16 v[12:15], a[148:151], v[96:99], v[12:15]
    v_fma_f32 v127, v127, s28, s28
    v_mfma_f32_16x16x32_bf16 v[32:35], a[152:155], v[96:99], v[32:35]
    v_rcp_f32 v120, v120
    v_mfma_f32_16x16x32_bf16 v[32:35], a[176:179], v[100:103], v[32:35]
    v_rcp_f32 v121, v121
    v_mfma_f32_16x16x32_bf16 v[36:39], a[180:183], v[100:103], v[36:39]
    v_rcp_f32 v122, v122
    v_mfma_f32_16x16x32_bf16 v[36:39], a[156:159], v[96:99], v[36:39]
    v_rcp_f32 v123, v123
    v_mfma_f32_16x16x32_bf16 v[24:27], a[160:163], v[96:99], v[24:27]
    v_rcp_f32 v124, v124
    v_mfma_f32_16x16x32_bf16 v[24:27], a[184:187], v[100:103], v[24:27]
    v_rcp_f32 v125, v125
    v_mfma_f32_16x16x32_bf16 v[28:31], a[188:191], v[100:103], v[28:31]
    v_rcp_f32 v126, v126
    v_mfma_f32_16x16x32_bf16 v[28:31], a[164:167], v[96:99], v[28:31]
    ds_read_b128 v[96:99], v1 offset:57856
    s_waitcnt lgkmcnt(2)
    v_mfma_f32_16x16x32_bf16 v[8:11], a[192:195], v[88:91], v[8:11]
    ds_read_b128 v[100:103], v1 offset:58112
    s_waitcnt lgkmcnt(2)
    v_mfma_f32_16x16x32_bf16 v[8:11], a[216:219], v[92:95], v[8:11]
    v_rcp_f32 v127, v127
    v_mfma_f32_16x16x32_bf16 v[12:15], a[220:223], v[92:95], v[12:15]
    v_mul_f32 v16, v16, v120
    v_mfma_f32_16x16x32_bf16 v[12:15], a[196:199], v[88:91], v[12:15]
    v_mul_f32 v17, v17, v121
    v_mfma_f32_16x16x32_bf16 v[32:35], a[200:203], v[88:91], v[32:35]
    v_mul_f32 v18, v18, v122
    v_mfma_f32_16x16x32_bf16 v[32:35], a[224:227], v[92:95], v[32:35]
    v_mul_f32 v19, v19, v123
    v_mfma_f32_16x16x32_bf16 v[36:39], a[228:231], v[92:95], v[36:39]
    v_mul_f32 v20, v20, v124
    v_mfma_f32_16x16x32_bf16 v[36:39], a[204:207], v[88:91], v[36:39]
    v_mul_f32 v21, v21, v125
    v_mfma_f32_16x16x32_bf16 v[24:27], a[208:211], v[88:91], v[24:27]
    v_mul_f32 v22, v22, v126
    v_mfma_f32_16x16x32_bf16 v[24:27], a[232:235], v[92:95], v[24:27]
    v_mul_f32 v23, v23, v127
    v_mfma_f32_16x16x32_bf16 v[28:31], a[236:239], v[92:95], v[28:31]
    v_cvt_pk_bf16_f32 v16, v16, v17
    v_mfma_f32_16x16x32_bf16 v[28:31], a[212:215], v[88:91], v[28:31]
    ds_read_b128 v[88:91], v1 offset:61440
    s_waitcnt lgkmcnt(2)
    v_mfma_f32_16x16x32_bf16 v[8:11], a[240:243], v[96:99], v[8:11]
    ds_read_b128 v[92:95], v1 offset:61696
    s_waitcnt lgkmcnt(2)
    v_mfma_f32_16x16x32_bf16 v[8:11], v[136:139], v[100:103], v[8:11]
    v_cvt_pk_bf16_f32 v17, v18, v19
    v_mfma_f32_16x16x32_bf16 v[12:15], v[140:143], v[100:103], v[12:15]
    v_cvt_pk_bf16_f32 v18, v20, v21
    v_mfma_f32_16x16x32_bf16 v[12:15], a[244:247], v[96:99], v[12:15]
    v_cvt_pk_bf16_f32 v19, v22, v23
    v_mfma_f32_16x16x32_bf16 v[32:35], a[248:251], v[96:99], v[32:35]
    v_mfma_f32_16x16x32_bf16 v[32:35], v[144:147], v[100:103], v[32:35]
    v_permlane16_swap_b32 v16, v18
    v_mfma_f32_16x16x32_bf16 v[36:39], v[148:151], v[100:103], v[36:39]
    v_permlane16_swap_b32 v17, v19
    s_add_u32 s39, s39, 1024
    v_mfma_f32_16x16x32_bf16 v[36:39], a[252:255], v[96:99], v[36:39]
    buffer_store_dwordx4 v[16:19], v3, s[16:19], s39 offen nt
    v_mfma_f32_16x16x32_bf16 v[24:27], v[128:131], v[96:99], v[24:27]
    v_mfma_f32_16x16x32_bf16 v[24:27], v[152:155], v[100:103], v[24:27]
    v_mfma_f32_16x16x32_bf16 v[28:31], v[156:159], v[100:103], v[28:31]
    v_mfma_f32_16x16x32_bf16 v[28:31], v[132:135], v[96:99], v[28:31]
    ds_read_b128 v[96:99], v1 offset:61952
    s_waitcnt lgkmcnt(2)
    v_mfma_f32_16x16x32_bf16 v[8:11], v[160:163], v[88:91], v[8:11]
    ds_read_b128 v[100:103], v1 offset:62208
    s_waitcnt lgkmcnt(2)
    v_mfma_f32_16x16x32_bf16 v[8:11], v[184:187], v[92:95], v[8:11]
    v_mfma_f32_16x16x32_bf16 v[12:15], v[188:191], v[92:95], v[12:15]
    v_mfma_f32_16x16x32_bf16 v[12:15], v[164:167], v[88:91], v[12:15]
    v_mfma_f32_16x16x32_bf16 v[32:35], v[168:171], v[88:91], v[32:35]
    v_mfma_f32_16x16x32_bf16 v[32:35], v[192:195], v[92:95], v[32:35]
    v_mfma_f32_16x16x32_bf16 v[36:39], v[196:199], v[92:95], v[36:39]
    v_mfma_f32_16x16x32_bf16 v[36:39], v[172:175], v[88:91], v[36:39]
    v_mfma_f32_16x16x32_bf16 v[24:27], v[176:179], v[88:91], v[24:27]
    v_mfma_f32_16x16x32_bf16 v[24:27], v[200:203], v[92:95], v[24:27]
    v_mfma_f32_16x16x32_bf16 v[28:31], v[204:207], v[92:95], v[28:31]
    v_mfma_f32_16x16x32_bf16 v[28:31], v[180:183], v[88:91], v[28:31]
    ds_read_b128 v[88:91], v2 offset:0
    s_waitcnt lgkmcnt(2)
    v_mfma_f32_16x16x32_bf16 v[8:11], v[208:211], v[96:99], v[8:11]
    ds_read_b128 v[92:95], v2 offset:256
    s_waitcnt lgkmcnt(2)
    v_mfma_f32_16x16x32_bf16 v[8:11], v[232:235], v[100:103], v[8:11]
    v_mfma_f32_16x16x32_bf16 v[12:15], v[236:239], v[100:103], v[12:15]
    v_mfma_f32_16x16x32_bf16 v[12:15], v[212:215], v[96:99], v[12:15]
    v_mfma_f32_16x16x32_bf16 v[32:35], v[216:219], v[96:99], v[32:35]
    v_mfma_f32_16x16x32_bf16 v[32:35], v[240:243], v[100:103], v[32:35]
    v_mfma_f32_16x16x32_bf16 v[36:39], v[244:247], v[100:103], v[36:39]
    v_mfma_f32_16x16x32_bf16 v[36:39], v[220:223], v[96:99], v[36:39]
    v_mfma_f32_16x16x32_bf16 v[24:27], v[224:227], v[96:99], v[24:27]
    v_mfma_f32_16x16x32_bf16 v[24:27], v[248:251], v[100:103], v[24:27]
    v_mfma_f32_16x16x32_bf16 v[28:31], v[252:255], v[100:103], v[28:31]
    v_mfma_f32_16x16x32_bf16 v[28:31], v[228:231], v[96:99], v[28:31]
    ds_read_b128 v[96:99], v2 offset:512
    v_swap_b32 v1, v2
    s_xor_b32 s36, s36, 0x10000
    s_xor_b32 s37, s37, 0x10000
    s_add_u32 s40, s40, 1
    s_branch L_loop
L_tail:
    ds_read_b128 v[100:103], v1 offset:49920
    ds_read_b128 v[40:43], v1 offset:53248
    ds_read_b128 v[44:47], v1 offset:53504
    ds_read_b128 v[48:51], v1 offset:53760
    ds_read_b128 v[52:55], v1 offset:54016
    ds_read_b128 v[56:59], v1 offset:57344
    ds_read_b128 v[60:63], v1 offset:57600
    ds_read_b128 v[64:67], v1 offset:57856
    ds_read_b128 v[68:71], v1 offset:58112
    ds_read_b128 v[72:75], v1 offset:61440
    ds_read_b128 v[76:79], v1 offset:61696
    s_waitcnt lgkmcnt(13)
    v_mfma_f32_16x16x32_bf16 v[24:27], a[16:19], v[88:91], v[24:27]
    ds_read_b128 v[80:83], v1 offset:61952
    s_waitcnt lgkmcnt(13)
    v_mfma_f32_16x16x32_bf16 v[24:27], a[40:43], v[92:95], v[24:27]
    ds_read_b128 v[84:87], v1 offset:62208
    v_mfma_f32_16x16x32_bf16 v[28:31], a[44:47], v[92:95], v[28:31]
    v_mfma_f32_16x16x32_bf16 v[28:31], a[20:23], v[88:91], v[28:31]
    s_waitcnt lgkmcnt(13)
    v_mfma_f32_16x16x32_bf16 v[24:27], a[64:67], v[96:99], v[24:27]
    s_waitcnt lgkmcnt(12)
    v_mfma_f32_16x16x32_bf16 v[24:27], a[88:91], v[100:103], v[24:27]
    v_mfma_f32_16x16x32_bf16 v[28:31], a[92:95], v[100:103], v[28:31]
    v_mfma_f32_16x16x32_bf16 v[28:31], a[68:71], v[96:99], v[28:31]
    s_waitcnt lgkmcnt(11)
    v_mfma_f32_16x16x32_bf16 v[24:27], a[112:115], v[40:43], v[24:27]
    v_fma_f32 v16, v16, v104, v112
    v_fma_f32 v17, v17, v105, v113
    s_waitcnt lgkmcnt(10)
    v_mfma_f32_16x16x32_bf16 v[24:27], a[136:139], v[44:47], v[24:27]
    v_fma_f32 v18, v18, v106, v114
    v_fma_f32 v19, v19, v107, v115
    v_mfma_f32_16x16x32_bf16 v[28:31], a[140:143], v[44:47], v[28:31]
    v_fma_f32 v20, v20, v108, v116
    v_fma_f32 v21, v21, v109, v117
    v_mfma_f32_16x16x32_bf16 v[28:31], a[116:119], v[40:43], v[28:31]
    v_fma_f32 v22, v22, v110, v118
    v_fma_f32 v23, v23, v111, v119
    s_waitcnt lgkmcnt(9)
    v_mfma_f32_16x16x32_bf16 v[24:27], a[160:163], v[48:51], v[24:27]
    v_exp_f32 v120, v16
    s_waitcnt lgkmcnt(8)
    v_mfma_f32_16x16x32_bf16 v[24:27], a[184:187], v[52:55], v[24:27]
    v_exp_f32 v121, v17
    v_mfma_f32_16x16x32_bf16 v[28:31], a[188:191], v[52:55], v[28:31]
    v_exp_f32 v122, v18
    v_mfma_f32_16x16x32_bf16 v[28:31], a[164:167], v[48:51], v[28:31]
    v_exp_f32 v123, v19
    s_waitcnt lgkmcnt(7)
    v_mfma_f32_16x16x32_bf16 v[24:27], a[208:211], v[56:59], v[24:27]
    v_exp_f32 v124, v20
    s_waitcnt lgkmcnt(6)
    v_mfma_f32_16x16x32_bf16 v[24:27], a[232:235], v[60:63], v[24:27]
    v_exp_f32 v125, v21
    v_mfma_f32_16x16x32_bf16 v[28:31], a[236:239], v[60:63], v[28:31]
    v_exp_f32 v126, v22
    v_mfma_f32_16x16x32_bf16 v[28:31], a[212:215], v[56:59], v[28:31]
    v_exp_f32 v127, v23
    s_waitcnt lgkmcnt(5)
    v_mfma_f32_16x16x32_bf16 v[24:27], v[128:131], v[64:67], v[24:27]
    v_fma_f32 v120, v120, s28, s28
    v_fma_f32 v121, v121, s28, s28
    s_waitcnt lgkmcnt(4)
    v_mfma_f32_16x16x32_bf16 v[24:27], v[152:155], v[68:71], v[24:27]
    v_fma_f32 v122, v122, s28, s28
    v_fma_f32 v123, v123, s28, s28
    v_mfma_f32_16x16x32_bf16 v[28:31], v[156:159], v[68:71], v[28:31]
    v_fma_f32 v124, v124, s28, s28
    v_fma_f32 v125, v125, s28, s28
    v_mfma_f32_16x16x32_bf16 v[28:31], v[132:135], v[64:67], v[28:31]
    v_fma_f32 v126, v126, s28, s28
    v_fma_f32 v127, v127, s28, s28
    s_waitcnt lgkmcnt(3)
    v_mfma_f32_16x16x32_bf16 v[24:27], v[176:179], v[72:75], v[24:27]
    v_rcp_f32 v120, v120
    s_waitcnt lgkmcnt(2)
    v_mfma_f32_16x16x32_bf16 v[24:27], v[200:203], v[76:79], v[24:27]
    v_rcp_f32 v121, v121
    v_mfma_f32_16x16x32_bf16 v[28:31], v[204:207], v[76:79], v[28:31]
    v_rcp_f32 v122, v122
    v_mfma_f32_16x16x32_bf16 v[28:31], v[180:183], v[72:75], v[28:31]
    v_rcp_f32 v123, v123
    s_waitcnt lgkmcnt(1)
    v_mfma_f32_16x16x32_bf16 v[24:27], v[224:227], v[80:83], v[24:27]
    v_rcp_f32 v124, v124
    s_waitcnt lgkmcnt(0)
    v_mfma_f32_16x16x32_bf16 v[24:27], v[248:251], v[84:87], v[24:27]
    v_rcp_f32 v125, v125
    v_mfma_f32_16x16x32_bf16 v[28:31], v[252:255], v[84:87], v[28:31]
    v_rcp_f32 v126, v126
    v_mfma_f32_16x16x32_bf16 v[28:31], v[228:231], v[80:83], v[28:31]
    v_rcp_f32 v127, v127
    v_mfma_f32_16x16x32_bf16 v[32:35], a[8:11], v[88:91], v[32:35]
    v_mul_f32 v16, v16, v120
    v_mul_f32 v17, v17, v121
    v_mfma_f32_16x16x32_bf16 v[32:35], a[32:35], v[92:95], v[32:35]
    v_mul_f32 v18, v18, v122
    v_mul_f32 v19, v19, v123
    v_mfma_f32_16x16x32_bf16 v[32:35], a[56:59], v[96:99], v[32:35]
    v_mul_f32 v20, v20, v124
    v_mul_f32 v21, v21, v125
    v_mfma_f32_16x16x32_bf16 v[32:35], a[80:83], v[100:103], v[32:35]
    v_mul_f32 v22, v22, v126
    v_mul_f32 v23, v23, v127
    v_mfma_f32_16x16x32_bf16 v[32:35], a[104:107], v[40:43], v[32:35]
    v_cvt_pk_bf16_f32 v16, v16, v17
    v_cvt_pk_bf16_f32 v17, v18, v19
    v_mfma_f32_16x16x32_bf16 v[32:35], a[128:131], v[44:47], v[32:35]
    v_cvt_pk_bf16_f32 v18, v20, v21
    v_cvt_pk_bf16_f32 v19, v22, v23
    v_mfma_f32_16x16x32_bf16 v[32:35], a[152:155], v[48:51], v[32:35]
    v_mfma_f32_16x16x32_bf16 v[32:35], a[176:179], v[52:55], v[32:35]
    v_permlane16_swap_b32 v16, v18
    v_mfma_f32_16x16x32_bf16 v[32:35], a[200:203], v[56:59], v[32:35]
    v_permlane16_swap_b32 v17, v19
    s_add_u32 s39, s39, 1024
    v_mfma_f32_16x16x32_bf16 v[32:35], a[224:227], v[60:63], v[32:35]
    buffer_store_dwordx4 v[16:19], v3, s[16:19], s39 offen nt
    v_mfma_f32_16x16x32_bf16 v[32:35], a[248:251], v[64:67], v[32:35]
    v_fma_f32 v24, v24, v104, v112
    v_fma_f32 v25, v25, v105, v113
    v_mfma_f32_16x16x32_bf16 v[32:35], v[144:147], v[68:71], v[32:35]
    v_fma_f32 v26, v26, v106, v114
    v_fma_f32 v27, v27, v107, v115
    v_mfma_f32_16x16x32_bf16 v[32:35], v[168:171], v[72:75], v[32:35]
    v_fma_f32 v28, v28, v108, v116
    v_fma_f32 v29, v29, v109, v117
    v_mfma_f32_16x16x32_bf16 v[32:35], v[192:195], v[76:79], v[32:35]
    v_fma_f32 v30, v30, v110, v118
    v_fma_f32 v31, v31, v111, v119
    v_mfma_f32_16x16x32_bf16 v[32:35], v[216:219], v[80:83], v[32:35]
    v_exp_f32 v120, v24
    v_mfma_f32_16x16x32_bf16 v[32:35], v[240:243], v[84:87], v[32:35]
    v_exp_f32 v121, v25
    v_mfma_f32_16x16x32_bf16 v[36:39], v[244:247], v[84:87], v[36:39]
    v_exp_f32 v122, v26
    v_mfma_f32_16x16x32_bf16 v[36:39], v[220:223], v[80:83], v[36:39]
    v_exp_f32 v123, v27
    v_mfma_f32_16x16x32_bf16 v[36:39], v[196:199], v[76:79], v[36:39]
    v_exp_f32 v124, v28
    v_mfma_f32_16x16x32_bf16 v[36:39], v[172:175], v[72:75], v[36:39]
    v_exp_f32 v125, v29
    v_mfma_f32_16x16x32_bf16 v[36:39], v[148:151], v[68:71], v[36:39]
    v_exp_f32 v126, v30
    v_mfma_f32_16x16x32_bf16 v[36:39], a[252:255], v[64:67], v[36:39]
    v_exp_f32 v127, v31
    v_mfma_f32_16x16x32_bf16 v[36:39], a[228:231], v[60:63], v[36:39]
    v_fma_f32 v120, v120, s28, s28
    v_fma_f32 v121, v121, s28, s28
    v_mfma_f32_16x16x32_bf16 v[36:39], a[204:207], v[56:59], v[36:39]
    v_fma_f32 v122, v122, s28, s28
    v_fma_f32 v123, v123, s28, s28
    v_mfma_f32_16x16x32_bf16 v[36:39], a[180:183], v[52:55], v[36:39]
    v_fma_f32 v124, v124, s28, s28
    v_fma_f32 v125, v125, s28, s28
    v_mfma_f32_16x16x32_bf16 v[36:39], a[156:159], v[48:51], v[36:39]
    v_fma_f32 v126, v126, s28, s28
    v_fma_f32 v127, v127, s28, s28
    v_mfma_f32_16x16x32_bf16 v[36:39], a[132:135], v[44:47], v[36:39]
    v_rcp_f32 v120, v120
    v_mfma_f32_16x16x32_bf16 v[36:39], a[108:111], v[40:43], v[36:39]
    v_rcp_f32 v121, v121
    v_mfma_f32_16x16x32_bf16 v[36:39], a[84:87], v[100:103], v[36:39]
    v_rcp_f32 v122, v122
    v_mfma_f32_16x16x32_bf16 v[36:39], a[60:63], v[96:99], v[36:39]
    v_rcp_f32 v123, v123
    v_mfma_f32_16x16x32_bf16 v[36:39], a[36:39], v[92:95], v[36:39]
    v_rcp_f32 v124, v124
    v_mfma_f32_16x16x32_bf16 v[36:39], a[12:15], v[88:91], v[36:39]
    v_rcp_f32 v125, v125
    v_rcp_f32 v126, v126
    v_rcp_f32 v127, v127
    v_mul_f32 v24, v24, v120
    v_mul_f32 v25, v25, v121
    v_mul_f32 v26, v26, v122
    v_mul_f32 v27, v27, v123
    v_mul_f32 v28, v28, v124
    v_mul_f32 v29, v29, v125
    v_mul_f32 v30, v30, v126
    v_mul_f32 v31, v31, v127
    v_cvt_pk_bf16_f32 v24, v24, v25
    v_cvt_pk_bf16_f32 v25, v26, v27
    v_cvt_pk_bf16_f32 v26, v28, v29
    v_cvt_pk_bf16_f32 v27, v30, v31
    s_nop 1
    v_permlane16_swap_b32 v24, v26
    s_nop 1
    v_permlane16_swap_b32 v25, v27
    s_mov_b32 s22, 30720
    s_nop 1
    buffer_store_dwordx4 v[24:27], v3, s[16:19], s22 offen nt
    v_fma_f32 v32, v32, v104, v112
    v_fma_f32 v33, v33, v105, v113
    v_fma_f32 v34, v34, v106, v114
    v_fma_f32 v35, v35, v107, v115
    v_exp_f32 v120, v32
    v_exp_f32 v121, v33
    v_exp_f32 v122, v34
    v_exp_f32 v123, v35
    v_fma_f32 v120, v120, s28, s28
    v_fma_f32 v121, v121, s28, s28
    v_fma_f32 v122, v122, s28, s28
    v_fma_f32 v123, v123, s28, s28
    v_rcp_f32 v120, v120
    v_rcp_f32 v121, v121
    v_rcp_f32 v122, v122
    v_rcp_f32 v123, v123
    v_mul_f32 v32, v32, v120
    v_mul_f32 v33, v33, v121
    v_mul_f32 v34, v34, v122
    v_mul_f32 v35, v35, v123
    v_cvt_pk_bf16_f32 v32, v32, v33
    v_cvt_pk_bf16_f32 v33, v34, v35
    v_fma_f32 v36, v36, v108, v116
    v_fma_f32 v37, v37, v109, v117
    v_fma_f32 v38, v38, v110, v118
    v_fma_f32 v39, v39, v111, v119
    v_exp_f32 v124, v36
    v_exp_f32 v125, v37
    v_exp_f32 v126, v38
    v_exp_f32 v127, v39
    v_fma_f32 v124, v124, s28, s28
    v_fma_f32 v125, v125, s28, s28
    v_fma_f32 v126, v126, s28, s28
    v_fma_f32 v127, v127, s28, s28
    v_rcp_f32 v124, v124
    v_rcp_f32 v125, v125
    v_rcp_f32 v126, v126
    v_rcp_f32 v127, v127
    v_mul_f32 v36, v36, v124
    v_mul_f32 v37, v37, v125
    v_mul_f32 v38, v38, v126
    v_mul_f32 v39, v39, v127
    v_cvt_pk_bf16_f32 v34, v36, v37
    v_cvt_pk_bf16_f32 v35, v38, v39
    s_nop 1
    v_permlane16_swap_b32 v32, v34
    s_nop 1
    v_permlane16_swap_b32 v33, v35
    s_mov_b32 s22, 31744
    s_nop 1
    buffer_store_dwordx4 v[32:35], v3, s[16:19], s22 offen nt
L_end:
    s_endpgm
L_code_end:
.section .rodata,"a"
.p2align 6
.amdhsa_kernel standalone__batchnorm__sampling_kernel
  .amdhsa_next_free_vgpr 512
  .amdhsa_next_free_sgpr 102
  .amdhsa_accum_offset 256
  .amdhsa_group_segment_fixed_size 0
  .amdhsa_kernarg_size 72
  .amdhsa_user_sgpr_count 2
  .amdhsa_user_sgpr_kernarg_segment_ptr 1
  .amdhsa_system_sgpr_workgroup_id_x 1
.end_amdhsa_kernel
```
